```python
import torch

def _softmax(x, axis=-1):
    return torch.softmax(x, dim=axis)
def _gelu(x):
    return torch.nn.functional.gelu(x, approximate="tanh")
def _silu(x):
    return torch.nn.functional.silu(x)
def _sigmoid(x):
    return torch.sigmoid(x)
def _layernorm(x, axis=-1, eps=1e-5):
    m = x.mean(dim=axis, keepdim=True)
    v = x.var(dim=axis, keepdim=True, unbiased=False)
    return (x - m) / torch.sqrt(v + eps)
def _scatter_add(tgt, idx, src, axis=0):
    return tgt.clone().index_add_(axis, idx, src)
def _segment_sum(src, seg, n):
    out = torch.zeros((n,) + src.shape[1:], dtype=src.dtype)
    return out.index_add_(0, seg, src)
def _pad(x, pw):
    flat = tuple(v for pair in reversed(pw) for v in pair)
    return torch.nn.functional.pad(x, flat)

kernel_name = 'recurrent_scan__sliding_block_cached__moe_arch_mod__prompt'

def setup_inputs():

    _w = (lambda a: (lambda t: t.to(torch.bfloat16) if t.is_floating_point() else t)(torch.as_tensor(a)))
    def _A_setup():
        B, Sq, D = 1, 2048, 512
        Hq, Hkv, Sk, Dh = 32, 8, 2048, 128
        assert Hq % Hkv == 0, (Hq, Hkv)
        return {
            "x": _w((lambda *s: torch.randn(*s, dtype=torch.bfloat16) * 0.05)(B, Sq, D)),
            "k_cache": _w((lambda *s: torch.randn(*s, dtype=torch.bfloat16) * 0.8)(B, Hkv, Sk, Dh)),
            "v_cache": _w((lambda *s: torch.randn(*s, dtype=torch.bfloat16) * 0.2)(B, Hkv, Sk, Dh)),
            "wq": _w((lambda *s: torch.randn(*s, dtype=torch.bfloat16) * 0.8)(D, Hq * Dh) * (D ** -0.5)),
            "wo": _w((lambda *s: torch.randn(*s, dtype=torch.bfloat16) * 0.2)(Hq * Dh, D) * ((Hq * Dh) ** -0.5)),
        }
    _A_in = _A_setup()

    def _B_setup():
        B, S, D, F, C = 1, 2048, 512, 1792, 1
        return {
            "x": _w((lambda *s: torch.randn(*s, dtype=torch.bfloat16) * 0.05)(B, S, D)),
            "w_r": _w((lambda *s: torch.randn(*s, dtype=torch.bfloat16) * 0.2)(D)),
            "w_gate": _w((lambda *s: torch.randn(*s, dtype=torch.bfloat16) * 0.1)(D, F)),
            "w_up": _w((lambda *s: torch.randn(*s, dtype=torch.bfloat16) * 0.1)(D, F)),
            "w_down": _w((lambda *s: torch.randn(*s, dtype=torch.bfloat16) * 0.1)(F, D)),
        }
    _B_in = _B_setup()

    return {
        "A_x": _A_in["x"],
        "A_k_cache": _A_in["k_cache"],
        "A_v_cache": _A_in["v_cache"],
        "A_wq": _A_in["wq"],
        "A_wo": _A_in["wo"],
        "B_x": _B_in["x"],
        "B_w_r": _B_in["w_r"],
        "B_w_gate": _B_in["w_gate"],
        "B_w_up": _B_in["w_up"],
        "B_w_down": _B_in["w_down"],
    }

def reference(A_x, A_k_cache, A_v_cache, A_wq, A_wo, B_x, B_w_r, B_w_gate, B_w_up, B_w_down):
    def _A_ref(x, k_cache, v_cache, wq, wo):
        B, Sq, D = x.shape
        Hq, Dh = 32, 128
        Hkv, Sk = k_cache.shape[1], k_cache.shape[2]
        W = min(4096, max(256, Sk // 4))
        rep = Hq // Hkv
        q = (lambda x, *d: x.permute(*d))((x @ wq).reshape(B, Sq, Hq, Dh), 0, 2, 1, 3)
        k = (lambda x, n, axis: torch.repeat_interleave(x, n, dim=axis))(k_cache[:, :, Sk - W:, :], rep, axis=1)
        v = (lambda x, n, axis: torch.repeat_interleave(x, n, dim=axis))(v_cache[:, :, Sk - W:, :], rep, axis=1)
        scores = torch.einsum("bhqd,bhkd->bhqk", q, k) * (Dh ** -0.5)
        p = _softmax(scores, axis=-1)
        o = torch.einsum("bhqk,bhkd->bhqd", p, v)
        return (lambda x, *d: x.permute(*d))(o, 0, 2, 1, 3).reshape(B, Sq, Hq * Dh) @ wo

    def _B_ref(x, w_r, w_gate, w_up, w_down):
        B, S, D = x.shape
        C = 1
        r = x @ w_r
        idx = torch.argsort(-r, axis=-1)[:, :C]
        idx_e = (lambda x, n, axis: torch.repeat_interleave(x, n, dim=axis))(idx.reshape(B, C, 1), D, axis=2)
        x_sel = (lambda x, i, axis: torch.take_along_dim(x, i, dim=axis))(x, idx_e, axis=1)
        g = _silu(x_sel @ w_gate)
        u = x_sel @ w_up
        y = (g * u) @ w_down
        r_sel = _sigmoid((lambda x, i, axis: torch.take_along_dim(x, i, dim=axis))(r, idx, axis=1))
        y = y * r_sel.reshape(B, C, 1)
        b_off = (torch.arange(B) * S).reshape(B, 1)
        flat_idx = (idx + b_off).reshape(B * C)
        zero = (x * 0.0).reshape(B * S, D)
        upd = _scatter_add(zero, flat_idx, y.reshape(B * C, D), axis=0)
        return x + upd.reshape(B, S, D)

    x = A_x
    xn = _layernorm(x, axis=-1)
    s = _A_ref(xn, A_k_cache, A_v_cache, A_wq, A_wo)
    g = _silu(_B_ref(xn, B_w_r, B_w_gate, B_w_up, B_w_down))
    return x + s * g
```

```asm
; @launch grid=(256,1,1) block=(256,1,1) lds=163840
.amdgcn_target "amdgcn-amd-amdhsa--gfx950"
.text
.globl recurrent_scan__sliding_block_cached__moe_arch_mod__prompt_kernel
.p2align 8
.type recurrent_scan__sliding_block_cached__moe_arch_mod__prompt_kernel,@function
recurrent_scan__sliding_block_cached__moe_arch_mod__prompt_kernel:
  s_cmp_ge_u32 s2, 256
  s_cbranch_scc1 L1_end
  s_load_dwordx16 s[32:47], s[0:1], 0
  s_load_dwordx8 s[48:55], s[0:1], 64
  s_load_dwordx2 s[56:57], s[0:1], 96
  s_getpc_b64 s[98:99]
  v_lshrrev_b32 v250, 6, v0
  v_and_b32 v255, 63, v0
  s_and_b32 s6, s2, 7
  s_lshr_b32 s7, s2, 3
  s_and_b32 s3, s6, 3
  s_lshl_b32 s3, s3, 1
  s_and_b32 s4, s7, 1
  s_add_u32 s3, s3, s4
  s_lshr_b32 s4, s6, 2
  s_lshl_b32 s4, s4, 4
  s_lshr_b32 s7, s7, 1
  s_add_u32 s4, s4, s7
  v_readfirstlane_b32 s5, v250
  s_mov_b32 s58, 0x05040100
  s_mov_b32 s59, 0x07060302
  s_mov_b32 s65, 0xffff0000
  v_lshrrev_b32 v250, 2, v255
  v_lshlrev_b32 v250, 10, v250
  v_and_b32 v251, 3, v255
  v_lshl_add_u32 v250, v251, 4, v250
  s_lshl_b32 s6, s5, 14
  s_lshl_b32 s64, s4, 16
  s_lshl_b32 s63, s5, 11
  v_add_u32 v246, s6, v250
  s_waitcnt lgkmcnt(0)
  s_mov_b32 s8, s32
  s_and_b32 s9, s33, 0xffff
  s_mov_b32 s10, 2097152
  s_mov_b32 s11, 0x20000
  s_and_b32 s6, s3, 1
  s_lshl_b32 s66, s6, 9
  v_add_u32 v250, s66, v246
  v_xor_b32 v251, 0x200, v250
  buffer_load_dwordx4 v[0:3], v250, s[8:11], s64 offen offset:0
  buffer_load_dwordx4 v[4:7], v250, s[8:11], s64 offen offset:64
  buffer_load_dwordx4 v[8:11], v250, s[8:11], s64 offen offset:128
  buffer_load_dwordx4 v[12:15], v250, s[8:11], s64 offen offset:192
  s_mov_b32 s12, s38
  s_and_b32 s13, s39, 0xffff
  s_mov_b32 s14, 4194304
  s_mov_b32 s15, 0x20000
  s_and_b32 s6, s4, 15
  s_lshl_b32 s6, s6, 2
  s_add_u32 s6, s6, s5
  s_mul_i32 s6, s6, 16
  v_and_b32 v252, 15, v255
  v_add_u32 v252, s6, v252
  v_lshrrev_b32 v235, 3, v252
  v_lshlrev_b32 v235, 13, v235
  v_and_b32 v252, 7, v252
  v_lshl_add_u32 v235, v252, 7, v235
  s_lshl_b32 s7, s3, 10
  s_mov_b32 s62, s7
  s_lshr_b32 s6, s2, 3
  s_lshl_b32 s6, s6, 2
  s_add_u32 s6, s6, s5
  s_lshl_b32 s6, s6, 9
  v_and_b32 v252, 3, v255
  v_lshlrev_b32 v252, 7, v252
  v_add_u32 v252, s6, v252
  v_min_u32 v252, (L1_end-recurrent_scan__sliding_block_cached__moe_arch_mod__prompt_kernel-1024), v252
  v_mov_b32 v234, v252
  buffer_load_dwordx4 v[16:19], v250, s[8:11], s64 offen offset:256
  buffer_load_dwordx4 v[20:23], v250, s[8:11], s64 offen offset:320
  buffer_load_dwordx4 v[24:27], v250, s[8:11], s64 offen offset:384
  buffer_load_dwordx4 v[28:31], v250, s[8:11], s64 offen offset:448
  s_barrier
  buffer_load_dwordx4 v[32:35], v251, s[8:11], s64 offen offset:0
  buffer_load_dwordx4 v[36:39], v251, s[8:11], s64 offen offset:64
  buffer_load_dwordx4 v[40:43], v251, s[8:11], s64 offen offset:128
  buffer_load_dwordx4 v[44:47], v251, s[8:11], s64 offen offset:192
  global_load_dword v232, v234, s[98:99]
  buffer_load_dwordx4 v[48:51], v251, s[8:11], s64 offen offset:256
  buffer_load_dwordx4 v[52:55], v251, s[8:11], s64 offen offset:320
  buffer_load_dwordx4 v[56:59], v251, s[8:11], s64 offen offset:384
  buffer_load_dwordx4 v[60:63], v251, s[8:11], s64 offen offset:448
  s_lshl_b32 s7, s5, 10
  s_add_u32 m0, s7, 131072
  v_lshlrev_b32 v252, 4, v255
  global_load_lds_dwordx4 v252, s[44:45]
  s_mov_b32 s61, s66
  buffer_load_dword v233, v235, s[12:15], s62 offen
  s_add_u32 s62, s62, 1048576
  buffer_load_dword v233, v235, s[12:15], s62 offen
  s_add_u32 s62, s62, 1048576
  buffer_load_dword v233, v235, s[12:15], s62 offen
  s_add_u32 s62, s62, 1048576
  buffer_load_dword v233, v235, s[12:15], s62 offen
  s_add_u32 s62, s62, 1048576
  s_lshl_b32 s6, s3, 19
  s_add_u32 s6, s6, 393216
  s_add_u32 s20, s34, s6
  s_addc_u32 s21, s35, 0
  s_and_b32 s21, s21, 0xffff
  s_mov_b32 s22, 131072
  s_mov_b32 s23, 0x20000
  s_add_u32 s24, s36, s6
  s_addc_u32 s25, s37, 0
  s_and_b32 s25, s25, 0xffff
  s_mov_b32 s26, 131072
  s_mov_b32 s27, 0x20000
  s_and_b32 s6, s4, 15
  s_lshl_b32 s6, s6, 2
  s_add_u32 s6, s6, s5
  s_mul_i32 s6, s6, 4
  v_and_b32 v252, 3, v255
  v_add_u32 v252, s6, v252
  v_lshlrev_b32 v253, 7, v252
  s_mov_b32 s7, 0
  buffer_load_dword v233, v253, s[20:23], s7 offen
  buffer_load_dword v233, v253, s[24:27], s7 offen
  v_lshrrev_b32 v250, 4, v255
  v_and_b32 v251, 15, v255
  v_lshlrev_b32 v252, 16, v250
  v_lshl_add_u32 v236, v251, 4, v252
  v_add_u32 v237, 8192, v236
  v_add_u32 v238, 16384, v236
  v_add_u32 v239, 24576, v236
  v_add_u32 v240, 32768, v236
  v_add_u32 v241, 40960, v236
  v_add_u32 v242, 49152, v236
  v_add_u32 v243, 57344, v236
  s_lshl_b32 s6, s3, 2
  s_add_u32 s6, s6, s5
  s_lshl_b32 s60, s6, 8
  s_mov_b32 s16, s40
  s_and_b32 s17, s41, 0xffff
  s_mov_b32 s18, 4194304
  s_mov_b32 s19, 0x20000
  s_mov_b32 s28, s56
  s_and_b32 s29, s57, 0xffff
  s_mov_b32 s30, 268435456
  s_mov_b32 s31, 0x20000
  s_mov_b32 s32, s50
  s_and_b32 s33, s51, 0xffff
  s_mov_b32 s34, 1835008
  s_mov_b32 s35, 0x20000
  s_mov_b32 s36, s54
  s_and_b32 s37, s55, 0xffff
  s_mov_b32 s38, 256
  s_mov_b32 s39, 0x20000
  s_lshl_b32 s6, s5, 3
  v_add_u32 v252, s6, v250
  v_lshlrev_b32 v252, 8, v252
  s_and_b32 s7, s5, 1
  s_lshl_b32 s7, s7, 3
  v_add_u32 v253, s7, v250
  v_xor_b32 v254, v251, v253
  v_lshl_add_u32 v247, v254, 4, v252
  v_add_u32 v253, 4, v253
  v_xor_b32 v254, v251, v253
  v_lshl_add_u32 v248, v254, 4, v252
  v_lshlrev_b32 v253, 2, v250
  v_xor_b32 v254, v251, v253
  v_lshl_add_u32 v249, v254, 4, v252
  v_lshlrev_b32 v253, 1, v250
  v_xor_b32 v254, v251, v253
  v_lshl_add_u32 v254, v250, 4, v254
  v_lshlrev_b32 v244, 4, v254
  v_add_u32 v245, 0x10000, v244
  s_mov_b32 s98, 0x3f803f80
  s_and_b32 s6, s4, 7
  s_cmp_eq_u32 s6, s3
  s_cselect_b32 s66, 1, 0
  s_cbranch_scc0 L1_p1plain
  s_waitcnt vmcnt(6)
  v_and_b32 v251, 3, v255
  v_lshlrev_b32 v251, 4, v251
  s_lshl_b32 s7, s5, 10
  s_add_u32 s7, s7, 131072
  s_add_u32 s7, s7, s61
  v_add_u32 v251, s7, v251
  v_xor_b32 v252, 0x200, v251
  ds_read_b128 v[64:67], v251 offset:0
  ds_read_b128 v[68:71], v251 offset:64
  ds_read_b128 v[72:75], v251 offset:128
  ds_read_b128 v[76:79], v251 offset:192
  ds_read_b128 v[80:83], v251 offset:256
  ds_read_b128 v[84:87], v251 offset:320
  ds_read_b128 v[88:91], v251 offset:384
  ds_read_b128 v[92:95], v251 offset:448
  s_waitcnt lgkmcnt(0)
  ds_read_b128 v[96:99], v252 offset:0
  ds_read_b128 v[100:103], v252 offset:64
  ds_read_b128 v[104:107], v252 offset:128
  ds_read_b128 v[108:111], v252 offset:192
  ds_read_b128 v[112:115], v252 offset:256
  ds_read_b128 v[116:119], v252 offset:320
  ds_read_b128 v[120:123], v252 offset:384
  ds_read_b128 v[124:127], v252 offset:448
  s_waitcnt lgkmcnt(0)
  v_dot2_f32_bf16 v132, v64, s98, 0
  v_dot2_f32_bf16 v133, v65, s98, 0
  v_dot2_f32_bf16 v134, v66, s98, 0
  v_dot2_f32_bf16 v135, v67, s98, 0
  v_dot2_f32_bf16 v132, v68, s98, v132
  v_dot2_f32_bf16 v133, v69, s98, v133
  v_dot2_f32_bf16 v134, v70, s98, v134
  v_dot2_f32_bf16 v135, v71, s98, v135
  v_dot2_f32_bf16 v132, v72, s98, v132
  v_dot2_f32_bf16 v133, v73, s98, v133
  v_dot2_f32_bf16 v134, v74, s98, v134
  v_dot2_f32_bf16 v135, v75, s98, v135
  v_dot2_f32_bf16 v132, v76, s98, v132
  v_dot2_f32_bf16 v133, v77, s98, v133
  v_dot2_f32_bf16 v134, v78, s98, v134
  v_dot2_f32_bf16 v135, v79, s98, v135
  v_dot2_f32_bf16 v132, v80, s98, v132
  v_dot2_f32_bf16 v133, v81, s98, v133
  v_dot2_f32_bf16 v134, v82, s98, v134
  v_dot2_f32_bf16 v135, v83, s98, v135
  v_dot2_f32_bf16 v132, v84, s98, v132
  v_dot2_f32_bf16 v133, v85, s98, v133
  v_dot2_f32_bf16 v134, v86, s98, v134
  v_dot2_f32_bf16 v135, v87, s98, v135
  v_dot2_f32_bf16 v132, v88, s98, v132
  v_dot2_f32_bf16 v133, v89, s98, v133
  v_dot2_f32_bf16 v134, v90, s98, v134
  v_dot2_f32_bf16 v135, v91, s98, v135
  v_dot2_f32_bf16 v132, v92, s98, v132
  v_dot2_f32_bf16 v133, v93, s98, v133
  v_dot2_f32_bf16 v134, v94, s98, v134
  v_dot2_f32_bf16 v135, v95, s98, v135
  v_dot2_f32_bf16 v132, v96, s98, v132
  v_dot2_f32_bf16 v133, v97, s98, v133
  v_dot2_f32_bf16 v134, v98, s98, v134
  v_dot2_f32_bf16 v135, v99, s98, v135
  v_dot2_f32_bf16 v132, v100, s98, v132
  v_dot2_f32_bf16 v133, v101, s98, v133
  v_dot2_f32_bf16 v134, v102, s98, v134
  v_dot2_f32_bf16 v135, v103, s98, v135
  v_dot2_f32_bf16 v132, v104, s98, v132
  v_dot2_f32_bf16 v133, v105, s98, v133
  v_dot2_f32_bf16 v134, v106, s98, v134
  v_dot2_f32_bf16 v135, v107, s98, v135
  v_dot2_f32_bf16 v132, v108, s98, v132
  v_dot2_f32_bf16 v133, v109, s98, v133
  v_dot2_f32_bf16 v134, v110, s98, v134
  v_dot2_f32_bf16 v135, v111, s98, v135
  v_dot2_f32_bf16 v132, v112, s98, v132
  v_dot2_f32_bf16 v133, v113, s98, v133
  v_dot2_f32_bf16 v134, v114, s98, v134
  v_dot2_f32_bf16 v135, v115, s98, v135
  v_dot2_f32_bf16 v132, v116, s98, v132
  v_dot2_f32_bf16 v133, v117, s98, v133
  v_dot2_f32_bf16 v134, v118, s98, v134
  v_dot2_f32_bf16 v135, v119, s98, v135
  v_dot2_f32_bf16 v132, v120, s98, v132
  v_dot2_f32_bf16 v133, v121, s98, v133
  v_dot2_f32_bf16 v134, v122, s98, v134
  v_dot2_f32_bf16 v135, v123, s98, v135
  v_dot2_f32_bf16 v132, v124, s98, v132
  v_dot2_f32_bf16 v133, v125, s98, v133
  v_dot2_f32_bf16 v134, v126, s98, v134
  v_dot2_f32_bf16 v135, v127, s98, v135
  s_waitcnt vmcnt(20)
  v_dot2_f32_bf16 v224, v0, s98, 0
  v_dot2_f32_bf16 v228, v0, v0, 0
  v_dot2_f32_bf16 v128, v0, v64, 0
  v_dot2_f32_bf16 v225, v1, s98, 0
  v_dot2_f32_bf16 v229, v1, v1, 0
  v_dot2_f32_bf16 v129, v1, v65, 0
  v_dot2_f32_bf16 v226, v2, s98, 0
  v_dot2_f32_bf16 v230, v2, v2, 0
  v_dot2_f32_bf16 v130, v2, v66, 0
  v_dot2_f32_bf16 v227, v3, s98, 0
  v_dot2_f32_bf16 v231, v3, v3, 0
  v_dot2_f32_bf16 v131, v3, v67, 0
  v_dot2_f32_bf16 v224, v4, s98, v224
  v_dot2_f32_bf16 v228, v4, v4, v228
  v_dot2_f32_bf16 v128, v4, v68, v128
  v_dot2_f32_bf16 v225, v5, s98, v225
  v_dot2_f32_bf16 v229, v5, v5, v229
  v_dot2_f32_bf16 v129, v5, v69, v129
  v_dot2_f32_bf16 v226, v6, s98, v226
  v_dot2_f32_bf16 v230, v6, v6, v230
  v_dot2_f32_bf16 v130, v6, v70, v130
  v_dot2_f32_bf16 v227, v7, s98, v227
  v_dot2_f32_bf16 v231, v7, v7, v231
  v_dot2_f32_bf16 v131, v7, v71, v131
  v_dot2_f32_bf16 v224, v8, s98, v224
  v_dot2_f32_bf16 v228, v8, v8, v228
  v_dot2_f32_bf16 v128, v8, v72, v128
  v_dot2_f32_bf16 v225, v9, s98, v225
  v_dot2_f32_bf16 v229, v9, v9, v229
  v_dot2_f32_bf16 v129, v9, v73, v129
  v_dot2_f32_bf16 v226, v10, s98, v226
  v_dot2_f32_bf16 v230, v10, v10, v230
  v_dot2_f32_bf16 v130, v10, v74, v130
  v_dot2_f32_bf16 v227, v11, s98, v227
  v_dot2_f32_bf16 v231, v11, v11, v231
  v_dot2_f32_bf16 v131, v11, v75, v131
  v_dot2_f32_bf16 v224, v12, s98, v224
  v_dot2_f32_bf16 v228, v12, v12, v228
  v_dot2_f32_bf16 v128, v12, v76, v128
  v_dot2_f32_bf16 v225, v13, s98, v225
  v_dot2_f32_bf16 v229, v13, v13, v229
  v_dot2_f32_bf16 v129, v13, v77, v129
  v_dot2_f32_bf16 v226, v14, s98, v226
  v_dot2_f32_bf16 v230, v14, v14, v230
  v_dot2_f32_bf16 v130, v14, v78, v130
  v_dot2_f32_bf16 v227, v15, s98, v227
  v_dot2_f32_bf16 v231, v15, v15, v231
  v_dot2_f32_bf16 v131, v15, v79, v131
  s_waitcnt vmcnt(16)
  v_dot2_f32_bf16 v224, v16, s98, v224
  v_dot2_f32_bf16 v228, v16, v16, v228
  v_dot2_f32_bf16 v128, v16, v80, v128
  v_dot2_f32_bf16 v225, v17, s98, v225
  v_dot2_f32_bf16 v229, v17, v17, v229
  v_dot2_f32_bf16 v129, v17, v81, v129
  v_dot2_f32_bf16 v226, v18, s98, v226
  v_dot2_f32_bf16 v230, v18, v18, v230
  v_dot2_f32_bf16 v130, v18, v82, v130
  v_dot2_f32_bf16 v227, v19, s98, v227
  v_dot2_f32_bf16 v231, v19, v19, v231
  v_dot2_f32_bf16 v131, v19, v83, v131
  v_dot2_f32_bf16 v224, v20, s98, v224
  v_dot2_f32_bf16 v228, v20, v20, v228
  v_dot2_f32_bf16 v128, v20, v84, v128
  v_dot2_f32_bf16 v225, v21, s98, v225
  v_dot2_f32_bf16 v229, v21, v21, v229
  v_dot2_f32_bf16 v129, v21, v85, v129
  v_dot2_f32_bf16 v226, v22, s98, v226
  v_dot2_f32_bf16 v230, v22, v22, v230
  v_dot2_f32_bf16 v130, v22, v86, v130
  v_dot2_f32_bf16 v227, v23, s98, v227
  v_dot2_f32_bf16 v231, v23, v23, v231
  v_dot2_f32_bf16 v131, v23, v87, v131
  v_dot2_f32_bf16 v224, v24, s98, v224
  v_dot2_f32_bf16 v228, v24, v24, v228
  v_dot2_f32_bf16 v128, v24, v88, v128
  v_dot2_f32_bf16 v225, v25, s98, v225
  v_dot2_f32_bf16 v229, v25, v25, v229
  v_dot2_f32_bf16 v129, v25, v89, v129
  v_dot2_f32_bf16 v226, v26, s98, v226
  v_dot2_f32_bf16 v230, v26, v26, v230
  v_dot2_f32_bf16 v130, v26, v90, v130
  v_dot2_f32_bf16 v227, v27, s98, v227
  v_dot2_f32_bf16 v231, v27, v27, v231
  v_dot2_f32_bf16 v131, v27, v91, v131
  v_dot2_f32_bf16 v224, v28, s98, v224
  v_dot2_f32_bf16 v228, v28, v28, v228
  v_dot2_f32_bf16 v128, v28, v92, v128
  v_dot2_f32_bf16 v225, v29, s98, v225
  v_dot2_f32_bf16 v229, v29, v29, v229
  v_dot2_f32_bf16 v129, v29, v93, v129
  v_dot2_f32_bf16 v226, v30, s98, v226
  v_dot2_f32_bf16 v230, v30, v30, v230
  v_dot2_f32_bf16 v130, v30, v94, v130
  v_dot2_f32_bf16 v227, v31, s98, v227
  v_dot2_f32_bf16 v231, v31, v31, v231
  v_dot2_f32_bf16 v131, v31, v95, v131
  s_waitcnt vmcnt(12)
  v_dot2_f32_bf16 v224, v32, s98, v224
  v_dot2_f32_bf16 v228, v32, v32, v228
  v_dot2_f32_bf16 v128, v32, v96, v128
  v_dot2_f32_bf16 v225, v33, s98, v225
  v_dot2_f32_bf16 v229, v33, v33, v229
  v_dot2_f32_bf16 v129, v33, v97, v129
  v_dot2_f32_bf16 v226, v34, s98, v226
  v_dot2_f32_bf16 v230, v34, v34, v230
  v_dot2_f32_bf16 v130, v34, v98, v130
  v_dot2_f32_bf16 v227, v35, s98, v227
  v_dot2_f32_bf16 v231, v35, v35, v231
  v_dot2_f32_bf16 v131, v35, v99, v131
  v_dot2_f32_bf16 v224, v36, s98, v224
  v_dot2_f32_bf16 v228, v36, v36, v228
  v_dot2_f32_bf16 v128, v36, v100, v128
  v_dot2_f32_bf16 v225, v37, s98, v225
  v_dot2_f32_bf16 v229, v37, v37, v229
  v_dot2_f32_bf16 v129, v37, v101, v129
  v_dot2_f32_bf16 v226, v38, s98, v226
  v_dot2_f32_bf16 v230, v38, v38, v230
  v_dot2_f32_bf16 v130, v38, v102, v130
  v_dot2_f32_bf16 v227, v39, s98, v227
  v_dot2_f32_bf16 v231, v39, v39, v231
  v_dot2_f32_bf16 v131, v39, v103, v131
  v_dot2_f32_bf16 v224, v40, s98, v224
  v_dot2_f32_bf16 v228, v40, v40, v228
  v_dot2_f32_bf16 v128, v40, v104, v128
  v_dot2_f32_bf16 v225, v41, s98, v225
  v_dot2_f32_bf16 v229, v41, v41, v229
  v_dot2_f32_bf16 v129, v41, v105, v129
  v_dot2_f32_bf16 v226, v42, s98, v226
  v_dot2_f32_bf16 v230, v42, v42, v230
  v_dot2_f32_bf16 v130, v42, v106, v130
  v_dot2_f32_bf16 v227, v43, s98, v227
  v_dot2_f32_bf16 v231, v43, v43, v231
  v_dot2_f32_bf16 v131, v43, v107, v131
  v_dot2_f32_bf16 v224, v44, s98, v224
  v_dot2_f32_bf16 v228, v44, v44, v228
  v_dot2_f32_bf16 v128, v44, v108, v128
  v_dot2_f32_bf16 v225, v45, s98, v225
  v_dot2_f32_bf16 v229, v45, v45, v229
  v_dot2_f32_bf16 v129, v45, v109, v129
  v_dot2_f32_bf16 v226, v46, s98, v226
  v_dot2_f32_bf16 v230, v46, v46, v230
  v_dot2_f32_bf16 v130, v46, v110, v130
  v_dot2_f32_bf16 v227, v47, s98, v227
  v_dot2_f32_bf16 v231, v47, v47, v231
  v_dot2_f32_bf16 v131, v47, v111, v131
  s_waitcnt vmcnt(7)
  v_dot2_f32_bf16 v224, v48, s98, v224
  v_dot2_f32_bf16 v228, v48, v48, v228
  v_dot2_f32_bf16 v128, v48, v112, v128
  v_dot2_f32_bf16 v225, v49, s98, v225
  v_dot2_f32_bf16 v229, v49, v49, v229
  v_dot2_f32_bf16 v129, v49, v113, v129
  v_dot2_f32_bf16 v226, v50, s98, v226
  v_dot2_f32_bf16 v230, v50, v50, v230
  v_dot2_f32_bf16 v130, v50, v114, v130
  v_dot2_f32_bf16 v227, v51, s98, v227
  v_dot2_f32_bf16 v231, v51, v51, v231
  v_dot2_f32_bf16 v131, v51, v115, v131
  v_dot2_f32_bf16 v224, v52, s98, v224
  v_dot2_f32_bf16 v228, v52, v52, v228
  v_dot2_f32_bf16 v128, v52, v116, v128
  v_dot2_f32_bf16 v225, v53, s98, v225
  v_dot2_f32_bf16 v229, v53, v53, v229
  v_dot2_f32_bf16 v129, v53, v117, v129
  v_dot2_f32_bf16 v226, v54, s98, v226
  v_dot2_f32_bf16 v230, v54, v54, v230
  v_dot2_f32_bf16 v130, v54, v118, v130
  v_dot2_f32_bf16 v227, v55, s98, v227
  v_dot2_f32_bf16 v231, v55, v55, v231
  v_dot2_f32_bf16 v131, v55, v119, v131
  v_dot2_f32_bf16 v224, v56, s98, v224
  v_dot2_f32_bf16 v228, v56, v56, v228
  v_dot2_f32_bf16 v128, v56, v120, v128
  v_dot2_f32_bf16 v225, v57, s98, v225
  v_dot2_f32_bf16 v229, v57, v57, v229
  v_dot2_f32_bf16 v129, v57, v121, v129
  v_dot2_f32_bf16 v226, v58, s98, v226
  v_dot2_f32_bf16 v230, v58, v58, v230
  v_dot2_f32_bf16 v130, v58, v122, v130
  v_dot2_f32_bf16 v227, v59, s98, v227
  v_dot2_f32_bf16 v231, v59, v59, v231
  v_dot2_f32_bf16 v131, v59, v123, v131
  v_dot2_f32_bf16 v224, v60, s98, v224
  v_dot2_f32_bf16 v228, v60, v60, v228
  v_dot2_f32_bf16 v128, v60, v124, v128
  v_dot2_f32_bf16 v225, v61, s98, v225
  v_dot2_f32_bf16 v229, v61, v61, v229
  v_dot2_f32_bf16 v129, v61, v125, v129
  v_dot2_f32_bf16 v226, v62, s98, v226
  v_dot2_f32_bf16 v230, v62, v62, v230
  v_dot2_f32_bf16 v130, v62, v126, v130
  v_dot2_f32_bf16 v227, v63, s98, v227
  v_dot2_f32_bf16 v231, v63, v63, v231
  v_dot2_f32_bf16 v131, v63, v127, v131
  s_branch L1_p1done
  L1_p1plain:
  s_waitcnt vmcnt(20)
  v_dot2_f32_bf16 v224, v0, s98, 0
  v_dot2_f32_bf16 v228, v0, v0, 0
  v_dot2_f32_bf16 v225, v1, s98, 0
  v_dot2_f32_bf16 v229, v1, v1, 0
  v_dot2_f32_bf16 v226, v2, s98, 0
  v_dot2_f32_bf16 v230, v2, v2, 0
  v_dot2_f32_bf16 v227, v3, s98, 0
  v_dot2_f32_bf16 v231, v3, v3, 0
  v_dot2_f32_bf16 v224, v4, s98, v224
  v_dot2_f32_bf16 v228, v4, v4, v228
  v_dot2_f32_bf16 v225, v5, s98, v225
  v_dot2_f32_bf16 v229, v5, v5, v229
  v_dot2_f32_bf16 v226, v6, s98, v226
  v_dot2_f32_bf16 v230, v6, v6, v230
  v_dot2_f32_bf16 v227, v7, s98, v227
  v_dot2_f32_bf16 v231, v7, v7, v231
  v_dot2_f32_bf16 v224, v8, s98, v224
  v_dot2_f32_bf16 v228, v8, v8, v228
  v_dot2_f32_bf16 v225, v9, s98, v225
  v_dot2_f32_bf16 v229, v9, v9, v229
  v_dot2_f32_bf16 v226, v10, s98, v226
  v_dot2_f32_bf16 v230, v10, v10, v230
  v_dot2_f32_bf16 v227, v11, s98, v227
  v_dot2_f32_bf16 v231, v11, v11, v231
  v_dot2_f32_bf16 v224, v12, s98, v224
  v_dot2_f32_bf16 v228, v12, v12, v228
  v_dot2_f32_bf16 v225, v13, s98, v225
  v_dot2_f32_bf16 v229, v13, v13, v229
  v_dot2_f32_bf16 v226, v14, s98, v226
  v_dot2_f32_bf16 v230, v14, v14, v230
  v_dot2_f32_bf16 v227, v15, s98, v227
  v_dot2_f32_bf16 v231, v15, v15, v231
  s_waitcnt vmcnt(16)
  v_dot2_f32_bf16 v224, v16, s98, v224
  v_dot2_f32_bf16 v228, v16, v16, v228
  v_dot2_f32_bf16 v225, v17, s98, v225
  v_dot2_f32_bf16 v229, v17, v17, v229
  v_dot2_f32_bf16 v226, v18, s98, v226
  v_dot2_f32_bf16 v230, v18, v18, v230
  v_dot2_f32_bf16 v227, v19, s98, v227
  v_dot2_f32_bf16 v231, v19, v19, v231
  v_dot2_f32_bf16 v224, v20, s98, v224
  v_dot2_f32_bf16 v228, v20, v20, v228
  v_dot2_f32_bf16 v225, v21, s98, v225
  v_dot2_f32_bf16 v229, v21, v21, v229
  v_dot2_f32_bf16 v226, v22, s98, v226
  v_dot2_f32_bf16 v230, v22, v22, v230
  v_dot2_f32_bf16 v227, v23, s98, v227
  v_dot2_f32_bf16 v231, v23, v23, v231
  v_dot2_f32_bf16 v224, v24, s98, v224
  v_dot2_f32_bf16 v228, v24, v24, v228
  v_dot2_f32_bf16 v225, v25, s98, v225
  v_dot2_f32_bf16 v229, v25, v25, v229
  v_dot2_f32_bf16 v226, v26, s98, v226
  v_dot2_f32_bf16 v230, v26, v26, v230
  v_dot2_f32_bf16 v227, v27, s98, v227
  v_dot2_f32_bf16 v231, v27, v27, v231
  v_dot2_f32_bf16 v224, v28, s98, v224
  v_dot2_f32_bf16 v228, v28, v28, v228
  v_dot2_f32_bf16 v225, v29, s98, v225
  v_dot2_f32_bf16 v229, v29, v29, v229
  v_dot2_f32_bf16 v226, v30, s98, v226
  v_dot2_f32_bf16 v230, v30, v30, v230
  v_dot2_f32_bf16 v227, v31, s98, v227
  v_dot2_f32_bf16 v231, v31, v31, v231
  s_waitcnt vmcnt(12)
  v_dot2_f32_bf16 v224, v32, s98, v224
  v_dot2_f32_bf16 v228, v32, v32, v228
  v_dot2_f32_bf16 v225, v33, s98, v225
  v_dot2_f32_bf16 v229, v33, v33, v229
  v_dot2_f32_bf16 v226, v34, s98, v226
  v_dot2_f32_bf16 v230, v34, v34, v230
  v_dot2_f32_bf16 v227, v35, s98, v227
  v_dot2_f32_bf16 v231, v35, v35, v231
  v_dot2_f32_bf16 v224, v36, s98, v224
  v_dot2_f32_bf16 v228, v36, v36, v228
  v_dot2_f32_bf16 v225, v37, s98, v225
  v_dot2_f32_bf16 v229, v37, v37, v229
  v_dot2_f32_bf16 v226, v38, s98, v226
  v_dot2_f32_bf16 v230, v38, v38, v230
  v_dot2_f32_bf16 v227, v39, s98, v227
  v_dot2_f32_bf16 v231, v39, v39, v231
  v_dot2_f32_bf16 v224, v40, s98, v224
  v_dot2_f32_bf16 v228, v40, v40, v228
  v_dot2_f32_bf16 v225, v41, s98, v225
  v_dot2_f32_bf16 v229, v41, v41, v229
  v_dot2_f32_bf16 v226, v42, s98, v226
  v_dot2_f32_bf16 v230, v42, v42, v230
  v_dot2_f32_bf16 v227, v43, s98, v227
  v_dot2_f32_bf16 v231, v43, v43, v231
  v_dot2_f32_bf16 v224, v44, s98, v224
  v_dot2_f32_bf16 v228, v44, v44, v228
  v_dot2_f32_bf16 v225, v45, s98, v225
  v_dot2_f32_bf16 v229, v45, v45, v229
  v_dot2_f32_bf16 v226, v46, s98, v226
  v_dot2_f32_bf16 v230, v46, v46, v230
  v_dot2_f32_bf16 v227, v47, s98, v227
  v_dot2_f32_bf16 v231, v47, v47, v231
  s_waitcnt vmcnt(7)
  v_dot2_f32_bf16 v224, v48, s98, v224
  v_dot2_f32_bf16 v228, v48, v48, v228
  v_dot2_f32_bf16 v225, v49, s98, v225
  v_dot2_f32_bf16 v229, v49, v49, v229
  v_dot2_f32_bf16 v226, v50, s98, v226
  v_dot2_f32_bf16 v230, v50, v50, v230
  v_dot2_f32_bf16 v227, v51, s98, v227
  v_dot2_f32_bf16 v231, v51, v51, v231
  v_dot2_f32_bf16 v224, v52, s98, v224
  v_dot2_f32_bf16 v228, v52, v52, v228
  v_dot2_f32_bf16 v225, v53, s98, v225
  v_dot2_f32_bf16 v229, v53, v53, v229
  v_dot2_f32_bf16 v226, v54, s98, v226
  v_dot2_f32_bf16 v230, v54, v54, v230
  v_dot2_f32_bf16 v227, v55, s98, v227
  v_dot2_f32_bf16 v231, v55, v55, v231
  v_dot2_f32_bf16 v224, v56, s98, v224
  v_dot2_f32_bf16 v228, v56, v56, v228
  v_dot2_f32_bf16 v225, v57, s98, v225
  v_dot2_f32_bf16 v229, v57, v57, v229
  v_dot2_f32_bf16 v226, v58, s98, v226
  v_dot2_f32_bf16 v230, v58, v58, v230
  v_dot2_f32_bf16 v227, v59, s98, v227
  v_dot2_f32_bf16 v231, v59, v59, v231
  v_dot2_f32_bf16 v224, v60, s98, v224
  v_dot2_f32_bf16 v228, v60, v60, v228
  v_dot2_f32_bf16 v225, v61, s98, v225
  v_dot2_f32_bf16 v229, v61, v61, v229
  v_dot2_f32_bf16 v226, v62, s98, v226
  v_dot2_f32_bf16 v230, v62, v62, v230
  v_dot2_f32_bf16 v227, v63, s98, v227
  v_dot2_f32_bf16 v231, v63, v63, v231
L1_p1done:
  s_nop 1
  s_nop 0
  v_add_f32 v224, v224, v225
  v_add_f32 v226, v226, v227
  v_add_f32 v228, v228, v229
  v_add_f32 v230, v230, v231
  v_add_f32 v224, v224, v226
  v_add_f32 v228, v228, v230
  s_nop 1
  v_add_f32_dpp v224, v224, v224 quad_perm:[1,0,3,2] row_mask:0xf bank_mask:0xf
  v_add_f32_dpp v228, v228, v228 quad_perm:[1,0,3,2] row_mask:0xf bank_mask:0xf
  s_nop 1
  v_add_f32_dpp v224, v224, v224 quad_perm:[2,3,0,1] row_mask:0xf bank_mask:0xf
  v_add_f32_dpp v228, v228, v228 quad_perm:[2,3,0,1] row_mask:0xf bank_mask:0xf
  s_nop 0
  v_mul_f32 v224, 0x3b000000, v224
  v_mul_f32 v228, 0x3b000000, v228
  v_fma_f32 v228, -v224, v224, v228
  v_max_f32 v228, 0, v228
  v_cvt_pk_bf16_f32 v224, v224, v228
  v_and_b32 v228, s65, v224
  v_lshlrev_b32 v224, 16, v224
  v_add_f32 v228, 0x3727c5ac, v228
  v_cvt_pk_bf16_f32 v228, v228, v228
  v_lshlrev_b32 v228, 16, v228
  v_sqrt_f32 v228, v228
  s_nop 0
  v_cvt_pk_bf16_f32 v228, v228, v228
  v_lshlrev_b32 v228, 16, v228
  v_rcp_f32 v228, v228
  s_nop 0
  v_mov_b32 v225, v228
  v_mul_f32 v226, 0x3e0293ee, v228
  v_mul_f32 v234, v224, v226
  v_mov_b32 v227, v226
  v_sub_f32 v234, 0, v234
  v_mov_b32 v235, v234
  s_and_b32 s6, s4, 7
  s_cmp_eq_u32 s6, s3
  s_cselect_b32 s66, 1, 0
  s_cselect_b32 s98, 0, 268435456
  v_lshrrev_b32 v250, 2, v255
  s_lshl_b32 s6, s4, 6
  s_lshl_b32 s7, s5, 4
  s_add_u32 s6, s6, s7
  v_add_u32 v250, s6, v250
  v_lshlrev_b32 v254, 3, v250
  s_add_u32 s7, s98, 16777216
  v_mov_b32 v230, 0
  v_mov_b32 v231, 0
  buffer_store_dwordx2 v[224:225], v254, s[28:31], s7 offen sc1
  v_lshlrev_b32 v254, 3, v255
  s_lshl_b32 s6, s4, 9
  s_add_u32 s6, s6, s98
  s_add_u32 s6, s6, 16818176
  buffer_store_dwordx2 v[230:231], v254, s[28:31], s6 offen sc1
  v_lshlrev_b32 v254, 2, v255
  s_lshl_b32 s6, s4, 8
  s_add_u32 s6, s6, s98
  s_add_u32 s6, s6, 16809984
  buffer_store_dword v230, v254, s[28:31], s6 offen sc1
  v_mov_b32 v246, v250
  s_cmp_eq_u32 s66, 1
  s_cbranch_scc0 L1_nokey
  v_add_f32 v128, v128, v129
  v_add_f32 v130, v130, v131
  v_add_f32 v132, v132, v133
  v_add_f32 v134, v134, v135
  v_add_f32 v128, v128, v130
  v_add_f32 v132, v132, v134
  s_nop 1
  v_add_f32_dpp v128, v128, v128 quad_perm:[1,0,3,2] row_mask:0xf bank_mask:0xf
  v_add_f32_dpp v132, v132, v132 quad_perm:[1,0,3,2] row_mask:0xf bank_mask:0xf
  s_nop 1
  v_add_f32_dpp v128, v128, v128 quad_perm:[2,3,0,1] row_mask:0xf bank_mask:0xf
  v_add_f32_dpp v132, v132, v132 quad_perm:[2,3,0,1] row_mask:0xf bank_mask:0xf
  s_nop 0
  v_fma_f32 v128, -v224, v132, v128
  v_mul_f32 v128, v128, v225
  v_cvt_pk_bf16_f32 v128, v128, v128
  v_and_b32 v128, 0xffff, v128
  v_cmp_gt_u32 vcc, 0x8000, v128
  v_xor_b32 v129, 0xffff, v128
  v_or_b32 v128, 0x8000, v128
  v_cndmask_b32 v128, v129, v128, vcc
  v_sub_u32 v129, 2047, v246
  v_lshlrev_b32 v129, 1, v129
  v_or_b32 v129, 1, v129
  v_lshl_or_b32 v128, v128, 16, v129
  s_nop 1
  v_max_u32_dpp v128, v128, v128 row_ror:4 row_mask:0xf bank_mask:0xf
  s_nop 1
  v_max_u32_dpp v128, v128, v128 row_ror:8 row_mask:0xf bank_mask:0xf
  s_nop 1
  v_readlane_b32 s6, v128, 0
  v_readlane_b32 s7, v128, 16
  v_readlane_b32 s98, v128, 32
  v_readlane_b32 s99, v128, 48
  s_max_u32 s6, s6, s7
  s_max_u32 s98, s98, s99
  s_max_u32 s6, s6, s98
  s_lshl_b32 s7, s5, 2
  s_add_u32 s7, s7, 139264
  v_mov_b32 v128, s6
  v_mov_b32 v129, s7
  ds_write_b32 v129, v128
  L1_nokey:
  v_lshrrev_b32 v250, 2, v255
  v_and_b32 v251, 3, v255
  v_lshlrev_b32 v252, 1, v251
  v_xor_b32 v252, v250, v252
  v_lshl_add_u32 v252, v251, 4, v252
  v_lshlrev_b32 v252, 4, v252
  s_lshl_b32 s6, s5, 10
  v_add_u32 v228, s6, v252
  s_lshl_b32 s6, s61, 7
  v_add_u32 v228, s6, v228
  v_xor_b32 v229, 0x10000, v228
  v_lshlrev_b32 v64, 16, v0
  v_and_b32 v65, s65, v0
  v_pk_fma_f32 v[64:65], v[64:65], v[226:227], v[234:235]
  v_cvt_pk_bf16_f32 v0, v64, v65
  v_lshlrev_b32 v66, 16, v1
  v_and_b32 v67, s65, v1
  v_pk_fma_f32 v[66:67], v[66:67], v[226:227], v[234:235]
  v_cvt_pk_bf16_f32 v1, v66, v67
  v_lshlrev_b32 v68, 16, v2
  v_and_b32 v69, s65, v2
  v_pk_fma_f32 v[68:69], v[68:69], v[226:227], v[234:235]
  v_cvt_pk_bf16_f32 v2, v68, v69
  v_lshlrev_b32 v70, 16, v3
  v_and_b32 v71, s65, v3
  v_pk_fma_f32 v[70:71], v[70:71], v[226:227], v[234:235]
  v_cvt_pk_bf16_f32 v3, v70, v71
  v_lshlrev_b32 v72, 16, v4
  v_and_b32 v73, s65, v4
  v_pk_fma_f32 v[72:73], v[72:73], v[226:227], v[234:235]
  v_cvt_pk_bf16_f32 v4, v72, v73
  v_lshlrev_b32 v74, 16, v5
  v_and_b32 v75, s65, v5
  v_pk_fma_f32 v[74:75], v[74:75], v[226:227], v[234:235]
  v_cvt_pk_bf16_f32 v5, v74, v75
  ds_write_b128 v228, v[0:3] offset:0
  v_lshlrev_b32 v76, 16, v6
  v_and_b32 v77, s65, v6
  v_pk_fma_f32 v[76:77], v[76:77], v[226:227], v[234:235]
  v_cvt_pk_bf16_f32 v6, v76, v77
  v_lshlrev_b32 v78, 16, v7
  v_and_b32 v79, s65, v7
  v_pk_fma_f32 v[78:79], v[78:79], v[226:227], v[234:235]
  v_cvt_pk_bf16_f32 v7, v78, v79
  v_lshlrev_b32 v64, 16, v8
  v_and_b32 v65, s65, v8
  v_pk_fma_f32 v[64:65], v[64:65], v[226:227], v[234:235]
  v_cvt_pk_bf16_f32 v8, v64, v65
  v_lshlrev_b32 v66, 16, v9
  v_and_b32 v67, s65, v9
  v_pk_fma_f32 v[66:67], v[66:67], v[226:227], v[234:235]
  v_cvt_pk_bf16_f32 v9, v66, v67
  ds_write_b128 v228, v[4:7] offset:4096
  v_lshlrev_b32 v68, 16, v10
  v_and_b32 v69, s65, v10
  v_pk_fma_f32 v[68:69], v[68:69], v[226:227], v[234:235]
  v_cvt_pk_bf16_f32 v10, v68, v69
  v_lshlrev_b32 v70, 16, v11
  v_and_b32 v71, s65, v11
  v_pk_fma_f32 v[70:71], v[70:71], v[226:227], v[234:235]
  v_cvt_pk_bf16_f32 v11, v70, v71
  v_lshlrev_b32 v72, 16, v12
  v_and_b32 v73, s65, v12
  v_pk_fma_f32 v[72:73], v[72:73], v[226:227], v[234:235]
  v_cvt_pk_bf16_f32 v12, v72, v73
  v_lshlrev_b32 v74, 16, v13
  v_and_b32 v75, s65, v13
  v_pk_fma_f32 v[74:75], v[74:75], v[226:227], v[234:235]
  v_cvt_pk_bf16_f32 v13, v74, v75
  ds_write_b128 v228, v[8:11] offset:8192
  v_lshlrev_b32 v76, 16, v14
  v_and_b32 v77, s65, v14
  v_pk_fma_f32 v[76:77], v[76:77], v[226:227], v[234:235]
  v_cvt_pk_bf16_f32 v14, v76, v77
  v_lshlrev_b32 v78, 16, v15
  v_and_b32 v79, s65, v15
  v_pk_fma_f32 v[78:79], v[78:79], v[226:227], v[234:235]
  v_cvt_pk_bf16_f32 v15, v78, v79
  buffer_load_dwordx4 v[128:131], v236, s[12:15], s60 offen
  buffer_load_dwordx4 v[132:135], v237, s[12:15], s60 offen
  buffer_load_dwordx4 v[136:139], v238, s[12:15], s60 offen
  buffer_load_dwordx4 v[140:143], v239, s[12:15], s60 offen
  v_lshlrev_b32 v64, 16, v16
  v_and_b32 v65, s65, v16
  v_pk_fma_f32 v[64:65], v[64:65], v[226:227], v[234:235]
  v_cvt_pk_bf16_f32 v16, v64, v65
  v_lshlrev_b32 v66, 16, v17
  v_and_b32 v67, s65, v17
  v_pk_fma_f32 v[66:67], v[66:67], v[226:227], v[234:235]
  v_cvt_pk_bf16_f32 v17, v66, v67
  ds_write_b128 v228, v[12:15] offset:12288
  v_lshlrev_b32 v68, 16, v18
  v_and_b32 v69, s65, v18
  v_pk_fma_f32 v[68:69], v[68:69], v[226:227], v[234:235]
  v_cvt_pk_bf16_f32 v18, v68, v69
  v_lshlrev_b32 v70, 16, v19
  v_and_b32 v71, s65, v19
  v_pk_fma_f32 v[70:71], v[70:71], v[226:227], v[234:235]
  v_cvt_pk_bf16_f32 v19, v70, v71
  buffer_load_dwordx4 v[144:147], v240, s[12:15], s60 offen
  buffer_load_dwordx4 v[148:151], v241, s[12:15], s60 offen
  buffer_load_dwordx4 v[152:155], v242, s[12:15], s60 offen
  buffer_load_dwordx4 v[156:159], v243, s[12:15], s60 offen
  s_add_u32 s60, s60, 262144
  v_lshlrev_b32 v72, 16, v20
  v_and_b32 v73, s65, v20
  v_pk_fma_f32 v[72:73], v[72:73], v[226:227], v[234:235]
  v_cvt_pk_bf16_f32 v20, v72, v73
  v_lshlrev_b32 v74, 16, v21
  v_and_b32 v75, s65, v21
  v_pk_fma_f32 v[74:75], v[74:75], v[226:227], v[234:235]
  v_cvt_pk_bf16_f32 v21, v74, v75
  ds_write_b128 v228, v[16:19] offset:16384
  v_lshlrev_b32 v76, 16, v22
  v_and_b32 v77, s65, v22
  v_pk_fma_f32 v[76:77], v[76:77], v[226:227], v[234:235]
  v_cvt_pk_bf16_f32 v22, v76, v77
  v_lshlrev_b32 v78, 16, v23
  v_and_b32 v79, s65, v23
  v_pk_fma_f32 v[78:79], v[78:79], v[226:227], v[234:235]
  v_cvt_pk_bf16_f32 v23, v78, v79
  v_lshlrev_b32 v64, 16, v24
  v_and_b32 v65, s65, v24
  v_pk_fma_f32 v[64:65], v[64:65], v[226:227], v[234:235]
  v_cvt_pk_bf16_f32 v24, v64, v65
  v_lshlrev_b32 v66, 16, v25
  v_and_b32 v67, s65, v25
  v_pk_fma_f32 v[66:67], v[66:67], v[226:227], v[234:235]
  v_cvt_pk_bf16_f32 v25, v66, v67
  ds_write_b128 v228, v[20:23] offset:20480
  v_lshlrev_b32 v68, 16, v26
  v_and_b32 v69, s65, v26
  v_pk_fma_f32 v[68:69], v[68:69], v[226:227], v[234:235]
  v_cvt_pk_bf16_f32 v26, v68, v69
  v_lshlrev_b32 v70, 16, v27
  v_and_b32 v71, s65, v27
  v_pk_fma_f32 v[70:71], v[70:71], v[226:227], v[234:235]
  v_cvt_pk_bf16_f32 v27, v70, v71
  v_lshlrev_b32 v72, 16, v28
  v_and_b32 v73, s65, v28
  v_pk_fma_f32 v[72:73], v[72:73], v[226:227], v[234:235]
  v_cvt_pk_bf16_f32 v28, v72, v73
  v_lshlrev_b32 v74, 16, v29
  v_and_b32 v75, s65, v29
  v_pk_fma_f32 v[74:75], v[74:75], v[226:227], v[234:235]
  v_cvt_pk_bf16_f32 v29, v74, v75
  ds_write_b128 v228, v[24:27] offset:24576
  v_lshlrev_b32 v76, 16, v30
  v_and_b32 v77, s65, v30
  v_pk_fma_f32 v[76:77], v[76:77], v[226:227], v[234:235]
  v_cvt_pk_bf16_f32 v30, v76, v77
  v_lshlrev_b32 v78, 16, v31
  v_and_b32 v79, s65, v31
  v_pk_fma_f32 v[78:79], v[78:79], v[226:227], v[234:235]
  v_cvt_pk_bf16_f32 v31, v78, v79
  v_lshlrev_b32 v64, 16, v32
  v_and_b32 v65, s65, v32
  v_pk_fma_f32 v[64:65], v[64:65], v[226:227], v[234:235]
  v_cvt_pk_bf16_f32 v32, v64, v65
  v_lshlrev_b32 v66, 16, v33
  v_and_b32 v67, s65, v33
  v_pk_fma_f32 v[66:67], v[66:67], v[226:227], v[234:235]
  v_cvt_pk_bf16_f32 v33, v66, v67
  ds_write_b128 v228, v[28:31] offset:28672
  v_lshlrev_b32 v68, 16, v34
  v_and_b32 v69, s65, v34
  v_pk_fma_f32 v[68:69], v[68:69], v[226:227], v[234:235]
  v_cvt_pk_bf16_f32 v34, v68, v69
  v_lshlrev_b32 v70, 16, v35
  v_and_b32 v71, s65, v35
  v_pk_fma_f32 v[70:71], v[70:71], v[226:227], v[234:235]
  v_cvt_pk_bf16_f32 v35, v70, v71
  v_lshlrev_b32 v72, 16, v36
  v_and_b32 v73, s65, v36
  v_pk_fma_f32 v[72:73], v[72:73], v[226:227], v[234:235]
  v_cvt_pk_bf16_f32 v36, v72, v73
  v_lshlrev_b32 v74, 16, v37
  v_and_b32 v75, s65, v37
  v_pk_fma_f32 v[74:75], v[74:75], v[226:227], v[234:235]
  v_cvt_pk_bf16_f32 v37, v74, v75
  ds_write_b128 v229, v[32:35] offset:0
  v_lshlrev_b32 v76, 16, v38
  v_and_b32 v77, s65, v38
  v_pk_fma_f32 v[76:77], v[76:77], v[226:227], v[234:235]
  v_cvt_pk_bf16_f32 v38, v76, v77
  v_lshlrev_b32 v78, 16, v39
  v_and_b32 v79, s65, v39
  v_pk_fma_f32 v[78:79], v[78:79], v[226:227], v[234:235]
  v_cvt_pk_bf16_f32 v39, v78, v79
  buffer_load_dwordx4 v[160:163], v236, s[12:15], s60 offen
  buffer_load_dwordx4 v[164:167], v237, s[12:15], s60 offen
  buffer_load_dwordx4 v[168:171], v238, s[12:15], s60 offen
  buffer_load_dwordx4 v[172:175], v239, s[12:15], s60 offen
  v_lshlrev_b32 v64, 16, v40
  v_and_b32 v65, s65, v40
  v_pk_fma_f32 v[64:65], v[64:65], v[226:227], v[234:235]
  v_cvt_pk_bf16_f32 v40, v64, v65
  v_lshlrev_b32 v66, 16, v41
  v_and_b32 v67, s65, v41
  v_pk_fma_f32 v[66:67], v[66:67], v[226:227], v[234:235]
  v_cvt_pk_bf16_f32 v41, v66, v67
  ds_write_b128 v229, v[36:39] offset:4096
  v_lshlrev_b32 v68, 16, v42
  v_and_b32 v69, s65, v42
  v_pk_fma_f32 v[68:69], v[68:69], v[226:227], v[234:235]
  v_cvt_pk_bf16_f32 v42, v68, v69
  v_lshlrev_b32 v70, 16, v43
  v_and_b32 v71, s65, v43
  v_pk_fma_f32 v[70:71], v[70:71], v[226:227], v[234:235]
  v_cvt_pk_bf16_f32 v43, v70, v71
  buffer_load_dwordx4 v[176:179], v240, s[12:15], s60 offen
  buffer_load_dwordx4 v[180:183], v241, s[12:15], s60 offen
  buffer_load_dwordx4 v[184:187], v242, s[12:15], s60 offen
  buffer_load_dwordx4 v[188:191], v243, s[12:15], s60 offen
  s_add_u32 s60, s60, 262144
  v_lshlrev_b32 v72, 16, v44
  v_and_b32 v73, s65, v44
  v_pk_fma_f32 v[72:73], v[72:73], v[226:227], v[234:235]
  v_cvt_pk_bf16_f32 v44, v72, v73
  v_lshlrev_b32 v74, 16, v45
  v_and_b32 v75, s65, v45
  v_pk_fma_f32 v[74:75], v[74:75], v[226:227], v[234:235]
  v_cvt_pk_bf16_f32 v45, v74, v75
  ds_write_b128 v229, v[40:43] offset:8192
  v_lshlrev_b32 v76, 16, v46
  v_and_b32 v77, s65, v46
  v_pk_fma_f32 v[76:77], v[76:77], v[226:227], v[234:235]
  v_cvt_pk_bf16_f32 v46, v76, v77
  v_lshlrev_b32 v78, 16, v47
  v_and_b32 v79, s65, v47
  v_pk_fma_f32 v[78:79], v[78:79], v[226:227], v[234:235]
  v_cvt_pk_bf16_f32 v47, v78, v79
  v_lshlrev_b32 v64, 16, v48
  v_and_b32 v65, s65, v48
  v_pk_fma_f32 v[64:65], v[64:65], v[226:227], v[234:235]
  v_cvt_pk_bf16_f32 v48, v64, v65
  v_lshlrev_b32 v66, 16, v49
  v_and_b32 v67, s65, v49
  v_pk_fma_f32 v[66:67], v[66:67], v[226:227], v[234:235]
  v_cvt_pk_bf16_f32 v49, v66, v67
  ds_write_b128 v229, v[44:47] offset:12288
  v_lshlrev_b32 v68, 16, v50
  v_and_b32 v69, s65, v50
  v_pk_fma_f32 v[68:69], v[68:69], v[226:227], v[234:235]
  v_cvt_pk_bf16_f32 v50, v68, v69
  v_lshlrev_b32 v70, 16, v51
  v_and_b32 v71, s65, v51
  v_pk_fma_f32 v[70:71], v[70:71], v[226:227], v[234:235]
  v_cvt_pk_bf16_f32 v51, v70, v71
  v_lshlrev_b32 v72, 16, v52
  v_and_b32 v73, s65, v52
  v_pk_fma_f32 v[72:73], v[72:73], v[226:227], v[234:235]
  v_cvt_pk_bf16_f32 v52, v72, v73
  v_lshlrev_b32 v74, 16, v53
  v_and_b32 v75, s65, v53
  v_pk_fma_f32 v[74:75], v[74:75], v[226:227], v[234:235]
  v_cvt_pk_bf16_f32 v53, v74, v75
  ds_write_b128 v229, v[48:51] offset:16384
  v_lshlrev_b32 v76, 16, v54
  v_and_b32 v77, s65, v54
  v_pk_fma_f32 v[76:77], v[76:77], v[226:227], v[234:235]
  v_cvt_pk_bf16_f32 v54, v76, v77
  v_lshlrev_b32 v78, 16, v55
  v_and_b32 v79, s65, v55
  v_pk_fma_f32 v[78:79], v[78:79], v[226:227], v[234:235]
  v_cvt_pk_bf16_f32 v55, v78, v79
  v_lshlrev_b32 v64, 16, v56
  v_and_b32 v65, s65, v56
  v_pk_fma_f32 v[64:65], v[64:65], v[226:227], v[234:235]
  v_cvt_pk_bf16_f32 v56, v64, v65
  v_lshlrev_b32 v66, 16, v57
  v_and_b32 v67, s65, v57
  v_pk_fma_f32 v[66:67], v[66:67], v[226:227], v[234:235]
  v_cvt_pk_bf16_f32 v57, v66, v67
  ds_write_b128 v229, v[52:55] offset:20480
  v_lshlrev_b32 v68, 16, v58
  v_and_b32 v69, s65, v58
  v_pk_fma_f32 v[68:69], v[68:69], v[226:227], v[234:235]
  v_cvt_pk_bf16_f32 v58, v68, v69
  v_lshlrev_b32 v70, 16, v59
  v_and_b32 v71, s65, v59
  v_pk_fma_f32 v[70:71], v[70:71], v[226:227], v[234:235]
  v_cvt_pk_bf16_f32 v59, v70, v71
  buffer_load_dwordx4 v[192:195], v236, s[12:15], s60 offen
  buffer_load_dwordx4 v[196:199], v237, s[12:15], s60 offen
  buffer_load_dwordx4 v[200:203], v238, s[12:15], s60 offen
  buffer_load_dwordx4 v[204:207], v239, s[12:15], s60 offen
  v_lshlrev_b32 v72, 16, v60
  v_and_b32 v73, s65, v60
  v_pk_fma_f32 v[72:73], v[72:73], v[226:227], v[234:235]
  v_cvt_pk_bf16_f32 v60, v72, v73
  v_lshlrev_b32 v74, 16, v61
  v_and_b32 v75, s65, v61
  v_pk_fma_f32 v[74:75], v[74:75], v[226:227], v[234:235]
  v_cvt_pk_bf16_f32 v61, v74, v75
  ds_write_b128 v229, v[56:59] offset:24576
  v_lshlrev_b32 v76, 16, v62
  v_and_b32 v77, s65, v62
  v_pk_fma_f32 v[76:77], v[76:77], v[226:227], v[234:235]
  v_cvt_pk_bf16_f32 v62, v76, v77
  v_lshlrev_b32 v78, 16, v63
  v_and_b32 v79, s65, v63
  v_pk_fma_f32 v[78:79], v[78:79], v[226:227], v[234:235]
  v_cvt_pk_bf16_f32 v63, v78, v79
  ds_write_b128 v229, v[60:63] offset:28672
  buffer_load_dwordx4 v[208:211], v240, s[12:15], s60 offen
  buffer_load_dwordx4 v[212:215], v241, s[12:15], s60 offen
  buffer_load_dwordx4 v[216:219], v242, s[12:15], s60 offen
  buffer_load_dwordx4 v[220:223], v243, s[12:15], s60 offen
  s_add_u32 s60, s60, 262144
  s_cmp_eq_u32 s66, 1
  s_cbranch_scc0 L1_nopub
  s_waitcnt vmcnt(24)
  L1_nopub:
  s_waitcnt lgkmcnt(0)
  s_barrier
  s_cmp_eq_u32 s5, 0
  s_cselect_b32 s6, s66, 0
  s_cmp_eq_u32 s6, 1
  s_cbranch_scc0 L1_nopub2
  v_mov_b32 v225, 139264
  ds_read_b128 v[224:227], v225
  s_waitcnt lgkmcnt(0)
  v_max_u32 v224, v224, v225
  v_max_u32 v226, v226, v227
  v_max_u32 v224, v224, v226
  s_lshl_b32 s6, s4, 2
  v_mov_b32 v225, 0
  buffer_store_dword v224, v225, s[36:39], s6 offen sc1
  L1_nopub2:
  ds_read_b128 a[192:195], v244 offset:0
  ds_read_b128 a[196:199], v244 offset:1024
  ds_read_b128 a[200:203], v244 offset:2048
  ds_read_b128 a[204:207], v244 offset:3072
  s_waitcnt vmcnt(16)
  v_perm_b32 v224, v132, v128, s58
  v_perm_b32 v225, v140, v136, s58
  v_perm_b32 v226, v148, v144, s58
  v_perm_b32 v227, v156, v152, s58
  s_waitcnt lgkmcnt(0)
  s_nop 0
  v_mfma_f32_16x16x32_bf16 v[0:3], v[224:227], a[192:195], 0
  v_perm_b32 v228, v132, v128, s59
  v_perm_b32 v229, v140, v136, s59
  v_mfma_f32_16x16x32_bf16 v[32:35], v[224:227], a[196:199], 0
  v_perm_b32 v230, v148, v144, s59
  ds_read_b128 a[208:211], v244 offset:4096
  v_mfma_f32_16x16x32_bf16 v[64:67], v[224:227], a[200:203], 0
  v_perm_b32 v231, v156, v152, s59
  v_mfma_f32_16x16x32_bf16 v[96:99], v[224:227], a[204:207], 0
  s_nop 0
  v_mfma_f32_16x16x32_bf16 v[4:7], v[228:231], a[192:195], 0
  v_perm_b32 v224, v133, v129, s58
  v_perm_b32 v225, v141, v137, s58
  v_mfma_f32_16x16x32_bf16 v[36:39], v[228:231], a[196:199], 0
  v_perm_b32 v226, v149, v145, s58
  ds_read_b128 a[212:215], v244 offset:5120
  v_mfma_f32_16x16x32_bf16 v[68:71], v[228:231], a[200:203], 0
  v_perm_b32 v227, v157, v153, s58
  v_mfma_f32_16x16x32_bf16 v[100:103], v[228:231], a[204:207], 0
  s_nop 0
  v_mfma_f32_16x16x32_bf16 v[8:11], v[224:227], a[192:195], 0
  v_perm_b32 v228, v133, v129, s59
  v_perm_b32 v229, v141, v137, s59
  v_mfma_f32_16x16x32_bf16 v[40:43], v[224:227], a[196:199], 0
  v_perm_b32 v230, v149, v145, s59
  ds_read_b128 a[216:219], v244 offset:6144
  v_mfma_f32_16x16x32_bf16 v[72:75], v[224:227], a[200:203], 0
  v_perm_b32 v231, v157, v153, s59
  v_mfma_f32_16x16x32_bf16 v[104:107], v[224:227], a[204:207], 0
  s_nop 0
  v_mfma_f32_16x16x32_bf16 v[12:15], v[228:231], a[192:195], 0
  v_perm_b32 v224, v134, v130, s58
  v_perm_b32 v225, v142, v138, s58
  v_mfma_f32_16x16x32_bf16 v[44:47], v[228:231], a[196:199], 0
  v_perm_b32 v226, v150, v146, s58
  ds_read_b128 a[220:223], v244 offset:7168
  v_mfma_f32_16x16x32_bf16 v[76:79], v[228:231], a[200:203], 0
  v_perm_b32 v227, v158, v154, s58
  v_mfma_f32_16x16x32_bf16 v[108:111], v[228:231], a[204:207], 0
  s_nop 0
  v_mfma_f32_16x16x32_bf16 v[16:19], v[224:227], a[192:195], 0
  v_perm_b32 v228, v134, v130, s59
  v_perm_b32 v229, v142, v138, s59
  v_mfma_f32_16x16x32_bf16 v[48:51], v[224:227], a[196:199], 0
  v_perm_b32 v230, v150, v146, s59
  v_mfma_f32_16x16x32_bf16 v[80:83], v[224:227], a[200:203], 0
  v_perm_b32 v231, v158, v154, s59
  v_mfma_f32_16x16x32_bf16 v[112:115], v[224:227], a[204:207], 0
  s_nop 0
  v_mfma_f32_16x16x32_bf16 v[20:23], v[228:231], a[192:195], 0
  v_perm_b32 v224, v135, v131, s58
  v_perm_b32 v225, v143, v139, s58
  v_mfma_f32_16x16x32_bf16 v[52:55], v[228:231], a[196:199], 0
  v_perm_b32 v226, v151, v147, s58
  v_mfma_f32_16x16x32_bf16 v[84:87], v[228:231], a[200:203], 0
  v_perm_b32 v227, v159, v155, s58
  v_mfma_f32_16x16x32_bf16 v[116:119], v[228:231], a[204:207], 0
  s_nop 0
  v_mfma_f32_16x16x32_bf16 v[24:27], v[224:227], a[192:195], 0
  v_perm_b32 v228, v135, v131, s59
  v_perm_b32 v229, v143, v139, s59
  v_mfma_f32_16x16x32_bf16 v[56:59], v[224:227], a[196:199], 0
  v_perm_b32 v230, v151, v147, s59
  v_mfma_f32_16x16x32_bf16 v[88:91], v[224:227], a[200:203], 0
  v_perm_b32 v231, v159, v155, s59
  v_mfma_f32_16x16x32_bf16 v[120:123], v[224:227], a[204:207], 0
  s_nop 0
  v_mfma_f32_16x16x32_bf16 v[28:31], v[228:231], a[192:195], 0
  s_waitcnt vmcnt(12)
  v_perm_b32 v224, v164, v160, s58
  v_perm_b32 v225, v172, v168, s58
  v_mfma_f32_16x16x32_bf16 v[60:63], v[228:231], a[196:199], 0
  s_waitcnt vmcnt(8)
  v_perm_b32 v226, v180, v176, s58
  v_mfma_f32_16x16x32_bf16 v[92:95], v[228:231], a[200:203], 0
  v_perm_b32 v227, v188, v184, s58
  v_mfma_f32_16x16x32_bf16 v[124:127], v[228:231], a[204:207], 0
  buffer_load_dwordx4 v[128:131], v236, s[12:15], s60 offen
  s_waitcnt lgkmcnt(0)
  v_mfma_f32_16x16x32_bf16 v[0:3], v[224:227], a[208:211], v[0:3]
  v_perm_b32 v228, v164, v160, s59
  v_perm_b32 v229, v172, v168, s59
  v_mfma_f32_16x16x32_bf16 v[32:35], v[224:227], a[212:215], v[32:35]
  v_perm_b32 v230, v180, v176, s59
  ds_read_b128 a[192:195], v244 offset:8192
  v_mfma_f32_16x16x32_bf16 v[64:67], v[224:227], a[216:219], v[64:67]
  v_perm_b32 v231, v188, v184, s59
  v_mfma_f32_16x16x32_bf16 v[96:99], v[224:227], a[220:223], v[96:99]
  buffer_load_dwordx4 v[132:135], v237, s[12:15], s60 offen
  v_mfma_f32_16x16x32_bf16 v[4:7], v[228:231], a[208:211], v[4:7]
  v_perm_b32 v224, v165, v161, s58
  v_perm_b32 v225, v173, v169, s58
  v_mfma_f32_16x16x32_bf16 v[36:39], v[228:231], a[212:215], v[36:39]
  v_perm_b32 v226, v181, v177, s58
  ds_read_b128 a[196:199], v244 offset:9216
  v_mfma_f32_16x16x32_bf16 v[68:71], v[228:231], a[216:219], v[68:71]
  v_perm_b32 v227, v189, v185, s58
  v_mfma_f32_16x16x32_bf16 v[100:103], v[228:231], a[220:223], v[100:103]
  buffer_load_dwordx4 v[136:139], v238, s[12:15], s60 offen
  v_mfma_f32_16x16x32_bf16 v[8:11], v[224:227], a[208:211], v[8:11]
  v_perm_b32 v228, v165, v161, s59
  v_perm_b32 v229, v173, v169, s59
  v_mfma_f32_16x16x32_bf16 v[40:43], v[224:227], a[212:215], v[40:43]
  v_perm_b32 v230, v181, v177, s59
  ds_read_b128 a[200:203], v244 offset:10240
  v_mfma_f32_16x16x32_bf16 v[72:75], v[224:227], a[216:219], v[72:75]
  v_perm_b32 v231, v189, v185, s59
  v_mfma_f32_16x16x32_bf16 v[104:107], v[224:227], a[220:223], v[104:107]
  buffer_load_dwordx4 v[140:143], v239, s[12:15], s60 offen
  v_mfma_f32_16x16x32_bf16 v[12:15], v[228:231], a[208:211], v[12:15]
  v_perm_b32 v224, v166, v162, s58
  v_perm_b32 v225, v174, v170, s58
  v_mfma_f32_16x16x32_bf16 v[44:47], v[228:231], a[212:215], v[44:47]
  v_perm_b32 v226, v182, v178, s58
  ds_read_b128 a[204:207], v244 offset:11264
  v_mfma_f32_16x16x32_bf16 v[76:79], v[228:231], a[216:219], v[76:79]
  v_perm_b32 v227, v190, v186, s58
  v_mfma_f32_16x16x32_bf16 v[108:111], v[228:231], a[220:223], v[108:111]
  buffer_load_dwordx4 v[144:147], v240, s[12:15], s60 offen
  v_mfma_f32_16x16x32_bf16 v[16:19], v[224:227], a[208:211], v[16:19]
  v_perm_b32 v228, v166, v162, s59
  v_perm_b32 v229, v174, v170, s59
  v_mfma_f32_16x16x32_bf16 v[48:51], v[224:227], a[212:215], v[48:51]
  v_perm_b32 v230, v182, v178, s59
  v_mfma_f32_16x16x32_bf16 v[80:83], v[224:227], a[216:219], v[80:83]
  v_perm_b32 v231, v190, v186, s59
  v_mfma_f32_16x16x32_bf16 v[112:115], v[224:227], a[220:223], v[112:115]
  buffer_load_dwordx4 v[148:151], v241, s[12:15], s60 offen
  v_mfma_f32_16x16x32_bf16 v[20:23], v[228:231], a[208:211], v[20:23]
  v_perm_b32 v224, v167, v163, s58
  v_perm_b32 v225, v175, v171, s58
  v_mfma_f32_16x16x32_bf16 v[52:55], v[228:231], a[212:215], v[52:55]
  v_perm_b32 v226, v183, v179, s58
  v_mfma_f32_16x16x32_bf16 v[84:87], v[228:231], a[216:219], v[84:87]
  v_perm_b32 v227, v191, v187, s58
  v_mfma_f32_16x16x32_bf16 v[116:119], v[228:231], a[220:223], v[116:119]
  buffer_load_dwordx4 v[152:155], v242, s[12:15], s60 offen
  v_mfma_f32_16x16x32_bf16 v[24:27], v[224:227], a[208:211], v[24:27]
  v_perm_b32 v228, v167, v163, s59
  v_perm_b32 v229, v175, v171, s59
  v_mfma_f32_16x16x32_bf16 v[56:59], v[224:227], a[212:215], v[56:59]
  v_perm_b32 v230, v183, v179, s59
  v_mfma_f32_16x16x32_bf16 v[88:91], v[224:227], a[216:219], v[88:91]
  v_perm_b32 v231, v191, v187, s59
  v_mfma_f32_16x16x32_bf16 v[120:123], v[224:227], a[220:223], v[120:123]
  buffer_load_dwordx4 v[156:159], v243, s[12:15], s60 offen
  s_add_u32 s60, s60, 262144
  v_mfma_f32_16x16x32_bf16 v[28:31], v[228:231], a[208:211], v[28:31]
  s_waitcnt vmcnt(12)
  v_perm_b32 v224, v196, v192, s58
  v_perm_b32 v225, v204, v200, s58
  v_mfma_f32_16x16x32_bf16 v[60:63], v[228:231], a[212:215], v[60:63]
  s_waitcnt vmcnt(8)
  v_perm_b32 v226, v212, v208, s58
  v_mfma_f32_16x16x32_bf16 v[92:95], v[228:231], a[216:219], v[92:95]
  v_perm_b32 v227, v220, v216, s58
  v_mfma_f32_16x16x32_bf16 v[124:127], v[228:231], a[220:223], v[124:127]
  buffer_load_dwordx4 v[160:163], v236, s[12:15], s60 offen
  s_waitcnt lgkmcnt(0)
  v_mfma_f32_16x16x32_bf16 v[0:3], v[224:227], a[192:195], v[0:3]
  v_perm_b32 v228, v196, v192, s59
  v_perm_b32 v229, v204, v200, s59
  v_mfma_f32_16x16x32_bf16 v[32:35], v[224:227], a[196:199], v[32:35]
  v_perm_b32 v230, v212, v208, s59
  ds_read_b128 a[208:211], v244 offset:12288
  v_mfma_f32_16x16x32_bf16 v[64:67], v[224:227], a[200:203], v[64:67]
  v_perm_b32 v231, v220, v216, s59
  v_mfma_f32_16x16x32_bf16 v[96:99], v[224:227], a[204:207], v[96:99]
  buffer_load_dwordx4 v[164:167], v237, s[12:15], s60 offen
  v_mfma_f32_16x16x32_bf16 v[4:7], v[228:231], a[192:195], v[4:7]
  v_perm_b32 v224, v197, v193, s58
  v_perm_b32 v225, v205, v201, s58
  v_mfma_f32_16x16x32_bf16 v[36:39], v[228:231], a[196:199], v[36:39]
  v_perm_b32 v226, v213, v209, s58
  ds_read_b128 a[212:215], v244 offset:13312
  v_mfma_f32_16x16x32_bf16 v[68:71], v[228:231], a[200:203], v[68:71]
  v_perm_b32 v227, v221, v217, s58
  v_mfma_f32_16x16x32_bf16 v[100:103], v[228:231], a[204:207], v[100:103]
  buffer_load_dwordx4 v[168:171], v238, s[12:15], s60 offen
  v_mfma_f32_16x16x32_bf16 v[8:11], v[224:227], a[192:195], v[8:11]
  v_perm_b32 v228, v197, v193, s59
  v_perm_b32 v229, v205, v201, s59
  v_mfma_f32_16x16x32_bf16 v[40:43], v[224:227], a[196:199], v[40:43]
  v_perm_b32 v230, v213, v209, s59
  ds_read_b128 a[216:219], v244 offset:14336
  v_mfma_f32_16x16x32_bf16 v[72:75], v[224:227], a[200:203], v[72:75]
  v_perm_b32 v231, v221, v217, s59
  v_mfma_f32_16x16x32_bf16 v[104:107], v[224:227], a[204:207], v[104:107]
  buffer_load_dwordx4 v[172:175], v239, s[12:15], s60 offen
  v_mfma_f32_16x16x32_bf16 v[12:15], v[228:231], a[192:195], v[12:15]
  v_perm_b32 v224, v198, v194, s58
  v_perm_b32 v225, v206, v202, s58
  v_mfma_f32_16x16x32_bf16 v[44:47], v[228:231], a[196:199], v[44:47]
  v_perm_b32 v226, v214, v210, s58
  ds_read_b128 a[220:223], v244 offset:15360
  v_mfma_f32_16x16x32_bf16 v[76:79], v[228:231], a[200:203], v[76:79]
  v_perm_b32 v227, v222, v218, s58
  v_mfma_f32_16x16x32_bf16 v[108:111], v[228:231], a[204:207], v[108:111]
  buffer_load_dwordx4 v[176:179], v240, s[12:15], s60 offen
  v_mfma_f32_16x16x32_bf16 v[16:19], v[224:227], a[192:195], v[16:19]
  v_perm_b32 v228, v198, v194, s59
  v_perm_b32 v229, v206, v202, s59
  v_mfma_f32_16x16x32_bf16 v[48:51], v[224:227], a[196:199], v[48:51]
  v_perm_b32 v230, v214, v210, s59
  v_mfma_f32_16x16x32_bf16 v[80:83], v[224:227], a[200:203], v[80:83]
  v_perm_b32 v231, v222, v218, s59
  v_mfma_f32_16x16x32_bf16 v[112:115], v[224:227], a[204:207], v[112:115]
  buffer_load_dwordx4 v[180:183], v241, s[12:15], s60 offen
  v_mfma_f32_16x16x32_bf16 v[20:23], v[228:231], a[192:195], v[20:23]
  v_perm_b32 v224, v199, v195, s58
  v_perm_b32 v225, v207, v203, s58
  v_mfma_f32_16x16x32_bf16 v[52:55], v[228:231], a[196:199], v[52:55]
  v_perm_b32 v226, v215, v211, s58
  v_mfma_f32_16x16x32_bf16 v[84:87], v[228:231], a[200:203], v[84:87]
  v_perm_b32 v227, v223, v219, s58
  v_mfma_f32_16x16x32_bf16 v[116:119], v[228:231], a[204:207], v[116:119]
  buffer_load_dwordx4 v[184:187], v242, s[12:15], s60 offen
  v_mfma_f32_16x16x32_bf16 v[24:27], v[224:227], a[192:195], v[24:27]
  v_perm_b32 v228, v199, v195, s59
  v_perm_b32 v229, v207, v203, s59
  v_mfma_f32_16x16x32_bf16 v[56:59], v[224:227], a[196:199], v[56:59]
  v_perm_b32 v230, v215, v211, s59
  v_mfma_f32_16x16x32_bf16 v[88:91], v[224:227], a[200:203], v[88:91]
  v_perm_b32 v231, v223, v219, s59
  v_mfma_f32_16x16x32_bf16 v[120:123], v[224:227], a[204:207], v[120:123]
  buffer_load_dwordx4 v[188:191], v243, s[12:15], s60 offen
  s_add_u32 s60, s60, 262144
  v_mfma_f32_16x16x32_bf16 v[28:31], v[228:231], a[192:195], v[28:31]
  s_waitcnt vmcnt(12)
  v_perm_b32 v224, v132, v128, s58
  v_perm_b32 v225, v140, v136, s58
  v_mfma_f32_16x16x32_bf16 v[60:63], v[228:231], a[196:199], v[60:63]
  s_waitcnt vmcnt(8)
  v_perm_b32 v226, v148, v144, s58
  v_mfma_f32_16x16x32_bf16 v[92:95], v[228:231], a[200:203], v[92:95]
  v_perm_b32 v227, v156, v152, s58
  v_mfma_f32_16x16x32_bf16 v[124:127], v[228:231], a[204:207], v[124:127]
  buffer_load_dwordx4 v[192:195], v236, s[12:15], s60 offen
  s_waitcnt lgkmcnt(0)
  v_mfma_f32_16x16x32_bf16 v[0:3], v[224:227], a[208:211], v[0:3]
  v_perm_b32 v228, v132, v128, s59
  v_perm_b32 v229, v140, v136, s59
  v_mfma_f32_16x16x32_bf16 v[32:35], v[224:227], a[212:215], v[32:35]
  v_perm_b32 v230, v148, v144, s59
  ds_read_b128 a[192:195], v244 offset:16384
  v_mfma_f32_16x16x32_bf16 v[64:67], v[224:227], a[216:219], v[64:67]
  v_perm_b32 v231, v156, v152, s59
  v_mfma_f32_16x16x32_bf16 v[96:99], v[224:227], a[220:223], v[96:99]
  buffer_load_dwordx4 v[196:199], v237, s[12:15], s60 offen
  v_mfma_f32_16x16x32_bf16 v[4:7], v[228:231], a[208:211], v[4:7]
  v_perm_b32 v224, v133, v129, s58
  v_perm_b32 v225, v141, v137, s58
  v_mfma_f32_16x16x32_bf16 v[36:39], v[228:231], a[212:215], v[36:39]
  v_perm_b32 v226, v149, v145, s58
  ds_read_b128 a[196:199], v244 offset:17408
  v_mfma_f32_16x16x32_bf16 v[68:71], v[228:231], a[216:219], v[68:71]
  v_perm_b32 v227, v157, v153, s58
  v_mfma_f32_16x16x32_bf16 v[100:103], v[228:231], a[220:223], v[100:103]
  buffer_load_dwordx4 v[200:203], v238, s[12:15], s60 offen
  v_mfma_f32_16x16x32_bf16 v[8:11], v[224:227], a[208:211], v[8:11]
  v_perm_b32 v228, v133, v129, s59
  v_perm_b32 v229, v141, v137, s59
  v_mfma_f32_16x16x32_bf16 v[40:43], v[224:227], a[212:215], v[40:43]
  v_perm_b32 v230, v149, v145, s59
  ds_read_b128 a[200:203], v244 offset:18432
  v_mfma_f32_16x16x32_bf16 v[72:75], v[224:227], a[216:219], v[72:75]
  v_perm_b32 v231, v157, v153, s59
  v_mfma_f32_16x16x32_bf16 v[104:107], v[224:227], a[220:223], v[104:107]
  buffer_load_dwordx4 v[204:207], v239, s[12:15], s60 offen
  v_mfma_f32_16x16x32_bf16 v[12:15], v[228:231], a[208:211], v[12:15]
  v_perm_b32 v224, v134, v130, s58
  v_perm_b32 v225, v142, v138, s58
  v_mfma_f32_16x16x32_bf16 v[44:47], v[228:231], a[212:215], v[44:47]
  v_perm_b32 v226, v150, v146, s58
  ds_read_b128 a[204:207], v244 offset:19456
  v_mfma_f32_16x16x32_bf16 v[76:79], v[228:231], a[216:219], v[76:79]
  v_perm_b32 v227, v158, v154, s58
  v_mfma_f32_16x16x32_bf16 v[108:111], v[228:231], a[220:223], v[108:111]
  buffer_load_dwordx4 v[208:211], v240, s[12:15], s60 offen
  v_mfma_f32_16x16x32_bf16 v[16:19], v[224:227], a[208:211], v[16:19]
  v_perm_b32 v228, v134, v130, s59
  v_perm_b32 v229, v142, v138, s59
  v_mfma_f32_16x16x32_bf16 v[48:51], v[224:227], a[212:215], v[48:51]
  v_perm_b32 v230, v150, v146, s59
  v_mfma_f32_16x16x32_bf16 v[80:83], v[224:227], a[216:219], v[80:83]
  v_perm_b32 v231, v158, v154, s59
  v_mfma_f32_16x16x32_bf16 v[112:115], v[224:227], a[220:223], v[112:115]
  buffer_load_dwordx4 v[212:215], v241, s[12:15], s60 offen
  v_mfma_f32_16x16x32_bf16 v[20:23], v[228:231], a[208:211], v[20:23]
  v_perm_b32 v224, v135, v131, s58
  v_perm_b32 v225, v143, v139, s58
  v_mfma_f32_16x16x32_bf16 v[52:55], v[228:231], a[212:215], v[52:55]
  v_perm_b32 v226, v151, v147, s58
  v_mfma_f32_16x16x32_bf16 v[84:87], v[228:231], a[216:219], v[84:87]
  v_perm_b32 v227, v159, v155, s58
  v_mfma_f32_16x16x32_bf16 v[116:119], v[228:231], a[220:223], v[116:119]
  buffer_load_dwordx4 v[216:219], v242, s[12:15], s60 offen
  v_mfma_f32_16x16x32_bf16 v[24:27], v[224:227], a[208:211], v[24:27]
  v_perm_b32 v228, v135, v131, s59
  v_perm_b32 v229, v143, v139, s59
  v_mfma_f32_16x16x32_bf16 v[56:59], v[224:227], a[212:215], v[56:59]
  v_perm_b32 v230, v151, v147, s59
  v_mfma_f32_16x16x32_bf16 v[88:91], v[224:227], a[216:219], v[88:91]
  v_perm_b32 v231, v159, v155, s59
  v_mfma_f32_16x16x32_bf16 v[120:123], v[224:227], a[220:223], v[120:123]
  buffer_load_dwordx4 v[220:223], v243, s[12:15], s60 offen
  s_add_u32 s60, s60, 262144
  v_mfma_f32_16x16x32_bf16 v[28:31], v[228:231], a[208:211], v[28:31]
  s_waitcnt vmcnt(12)
  v_perm_b32 v224, v164, v160, s58
  v_perm_b32 v225, v172, v168, s58
  v_mfma_f32_16x16x32_bf16 v[60:63], v[228:231], a[212:215], v[60:63]
  s_waitcnt vmcnt(8)
  v_perm_b32 v226, v180, v176, s58
  v_mfma_f32_16x16x32_bf16 v[92:95], v[228:231], a[216:219], v[92:95]
  v_perm_b32 v227, v188, v184, s58
  v_mfma_f32_16x16x32_bf16 v[124:127], v[228:231], a[220:223], v[124:127]
  buffer_load_dwordx4 v[128:131], v236, s[12:15], s60 offen
  s_waitcnt lgkmcnt(0)
  v_mfma_f32_16x16x32_bf16 v[0:3], v[224:227], a[192:195], v[0:3]
  v_perm_b32 v228, v164, v160, s59
  v_perm_b32 v229, v172, v168, s59
  v_mfma_f32_16x16x32_bf16 v[32:35], v[224:227], a[196:199], v[32:35]
  v_perm_b32 v230, v180, v176, s59
  ds_read_b128 a[208:211], v244 offset:20480
  v_mfma_f32_16x16x32_bf16 v[64:67], v[224:227], a[200:203], v[64:67]
  v_perm_b32 v231, v188, v184, s59
  v_mfma_f32_16x16x32_bf16 v[96:99], v[224:227], a[204:207], v[96:99]
  buffer_load_dwordx4 v[132:135], v237, s[12:15], s60 offen
  v_mfma_f32_16x16x32_bf16 v[4:7], v[228:231], a[192:195], v[4:7]
  v_perm_b32 v224, v165, v161, s58
  v_perm_b32 v225, v173, v169, s58
  v_mfma_f32_16x16x32_bf16 v[36:39], v[228:231], a[196:199], v[36:39]
  v_perm_b32 v226, v181, v177, s58
  ds_read_b128 a[212:215], v244 offset:21504
  v_mfma_f32_16x16x32_bf16 v[68:71], v[228:231], a[200:203], v[68:71]
  v_perm_b32 v227, v189, v185, s58
  v_mfma_f32_16x16x32_bf16 v[100:103], v[228:231], a[204:207], v[100:103]
  buffer_load_dwordx4 v[136:139], v238, s[12:15], s60 offen
  v_mfma_f32_16x16x32_bf16 v[8:11], v[224:227], a[192:195], v[8:11]
  v_perm_b32 v228, v165, v161, s59
  v_perm_b32 v229, v173, v169, s59
  v_mfma_f32_16x16x32_bf16 v[40:43], v[224:227], a[196:199], v[40:43]
  v_perm_b32 v230, v181, v177, s59
  ds_read_b128 a[216:219], v244 offset:22528
  v_mfma_f32_16x16x32_bf16 v[72:75], v[224:227], a[200:203], v[72:75]
  v_perm_b32 v231, v189, v185, s59
  v_mfma_f32_16x16x32_bf16 v[104:107], v[224:227], a[204:207], v[104:107]
  buffer_load_dwordx4 v[140:143], v239, s[12:15], s60 offen
  v_mfma_f32_16x16x32_bf16 v[12:15], v[228:231], a[192:195], v[12:15]
  v_perm_b32 v224, v166, v162, s58
  v_perm_b32 v225, v174, v170, s58
  v_mfma_f32_16x16x32_bf16 v[44:47], v[228:231], a[196:199], v[44:47]
  v_perm_b32 v226, v182, v178, s58
  ds_read_b128 a[220:223], v244 offset:23552
  v_mfma_f32_16x16x32_bf16 v[76:79], v[228:231], a[200:203], v[76:79]
  v_perm_b32 v227, v190, v186, s58
  v_mfma_f32_16x16x32_bf16 v[108:111], v[228:231], a[204:207], v[108:111]
  buffer_load_dwordx4 v[144:147], v240, s[12:15], s60 offen
  v_mfma_f32_16x16x32_bf16 v[16:19], v[224:227], a[192:195], v[16:19]
  v_perm_b32 v228, v166, v162, s59
  v_perm_b32 v229, v174, v170, s59
  v_mfma_f32_16x16x32_bf16 v[48:51], v[224:227], a[196:199], v[48:51]
  v_perm_b32 v230, v182, v178, s59
  v_mfma_f32_16x16x32_bf16 v[80:83], v[224:227], a[200:203], v[80:83]
  v_perm_b32 v231, v190, v186, s59
  v_mfma_f32_16x16x32_bf16 v[112:115], v[224:227], a[204:207], v[112:115]
  buffer_load_dwordx4 v[148:151], v241, s[12:15], s60 offen
  v_mfma_f32_16x16x32_bf16 v[20:23], v[228:231], a[192:195], v[20:23]
  v_perm_b32 v224, v167, v163, s58
  v_perm_b32 v225, v175, v171, s58
  v_mfma_f32_16x16x32_bf16 v[52:55], v[228:231], a[196:199], v[52:55]
  v_perm_b32 v226, v183, v179, s58
  v_mfma_f32_16x16x32_bf16 v[84:87], v[228:231], a[200:203], v[84:87]
  v_perm_b32 v227, v191, v187, s58
  v_mfma_f32_16x16x32_bf16 v[116:119], v[228:231], a[204:207], v[116:119]
  buffer_load_dwordx4 v[152:155], v242, s[12:15], s60 offen
  v_mfma_f32_16x16x32_bf16 v[24:27], v[224:227], a[192:195], v[24:27]
  v_perm_b32 v228, v167, v163, s59
  v_perm_b32 v229, v175, v171, s59
  v_mfma_f32_16x16x32_bf16 v[56:59], v[224:227], a[196:199], v[56:59]
  v_perm_b32 v230, v183, v179, s59
  v_mfma_f32_16x16x32_bf16 v[88:91], v[224:227], a[200:203], v[88:91]
  v_perm_b32 v231, v191, v187, s59
  v_mfma_f32_16x16x32_bf16 v[120:123], v[224:227], a[204:207], v[120:123]
  buffer_load_dwordx4 v[156:159], v243, s[12:15], s60 offen
  s_add_u32 s60, s60, 262144
  v_mfma_f32_16x16x32_bf16 v[28:31], v[228:231], a[192:195], v[28:31]
  s_waitcnt vmcnt(12)
  v_perm_b32 v224, v196, v192, s58
  v_perm_b32 v225, v204, v200, s58
  v_mfma_f32_16x16x32_bf16 v[60:63], v[228:231], a[196:199], v[60:63]
  s_waitcnt vmcnt(8)
  v_perm_b32 v226, v212, v208, s58
  v_mfma_f32_16x16x32_bf16 v[92:95], v[228:231], a[200:203], v[92:95]
  v_perm_b32 v227, v220, v216, s58
  v_mfma_f32_16x16x32_bf16 v[124:127], v[228:231], a[204:207], v[124:127]
  buffer_load_dwordx4 v[160:163], v236, s[12:15], s60 offen
  s_waitcnt lgkmcnt(0)
  v_mfma_f32_16x16x32_bf16 v[0:3], v[224:227], a[208:211], v[0:3]
  v_perm_b32 v228, v196, v192, s59
  v_perm_b32 v229, v204, v200, s59
  v_mfma_f32_16x16x32_bf16 v[32:35], v[224:227], a[212:215], v[32:35]
  v_perm_b32 v230, v212, v208, s59
  ds_read_b128 a[192:195], v244 offset:24576
  v_mfma_f32_16x16x32_bf16 v[64:67], v[224:227], a[216:219], v[64:67]
  v_perm_b32 v231, v220, v216, s59
  v_mfma_f32_16x16x32_bf16 v[96:99], v[224:227], a[220:223], v[96:99]
  buffer_load_dwordx4 v[164:167], v237, s[12:15], s60 offen
  v_mfma_f32_16x16x32_bf16 v[4:7], v[228:231], a[208:211], v[4:7]
  v_perm_b32 v224, v197, v193, s58
  v_perm_b32 v225, v205, v201, s58
  v_mfma_f32_16x16x32_bf16 v[36:39], v[228:231], a[212:215], v[36:39]
  v_perm_b32 v226, v213, v209, s58
  ds_read_b128 a[196:199], v244 offset:25600
  v_mfma_f32_16x16x32_bf16 v[68:71], v[228:231], a[216:219], v[68:71]
  v_perm_b32 v227, v221, v217, s58
  v_mfma_f32_16x16x32_bf16 v[100:103], v[228:231], a[220:223], v[100:103]
  buffer_load_dwordx4 v[168:171], v238, s[12:15], s60 offen
  v_mfma_f32_16x16x32_bf16 v[8:11], v[224:227], a[208:211], v[8:11]
  v_perm_b32 v228, v197, v193, s59
  v_perm_b32 v229, v205, v201, s59
  v_mfma_f32_16x16x32_bf16 v[40:43], v[224:227], a[212:215], v[40:43]
  v_perm_b32 v230, v213, v209, s59
  ds_read_b128 a[200:203], v244 offset:26624
  v_mfma_f32_16x16x32_bf16 v[72:75], v[224:227], a[216:219], v[72:75]
  v_perm_b32 v231, v221, v217, s59
  v_mfma_f32_16x16x32_bf16 v[104:107], v[224:227], a[220:223], v[104:107]
  buffer_load_dwordx4 v[172:175], v239, s[12:15], s60 offen
  v_mfma_f32_16x16x32_bf16 v[12:15], v[228:231], a[208:211], v[12:15]
  v_perm_b32 v224, v198, v194, s58
  v_perm_b32 v225, v206, v202, s58
  v_mfma_f32_16x16x32_bf16 v[44:47], v[228:231], a[212:215], v[44:47]
  v_perm_b32 v226, v214, v210, s58
  ds_read_b128 a[204:207], v244 offset:27648
  v_mfma_f32_16x16x32_bf16 v[76:79], v[228:231], a[216:219], v[76:79]
  v_perm_b32 v227, v222, v218, s58
  v_mfma_f32_16x16x32_bf16 v[108:111], v[228:231], a[220:223], v[108:111]
  buffer_load_dwordx4 v[176:179], v240, s[12:15], s60 offen
  v_mfma_f32_16x16x32_bf16 v[16:19], v[224:227], a[208:211], v[16:19]
  v_perm_b32 v228, v198, v194, s59
  v_perm_b32 v229, v206, v202, s59
  v_mfma_f32_16x16x32_bf16 v[48:51], v[224:227], a[212:215], v[48:51]
  v_perm_b32 v230, v214, v210, s59
  v_mfma_f32_16x16x32_bf16 v[80:83], v[224:227], a[216:219], v[80:83]
  v_perm_b32 v231, v222, v218, s59
  v_mfma_f32_16x16x32_bf16 v[112:115], v[224:227], a[220:223], v[112:115]
  buffer_load_dwordx4 v[180:183], v241, s[12:15], s60 offen
  v_mfma_f32_16x16x32_bf16 v[20:23], v[228:231], a[208:211], v[20:23]
  v_perm_b32 v224, v199, v195, s58
  v_perm_b32 v225, v207, v203, s58
  v_mfma_f32_16x16x32_bf16 v[52:55], v[228:231], a[212:215], v[52:55]
  v_perm_b32 v226, v215, v211, s58
  v_mfma_f32_16x16x32_bf16 v[84:87], v[228:231], a[216:219], v[84:87]
  v_perm_b32 v227, v223, v219, s58
  v_mfma_f32_16x16x32_bf16 v[116:119], v[228:231], a[220:223], v[116:119]
  buffer_load_dwordx4 v[184:187], v242, s[12:15], s60 offen
  v_mfma_f32_16x16x32_bf16 v[24:27], v[224:227], a[208:211], v[24:27]
  v_perm_b32 v228, v199, v195, s59
  v_perm_b32 v229, v207, v203, s59
  v_mfma_f32_16x16x32_bf16 v[56:59], v[224:227], a[212:215], v[56:59]
  v_perm_b32 v230, v215, v211, s59
  v_mfma_f32_16x16x32_bf16 v[88:91], v[224:227], a[216:219], v[88:91]
  v_perm_b32 v231, v223, v219, s59
  v_mfma_f32_16x16x32_bf16 v[120:123], v[224:227], a[220:223], v[120:123]
  buffer_load_dwordx4 v[188:191], v243, s[12:15], s60 offen
  s_add_u32 s60, s60, 262144
  v_mfma_f32_16x16x32_bf16 v[28:31], v[228:231], a[208:211], v[28:31]
  s_waitcnt vmcnt(12)
  v_perm_b32 v224, v132, v128, s58
  v_perm_b32 v225, v140, v136, s58
  v_mfma_f32_16x16x32_bf16 v[60:63], v[228:231], a[212:215], v[60:63]
  s_waitcnt vmcnt(8)
  v_perm_b32 v226, v148, v144, s58
  v_mfma_f32_16x16x32_bf16 v[92:95], v[228:231], a[216:219], v[92:95]
  v_perm_b32 v227, v156, v152, s58
  v_mfma_f32_16x16x32_bf16 v[124:127], v[228:231], a[220:223], v[124:127]
  buffer_load_dwordx4 v[192:195], v236, s[12:15], s60 offen
  s_waitcnt lgkmcnt(0)
  v_mfma_f32_16x16x32_bf16 v[0:3], v[224:227], a[192:195], v[0:3]
  v_perm_b32 v228, v132, v128, s59
  v_perm_b32 v229, v140, v136, s59
  v_mfma_f32_16x16x32_bf16 v[32:35], v[224:227], a[196:199], v[32:35]
  v_perm_b32 v230, v148, v144, s59
  ds_read_b128 a[208:211], v244 offset:28672
  v_mfma_f32_16x16x32_bf16 v[64:67], v[224:227], a[200:203], v[64:67]
  v_perm_b32 v231, v156, v152, s59
  v_mfma_f32_16x16x32_bf16 v[96:99], v[224:227], a[204:207], v[96:99]
  buffer_load_dwordx4 v[196:199], v237, s[12:15], s60 offen
  v_mfma_f32_16x16x32_bf16 v[4:7], v[228:231], a[192:195], v[4:7]
  v_perm_b32 v224, v133, v129, s58
  v_perm_b32 v225, v141, v137, s58
  v_mfma_f32_16x16x32_bf16 v[36:39], v[228:231], a[196:199], v[36:39]
  v_perm_b32 v226, v149, v145, s58
  ds_read_b128 a[212:215], v244 offset:29696
  v_mfma_f32_16x16x32_bf16 v[68:71], v[228:231], a[200:203], v[68:71]
  v_perm_b32 v227, v157, v153, s58
  v_mfma_f32_16x16x32_bf16 v[100:103], v[228:231], a[204:207], v[100:103]
  buffer_load_dwordx4 v[200:203], v238, s[12:15], s60 offen
  v_mfma_f32_16x16x32_bf16 v[8:11], v[224:227], a[192:195], v[8:11]
  v_perm_b32 v228, v133, v129, s59
  v_perm_b32 v229, v141, v137, s59
  v_mfma_f32_16x16x32_bf16 v[40:43], v[224:227], a[196:199], v[40:43]
  v_perm_b32 v230, v149, v145, s59
  ds_read_b128 a[216:219], v244 offset:30720
  v_mfma_f32_16x16x32_bf16 v[72:75], v[224:227], a[200:203], v[72:75]
  v_perm_b32 v231, v157, v153, s59
  v_mfma_f32_16x16x32_bf16 v[104:107], v[224:227], a[204:207], v[104:107]
  buffer_load_dwordx4 v[204:207], v239, s[12:15], s60 offen
  v_mfma_f32_16x16x32_bf16 v[12:15], v[228:231], a[192:195], v[12:15]
  v_perm_b32 v224, v134, v130, s58
  v_perm_b32 v225, v142, v138, s58
  v_mfma_f32_16x16x32_bf16 v[44:47], v[228:231], a[196:199], v[44:47]
  v_perm_b32 v226, v150, v146, s58
  ds_read_b128 a[220:223], v244 offset:31744
  v_mfma_f32_16x16x32_bf16 v[76:79], v[228:231], a[200:203], v[76:79]
  v_perm_b32 v227, v158, v154, s58
  v_mfma_f32_16x16x32_bf16 v[108:111], v[228:231], a[204:207], v[108:111]
  buffer_load_dwordx4 v[208:211], v240, s[12:15], s60 offen
  v_mfma_f32_16x16x32_bf16 v[16:19], v[224:227], a[192:195], v[16:19]
  v_perm_b32 v228, v134, v130, s59
  v_perm_b32 v229, v142, v138, s59
  v_mfma_f32_16x16x32_bf16 v[48:51], v[224:227], a[196:199], v[48:51]
  v_perm_b32 v230, v150, v146, s59
  v_mfma_f32_16x16x32_bf16 v[80:83], v[224:227], a[200:203], v[80:83]
  v_perm_b32 v231, v158, v154, s59
  v_mfma_f32_16x16x32_bf16 v[112:115], v[224:227], a[204:207], v[112:115]
  buffer_load_dwordx4 v[212:215], v241, s[12:15], s60 offen
  v_mfma_f32_16x16x32_bf16 v[20:23], v[228:231], a[192:195], v[20:23]
  v_perm_b32 v224, v135, v131, s58
  v_perm_b32 v225, v143, v139, s58
  v_mfma_f32_16x16x32_bf16 v[52:55], v[228:231], a[196:199], v[52:55]
  v_perm_b32 v226, v151, v147, s58
  v_mfma_f32_16x16x32_bf16 v[84:87], v[228:231], a[200:203], v[84:87]
  v_perm_b32 v227, v159, v155, s58
  v_mfma_f32_16x16x32_bf16 v[116:119], v[228:231], a[204:207], v[116:119]
  buffer_load_dwordx4 v[216:219], v242, s[12:15], s60 offen
  v_mfma_f32_16x16x32_bf16 v[24:27], v[224:227], a[192:195], v[24:27]
  v_perm_b32 v228, v135, v131, s59
  v_perm_b32 v229, v143, v139, s59
  v_mfma_f32_16x16x32_bf16 v[56:59], v[224:227], a[196:199], v[56:59]
  v_perm_b32 v230, v151, v147, s59
  v_mfma_f32_16x16x32_bf16 v[88:91], v[224:227], a[200:203], v[88:91]
  v_perm_b32 v231, v159, v155, s59
  v_mfma_f32_16x16x32_bf16 v[120:123], v[224:227], a[204:207], v[120:123]
  buffer_load_dwordx4 v[220:223], v243, s[12:15], s60 offen
  s_add_u32 s60, s60, 262144
  v_mfma_f32_16x16x32_bf16 v[28:31], v[228:231], a[192:195], v[28:31]
  s_waitcnt vmcnt(12)
  v_perm_b32 v224, v164, v160, s58
  v_perm_b32 v225, v172, v168, s58
  v_mfma_f32_16x16x32_bf16 v[60:63], v[228:231], a[196:199], v[60:63]
  s_waitcnt vmcnt(8)
  v_perm_b32 v226, v180, v176, s58
  v_mfma_f32_16x16x32_bf16 v[92:95], v[228:231], a[200:203], v[92:95]
  v_perm_b32 v227, v188, v184, s58
  v_mfma_f32_16x16x32_bf16 v[124:127], v[228:231], a[204:207], v[124:127]
  buffer_load_dwordx4 v[128:131], v236, s[12:15], s60 offen
  s_waitcnt lgkmcnt(0)
  v_mfma_f32_16x16x32_bf16 v[0:3], v[224:227], a[208:211], v[0:3]
  v_perm_b32 v228, v164, v160, s59
  v_perm_b32 v229, v172, v168, s59
  v_mfma_f32_16x16x32_bf16 v[32:35], v[224:227], a[212:215], v[32:35]
  v_perm_b32 v230, v180, v176, s59
  ds_read_b128 a[192:195], v245 offset:0
  v_mfma_f32_16x16x32_bf16 v[64:67], v[224:227], a[216:219], v[64:67]
  v_perm_b32 v231, v188, v184, s59
  v_mfma_f32_16x16x32_bf16 v[96:99], v[224:227], a[220:223], v[96:99]
  buffer_load_dwordx4 v[132:135], v237, s[12:15], s60 offen
  v_mfma_f32_16x16x32_bf16 v[4:7], v[228:231], a[208:211], v[4:7]
  v_perm_b32 v224, v165, v161, s58
  v_perm_b32 v225, v173, v169, s58
  v_mfma_f32_16x16x32_bf16 v[36:39], v[228:231], a[212:215], v[36:39]
  v_perm_b32 v226, v181, v177, s58
  ds_read_b128 a[196:199], v245 offset:1024
  v_mfma_f32_16x16x32_bf16 v[68:71], v[228:231], a[216:219], v[68:71]
  v_perm_b32 v227, v189, v185, s58
  v_mfma_f32_16x16x32_bf16 v[100:103], v[228:231], a[220:223], v[100:103]
  buffer_load_dwordx4 v[136:139], v238, s[12:15], s60 offen
  v_mfma_f32_16x16x32_bf16 v[8:11], v[224:227], a[208:211], v[8:11]
  v_perm_b32 v228, v165, v161, s59
  v_perm_b32 v229, v173, v169, s59
  v_mfma_f32_16x16x32_bf16 v[40:43], v[224:227], a[212:215], v[40:43]
  v_perm_b32 v230, v181, v177, s59
  ds_read_b128 a[200:203], v245 offset:2048
  v_mfma_f32_16x16x32_bf16 v[72:75], v[224:227], a[216:219], v[72:75]
  v_perm_b32 v231, v189, v185, s59
  v_mfma_f32_16x16x32_bf16 v[104:107], v[224:227], a[220:223], v[104:107]
  buffer_load_dwordx4 v[140:143], v239, s[12:15], s60 offen
  v_mfma_f32_16x16x32_bf16 v[12:15], v[228:231], a[208:211], v[12:15]
  v_perm_b32 v224, v166, v162, s58
  v_perm_b32 v225, v174, v170, s58
  v_mfma_f32_16x16x32_bf16 v[44:47], v[228:231], a[212:215], v[44:47]
  v_perm_b32 v226, v182, v178, s58
  ds_read_b128 a[204:207], v245 offset:3072
  v_mfma_f32_16x16x32_bf16 v[76:79], v[228:231], a[216:219], v[76:79]
  v_perm_b32 v227, v190, v186, s58
  v_mfma_f32_16x16x32_bf16 v[108:111], v[228:231], a[220:223], v[108:111]
  buffer_load_dwordx4 v[144:147], v240, s[12:15], s60 offen
  v_mfma_f32_16x16x32_bf16 v[16:19], v[224:227], a[208:211], v[16:19]
  v_perm_b32 v228, v166, v162, s59
  v_perm_b32 v229, v174, v170, s59
  v_mfma_f32_16x16x32_bf16 v[48:51], v[224:227], a[212:215], v[48:51]
  v_perm_b32 v230, v182, v178, s59
  v_mfma_f32_16x16x32_bf16 v[80:83], v[224:227], a[216:219], v[80:83]
  v_perm_b32 v231, v190, v186, s59
  v_mfma_f32_16x16x32_bf16 v[112:115], v[224:227], a[220:223], v[112:115]
  buffer_load_dwordx4 v[148:151], v241, s[12:15], s60 offen
  v_mfma_f32_16x16x32_bf16 v[20:23], v[228:231], a[208:211], v[20:23]
  v_perm_b32 v224, v167, v163, s58
  v_perm_b32 v225, v175, v171, s58
  v_mfma_f32_16x16x32_bf16 v[52:55], v[228:231], a[212:215], v[52:55]
  v_perm_b32 v226, v183, v179, s58
  v_mfma_f32_16x16x32_bf16 v[84:87], v[228:231], a[216:219], v[84:87]
  v_perm_b32 v227, v191, v187, s58
  v_mfma_f32_16x16x32_bf16 v[116:119], v[228:231], a[220:223], v[116:119]
  buffer_load_dwordx4 v[152:155], v242, s[12:15], s60 offen
  v_mfma_f32_16x16x32_bf16 v[24:27], v[224:227], a[208:211], v[24:27]
  v_perm_b32 v228, v167, v163, s59
  v_perm_b32 v229, v175, v171, s59
  v_mfma_f32_16x16x32_bf16 v[56:59], v[224:227], a[212:215], v[56:59]
  v_perm_b32 v230, v183, v179, s59
  v_mfma_f32_16x16x32_bf16 v[88:91], v[224:227], a[216:219], v[88:91]
  v_perm_b32 v231, v191, v187, s59
  v_mfma_f32_16x16x32_bf16 v[120:123], v[224:227], a[220:223], v[120:123]
  buffer_load_dwordx4 v[156:159], v243, s[12:15], s60 offen
  s_add_u32 s60, s60, 262144
  v_mfma_f32_16x16x32_bf16 v[28:31], v[228:231], a[208:211], v[28:31]
  s_waitcnt vmcnt(12)
  v_perm_b32 v224, v196, v192, s58
  v_perm_b32 v225, v204, v200, s58
  v_mfma_f32_16x16x32_bf16 v[60:63], v[228:231], a[212:215], v[60:63]
  s_waitcnt vmcnt(8)
  v_perm_b32 v226, v212, v208, s58
  v_mfma_f32_16x16x32_bf16 v[92:95], v[228:231], a[216:219], v[92:95]
  v_perm_b32 v227, v220, v216, s58
  v_mfma_f32_16x16x32_bf16 v[124:127], v[228:231], a[220:223], v[124:127]
  buffer_load_dwordx4 v[160:163], v236, s[12:15], s60 offen
  s_waitcnt lgkmcnt(0)
  v_mfma_f32_16x16x32_bf16 v[0:3], v[224:227], a[192:195], v[0:3]
  v_perm_b32 v228, v196, v192, s59
  v_perm_b32 v229, v204, v200, s59
  v_mfma_f32_16x16x32_bf16 v[32:35], v[224:227], a[196:199], v[32:35]
  v_perm_b32 v230, v212, v208, s59
  ds_read_b128 a[208:211], v245 offset:4096
  v_mfma_f32_16x16x32_bf16 v[64:67], v[224:227], a[200:203], v[64:67]
  v_perm_b32 v231, v220, v216, s59
  v_mfma_f32_16x16x32_bf16 v[96:99], v[224:227], a[204:207], v[96:99]
  buffer_load_dwordx4 v[164:167], v237, s[12:15], s60 offen
  v_mfma_f32_16x16x32_bf16 v[4:7], v[228:231], a[192:195], v[4:7]
  v_perm_b32 v224, v197, v193, s58
  v_perm_b32 v225, v205, v201, s58
  v_mfma_f32_16x16x32_bf16 v[36:39], v[228:231], a[196:199], v[36:39]
  v_perm_b32 v226, v213, v209, s58
  ds_read_b128 a[212:215], v245 offset:5120
  v_mfma_f32_16x16x32_bf16 v[68:71], v[228:231], a[200:203], v[68:71]
  v_perm_b32 v227, v221, v217, s58
  v_mfma_f32_16x16x32_bf16 v[100:103], v[228:231], a[204:207], v[100:103]
  buffer_load_dwordx4 v[168:171], v238, s[12:15], s60 offen
  v_mfma_f32_16x16x32_bf16 v[8:11], v[224:227], a[192:195], v[8:11]
  v_perm_b32 v228, v197, v193, s59
  v_perm_b32 v229, v205, v201, s59
  v_mfma_f32_16x16x32_bf16 v[40:43], v[224:227], a[196:199], v[40:43]
  v_perm_b32 v230, v213, v209, s59
  ds_read_b128 a[216:219], v245 offset:6144
  v_mfma_f32_16x16x32_bf16 v[72:75], v[224:227], a[200:203], v[72:75]
  v_perm_b32 v231, v221, v217, s59
  v_mfma_f32_16x16x32_bf16 v[104:107], v[224:227], a[204:207], v[104:107]
  buffer_load_dwordx4 v[172:175], v239, s[12:15], s60 offen
  v_mfma_f32_16x16x32_bf16 v[12:15], v[228:231], a[192:195], v[12:15]
  v_perm_b32 v224, v198, v194, s58
  v_perm_b32 v225, v206, v202, s58
  v_mfma_f32_16x16x32_bf16 v[44:47], v[228:231], a[196:199], v[44:47]
  v_perm_b32 v226, v214, v210, s58
  ds_read_b128 a[220:223], v245 offset:7168
  v_mfma_f32_16x16x32_bf16 v[76:79], v[228:231], a[200:203], v[76:79]
  v_perm_b32 v227, v222, v218, s58
  v_mfma_f32_16x16x32_bf16 v[108:111], v[228:231], a[204:207], v[108:111]
  buffer_load_dwordx4 v[176:179], v240, s[12:15], s60 offen
  v_mfma_f32_16x16x32_bf16 v[16:19], v[224:227], a[192:195], v[16:19]
  v_perm_b32 v228, v198, v194, s59
  v_perm_b32 v229, v206, v202, s59
  v_mfma_f32_16x16x32_bf16 v[48:51], v[224:227], a[196:199], v[48:51]
  v_perm_b32 v230, v214, v210, s59
  v_mfma_f32_16x16x32_bf16 v[80:83], v[224:227], a[200:203], v[80:83]
  v_perm_b32 v231, v222, v218, s59
  v_mfma_f32_16x16x32_bf16 v[112:115], v[224:227], a[204:207], v[112:115]
  buffer_load_dwordx4 v[180:183], v241, s[12:15], s60 offen
  v_mfma_f32_16x16x32_bf16 v[20:23], v[228:231], a[192:195], v[20:23]
  v_perm_b32 v224, v199, v195, s58
  v_perm_b32 v225, v207, v203, s58
  v_mfma_f32_16x16x32_bf16 v[52:55], v[228:231], a[196:199], v[52:55]
  v_perm_b32 v226, v215, v211, s58
  v_mfma_f32_16x16x32_bf16 v[84:87], v[228:231], a[200:203], v[84:87]
  v_perm_b32 v227, v223, v219, s58
  v_mfma_f32_16x16x32_bf16 v[116:119], v[228:231], a[204:207], v[116:119]
  buffer_load_dwordx4 v[184:187], v242, s[12:15], s60 offen
  v_mfma_f32_16x16x32_bf16 v[24:27], v[224:227], a[192:195], v[24:27]
  v_perm_b32 v228, v199, v195, s59
  v_perm_b32 v229, v207, v203, s59
  v_mfma_f32_16x16x32_bf16 v[56:59], v[224:227], a[196:199], v[56:59]
  v_perm_b32 v230, v215, v211, s59
  v_mfma_f32_16x16x32_bf16 v[88:91], v[224:227], a[200:203], v[88:91]
  v_perm_b32 v231, v223, v219, s59
  v_mfma_f32_16x16x32_bf16 v[120:123], v[224:227], a[204:207], v[120:123]
  buffer_load_dwordx4 v[188:191], v243, s[12:15], s60 offen
  s_add_u32 s60, s60, 262144
  v_mfma_f32_16x16x32_bf16 v[28:31], v[228:231], a[192:195], v[28:31]
  s_waitcnt vmcnt(12)
  v_perm_b32 v224, v132, v128, s58
  v_perm_b32 v225, v140, v136, s58
  v_mfma_f32_16x16x32_bf16 v[60:63], v[228:231], a[196:199], v[60:63]
  s_waitcnt vmcnt(8)
  v_perm_b32 v226, v148, v144, s58
  v_mfma_f32_16x16x32_bf16 v[92:95], v[228:231], a[200:203], v[92:95]
  v_perm_b32 v227, v156, v152, s58
  v_mfma_f32_16x16x32_bf16 v[124:127], v[228:231], a[204:207], v[124:127]
  buffer_load_dwordx4 v[192:195], v236, s[12:15], s60 offen
  s_waitcnt lgkmcnt(0)
  v_mfma_f32_16x16x32_bf16 v[0:3], v[224:227], a[208:211], v[0:3]
  v_perm_b32 v228, v132, v128, s59
  v_perm_b32 v229, v140, v136, s59
  v_mfma_f32_16x16x32_bf16 v[32:35], v[224:227], a[212:215], v[32:35]
  v_perm_b32 v230, v148, v144, s59
  ds_read_b128 a[192:195], v245 offset:8192
  v_mfma_f32_16x16x32_bf16 v[64:67], v[224:227], a[216:219], v[64:67]
  v_perm_b32 v231, v156, v152, s59
  v_mfma_f32_16x16x32_bf16 v[96:99], v[224:227], a[220:223], v[96:99]
  buffer_load_dwordx4 v[196:199], v237, s[12:15], s60 offen
  v_mfma_f32_16x16x32_bf16 v[4:7], v[228:231], a[208:211], v[4:7]
  v_perm_b32 v224, v133, v129, s58
  v_perm_b32 v225, v141, v137, s58
  v_mfma_f32_16x16x32_bf16 v[36:39], v[228:231], a[212:215], v[36:39]
  v_perm_b32 v226, v149, v145, s58
  ds_read_b128 a[196:199], v245 offset:9216
  v_mfma_f32_16x16x32_bf16 v[68:71], v[228:231], a[216:219], v[68:71]
  v_perm_b32 v227, v157, v153, s58
  v_mfma_f32_16x16x32_bf16 v[100:103], v[228:231], a[220:223], v[100:103]
  buffer_load_dwordx4 v[200:203], v238, s[12:15], s60 offen
  v_mfma_f32_16x16x32_bf16 v[8:11], v[224:227], a[208:211], v[8:11]
  v_perm_b32 v228, v133, v129, s59
  v_perm_b32 v229, v141, v137, s59
  v_mfma_f32_16x16x32_bf16 v[40:43], v[224:227], a[212:215], v[40:43]
  v_perm_b32 v230, v149, v145, s59
  ds_read_b128 a[200:203], v245 offset:10240
  v_mfma_f32_16x16x32_bf16 v[72:75], v[224:227], a[216:219], v[72:75]
  v_perm_b32 v231, v157, v153, s59
  v_mfma_f32_16x16x32_bf16 v[104:107], v[224:227], a[220:223], v[104:107]
  buffer_load_dwordx4 v[204:207], v239, s[12:15], s60 offen
  v_mfma_f32_16x16x32_bf16 v[12:15], v[228:231], a[208:211], v[12:15]
  v_perm_b32 v224, v134, v130, s58
  v_perm_b32 v225, v142, v138, s58
  v_mfma_f32_16x16x32_bf16 v[44:47], v[228:231], a[212:215], v[44:47]
  v_perm_b32 v226, v150, v146, s58
  ds_read_b128 a[204:207], v245 offset:11264
  v_mfma_f32_16x16x32_bf16 v[76:79], v[228:231], a[216:219], v[76:79]
  v_perm_b32 v227, v158, v154, s58
  v_mfma_f32_16x16x32_bf16 v[108:111], v[228:231], a[220:223], v[108:111]
  buffer_load_dwordx4 v[208:211], v240, s[12:15], s60 offen
  v_mfma_f32_16x16x32_bf16 v[16:19], v[224:227], a[208:211], v[16:19]
  v_perm_b32 v228, v134, v130, s59
  v_perm_b32 v229, v142, v138, s59
  v_mfma_f32_16x16x32_bf16 v[48:51], v[224:227], a[212:215], v[48:51]
  v_perm_b32 v230, v150, v146, s59
  v_mfma_f32_16x16x32_bf16 v[80:83], v[224:227], a[216:219], v[80:83]
  v_perm_b32 v231, v158, v154, s59
  v_mfma_f32_16x16x32_bf16 v[112:115], v[224:227], a[220:223], v[112:115]
  buffer_load_dwordx4 v[212:215], v241, s[12:15], s60 offen
  v_mfma_f32_16x16x32_bf16 v[20:23], v[228:231], a[208:211], v[20:23]
  v_perm_b32 v224, v135, v131, s58
  v_perm_b32 v225, v143, v139, s58
  v_mfma_f32_16x16x32_bf16 v[52:55], v[228:231], a[212:215], v[52:55]
  v_perm_b32 v226, v151, v147, s58
  v_mfma_f32_16x16x32_bf16 v[84:87], v[228:231], a[216:219], v[84:87]
  v_perm_b32 v227, v159, v155, s58
  v_mfma_f32_16x16x32_bf16 v[116:119], v[228:231], a[220:223], v[116:119]
  buffer_load_dwordx4 v[216:219], v242, s[12:15], s60 offen
  v_mfma_f32_16x16x32_bf16 v[24:27], v[224:227], a[208:211], v[24:27]
  v_perm_b32 v228, v135, v131, s59
  v_perm_b32 v229, v143, v139, s59
  v_mfma_f32_16x16x32_bf16 v[56:59], v[224:227], a[212:215], v[56:59]
  v_perm_b32 v230, v151, v147, s59
  v_mfma_f32_16x16x32_bf16 v[88:91], v[224:227], a[216:219], v[88:91]
  v_perm_b32 v231, v159, v155, s59
  v_mfma_f32_16x16x32_bf16 v[120:123], v[224:227], a[220:223], v[120:123]
  buffer_load_dwordx4 v[220:223], v243, s[12:15], s60 offen
  s_add_u32 s60, s60, 262144
  v_mfma_f32_16x16x32_bf16 v[28:31], v[228:231], a[208:211], v[28:31]
  s_waitcnt vmcnt(12)
  v_perm_b32 v224, v164, v160, s58
  v_perm_b32 v225, v172, v168, s58
  v_mfma_f32_16x16x32_bf16 v[60:63], v[228:231], a[212:215], v[60:63]
  s_waitcnt vmcnt(8)
  v_perm_b32 v226, v180, v176, s58
  v_mfma_f32_16x16x32_bf16 v[92:95], v[228:231], a[216:219], v[92:95]
  v_perm_b32 v227, v188, v184, s58
  v_mfma_f32_16x16x32_bf16 v[124:127], v[228:231], a[220:223], v[124:127]
  buffer_load_dwordx4 v[128:131], v236, s[12:15], s60 offen
  s_waitcnt lgkmcnt(0)
  v_mfma_f32_16x16x32_bf16 v[0:3], v[224:227], a[192:195], v[0:3]
  v_perm_b32 v228, v164, v160, s59
  v_perm_b32 v229, v172, v168, s59
  v_mfma_f32_16x16x32_bf16 v[32:35], v[224:227], a[196:199], v[32:35]
  v_perm_b32 v230, v180, v176, s59
  ds_read_b128 a[208:211], v245 offset:12288
  v_mfma_f32_16x16x32_bf16 v[64:67], v[224:227], a[200:203], v[64:67]
  v_perm_b32 v231, v188, v184, s59
  v_mfma_f32_16x16x32_bf16 v[96:99], v[224:227], a[204:207], v[96:99]
  buffer_load_dwordx4 v[132:135], v237, s[12:15], s60 offen
  v_mfma_f32_16x16x32_bf16 v[4:7], v[228:231], a[192:195], v[4:7]
  v_perm_b32 v224, v165, v161, s58
  v_perm_b32 v225, v173, v169, s58
  v_mfma_f32_16x16x32_bf16 v[36:39], v[228:231], a[196:199], v[36:39]
  v_perm_b32 v226, v181, v177, s58
  ds_read_b128 a[212:215], v245 offset:13312
  v_mfma_f32_16x16x32_bf16 v[68:71], v[228:231], a[200:203], v[68:71]
  v_perm_b32 v227, v189, v185, s58
  v_mfma_f32_16x16x32_bf16 v[100:103], v[228:231], a[204:207], v[100:103]
  buffer_load_dwordx4 v[136:139], v238, s[12:15], s60 offen
  v_mfma_f32_16x16x32_bf16 v[8:11], v[224:227], a[192:195], v[8:11]
  v_perm_b32 v228, v165, v161, s59
  v_perm_b32 v229, v173, v169, s59
  v_mfma_f32_16x16x32_bf16 v[40:43], v[224:227], a[196:199], v[40:43]
  v_perm_b32 v230, v181, v177, s59
  ds_read_b128 a[216:219], v245 offset:14336
  v_mfma_f32_16x16x32_bf16 v[72:75], v[224:227], a[200:203], v[72:75]
  v_perm_b32 v231, v189, v185, s59
  v_mfma_f32_16x16x32_bf16 v[104:107], v[224:227], a[204:207], v[104:107]
  buffer_load_dwordx4 v[140:143], v239, s[12:15], s60 offen
  v_mfma_f32_16x16x32_bf16 v[12:15], v[228:231], a[192:195], v[12:15]
  v_perm_b32 v224, v166, v162, s58
  v_perm_b32 v225, v174, v170, s58
  v_mfma_f32_16x16x32_bf16 v[44:47], v[228:231], a[196:199], v[44:47]
  v_perm_b32 v226, v182, v178, s58
  ds_read_b128 a[220:223], v245 offset:15360
  v_mfma_f32_16x16x32_bf16 v[76:79], v[228:231], a[200:203], v[76:79]
  v_perm_b32 v227, v190, v186, s58
  v_mfma_f32_16x16x32_bf16 v[108:111], v[228:231], a[204:207], v[108:111]
  buffer_load_dwordx4 v[144:147], v240, s[12:15], s60 offen
  v_mfma_f32_16x16x32_bf16 v[16:19], v[224:227], a[192:195], v[16:19]
  v_perm_b32 v228, v166, v162, s59
  v_perm_b32 v229, v174, v170, s59
  v_mfma_f32_16x16x32_bf16 v[48:51], v[224:227], a[196:199], v[48:51]
  v_perm_b32 v230, v182, v178, s59
  v_mfma_f32_16x16x32_bf16 v[80:83], v[224:227], a[200:203], v[80:83]
  v_perm_b32 v231, v190, v186, s59
  v_mfma_f32_16x16x32_bf16 v[112:115], v[224:227], a[204:207], v[112:115]
  buffer_load_dwordx4 v[148:151], v241, s[12:15], s60 offen
  v_mfma_f32_16x16x32_bf16 v[20:23], v[228:231], a[192:195], v[20:23]
  v_perm_b32 v224, v167, v163, s58
  v_perm_b32 v225, v175, v171, s58
  v_mfma_f32_16x16x32_bf16 v[52:55], v[228:231], a[196:199], v[52:55]
  v_perm_b32 v226, v183, v179, s58
  v_mfma_f32_16x16x32_bf16 v[84:87], v[228:231], a[200:203], v[84:87]
  v_perm_b32 v227, v191, v187, s58
  v_mfma_f32_16x16x32_bf16 v[116:119], v[228:231], a[204:207], v[116:119]
  buffer_load_dwordx4 v[152:155], v242, s[12:15], s60 offen
  v_mfma_f32_16x16x32_bf16 v[24:27], v[224:227], a[192:195], v[24:27]
  v_perm_b32 v228, v167, v163, s59
  v_perm_b32 v229, v175, v171, s59
  v_mfma_f32_16x16x32_bf16 v[56:59], v[224:227], a[196:199], v[56:59]
  v_perm_b32 v230, v183, v179, s59
  v_mfma_f32_16x16x32_bf16 v[88:91], v[224:227], a[200:203], v[88:91]
  v_perm_b32 v231, v191, v187, s59
  v_mfma_f32_16x16x32_bf16 v[120:123], v[224:227], a[204:207], v[120:123]
  buffer_load_dwordx4 v[156:159], v243, s[12:15], s60 offen
  s_add_u32 s60, s60, 262144
  v_mfma_f32_16x16x32_bf16 v[28:31], v[228:231], a[192:195], v[28:31]
  s_waitcnt vmcnt(12)
  v_perm_b32 v224, v196, v192, s58
  v_perm_b32 v225, v204, v200, s58
  v_mfma_f32_16x16x32_bf16 v[60:63], v[228:231], a[196:199], v[60:63]
  s_waitcnt vmcnt(8)
  v_perm_b32 v226, v212, v208, s58
  v_mfma_f32_16x16x32_bf16 v[92:95], v[228:231], a[200:203], v[92:95]
  v_perm_b32 v227, v220, v216, s58
  v_mfma_f32_16x16x32_bf16 v[124:127], v[228:231], a[204:207], v[124:127]
  buffer_load_dwordx4 v[160:163], v236, s[12:15], s60 offen
  s_waitcnt lgkmcnt(0)
  v_mfma_f32_16x16x32_bf16 v[0:3], v[224:227], a[208:211], v[0:3]
  v_perm_b32 v228, v196, v192, s59
  v_perm_b32 v229, v204, v200, s59
  v_mfma_f32_16x16x32_bf16 v[32:35], v[224:227], a[212:215], v[32:35]
  v_perm_b32 v230, v212, v208, s59
  ds_read_b128 a[192:195], v245 offset:16384
  v_mfma_f32_16x16x32_bf16 v[64:67], v[224:227], a[216:219], v[64:67]
  v_perm_b32 v231, v220, v216, s59
  v_mfma_f32_16x16x32_bf16 v[96:99], v[224:227], a[220:223], v[96:99]
  buffer_load_dwordx4 v[164:167], v237, s[12:15], s60 offen
  v_mfma_f32_16x16x32_bf16 v[4:7], v[228:231], a[208:211], v[4:7]
  v_perm_b32 v224, v197, v193, s58
  v_perm_b32 v225, v205, v201, s58
  v_mfma_f32_16x16x32_bf16 v[36:39], v[228:231], a[212:215], v[36:39]
  v_perm_b32 v226, v213, v209, s58
  ds_read_b128 a[196:199], v245 offset:17408
  v_mfma_f32_16x16x32_bf16 v[68:71], v[228:231], a[216:219], v[68:71]
  v_perm_b32 v227, v221, v217, s58
  v_mfma_f32_16x16x32_bf16 v[100:103], v[228:231], a[220:223], v[100:103]
  buffer_load_dwordx4 v[168:171], v238, s[12:15], s60 offen
  v_mfma_f32_16x16x32_bf16 v[8:11], v[224:227], a[208:211], v[8:11]
  v_perm_b32 v228, v197, v193, s59
  v_perm_b32 v229, v205, v201, s59
  v_mfma_f32_16x16x32_bf16 v[40:43], v[224:227], a[212:215], v[40:43]
  v_perm_b32 v230, v213, v209, s59
  ds_read_b128 a[200:203], v245 offset:18432
  v_mfma_f32_16x16x32_bf16 v[72:75], v[224:227], a[216:219], v[72:75]
  v_perm_b32 v231, v221, v217, s59
  v_mfma_f32_16x16x32_bf16 v[104:107], v[224:227], a[220:223], v[104:107]
  buffer_load_dwordx4 v[172:175], v239, s[12:15], s60 offen
  v_mfma_f32_16x16x32_bf16 v[12:15], v[228:231], a[208:211], v[12:15]
  v_perm_b32 v224, v198, v194, s58
  v_perm_b32 v225, v206, v202, s58
  v_mfma_f32_16x16x32_bf16 v[44:47], v[228:231], a[212:215], v[44:47]
  v_perm_b32 v226, v214, v210, s58
  ds_read_b128 a[204:207], v245 offset:19456
  v_mfma_f32_16x16x32_bf16 v[76:79], v[228:231], a[216:219], v[76:79]
  v_perm_b32 v227, v222, v218, s58
  v_mfma_f32_16x16x32_bf16 v[108:111], v[228:231], a[220:223], v[108:111]
  buffer_load_dwordx4 v[176:179], v240, s[12:15], s60 offen
  v_mfma_f32_16x16x32_bf16 v[16:19], v[224:227], a[208:211], v[16:19]
  v_perm_b32 v228, v198, v194, s59
  v_perm_b32 v229, v206, v202, s59
  v_mfma_f32_16x16x32_bf16 v[48:51], v[224:227], a[212:215], v[48:51]
  v_perm_b32 v230, v214, v210, s59
  v_mfma_f32_16x16x32_bf16 v[80:83], v[224:227], a[216:219], v[80:83]
  v_perm_b32 v231, v222, v218, s59
  v_mfma_f32_16x16x32_bf16 v[112:115], v[224:227], a[220:223], v[112:115]
  buffer_load_dwordx4 v[180:183], v241, s[12:15], s60 offen
  v_mfma_f32_16x16x32_bf16 v[20:23], v[228:231], a[208:211], v[20:23]
  v_perm_b32 v224, v199, v195, s58
  v_perm_b32 v225, v207, v203, s58
  v_mfma_f32_16x16x32_bf16 v[52:55], v[228:231], a[212:215], v[52:55]
  v_perm_b32 v226, v215, v211, s58
  v_mfma_f32_16x16x32_bf16 v[84:87], v[228:231], a[216:219], v[84:87]
  v_perm_b32 v227, v223, v219, s58
  v_mfma_f32_16x16x32_bf16 v[116:119], v[228:231], a[220:223], v[116:119]
  buffer_load_dwordx4 v[184:187], v242, s[12:15], s60 offen
  v_mfma_f32_16x16x32_bf16 v[24:27], v[224:227], a[208:211], v[24:27]
  v_perm_b32 v228, v199, v195, s59
  v_perm_b32 v229, v207, v203, s59
  v_mfma_f32_16x16x32_bf16 v[56:59], v[224:227], a[212:215], v[56:59]
  v_perm_b32 v230, v215, v211, s59
  v_mfma_f32_16x16x32_bf16 v[88:91], v[224:227], a[216:219], v[88:91]
  v_perm_b32 v231, v223, v219, s59
  v_mfma_f32_16x16x32_bf16 v[120:123], v[224:227], a[220:223], v[120:123]
  buffer_load_dwordx4 v[188:191], v243, s[12:15], s60 offen
  s_add_u32 s60, s60, 262144
  v_mfma_f32_16x16x32_bf16 v[28:31], v[228:231], a[208:211], v[28:31]
  s_waitcnt vmcnt(12)
  v_perm_b32 v224, v132, v128, s58
  v_perm_b32 v225, v140, v136, s58
  v_mfma_f32_16x16x32_bf16 v[60:63], v[228:231], a[212:215], v[60:63]
  s_waitcnt vmcnt(8)
  v_perm_b32 v226, v148, v144, s58
  v_mfma_f32_16x16x32_bf16 v[92:95], v[228:231], a[216:219], v[92:95]
  v_perm_b32 v227, v156, v152, s58
  v_mfma_f32_16x16x32_bf16 v[124:127], v[228:231], a[220:223], v[124:127]
  buffer_load_dwordx4 v[192:195], v236, s[12:15], s60 offen
  s_waitcnt lgkmcnt(0)
  v_mfma_f32_16x16x32_bf16 v[0:3], v[224:227], a[192:195], v[0:3]
  v_perm_b32 v228, v132, v128, s59
  v_perm_b32 v229, v140, v136, s59
  v_mfma_f32_16x16x32_bf16 v[32:35], v[224:227], a[196:199], v[32:35]
  v_perm_b32 v230, v148, v144, s59
  ds_read_b128 a[208:211], v245 offset:20480
  v_mfma_f32_16x16x32_bf16 v[64:67], v[224:227], a[200:203], v[64:67]
  v_perm_b32 v231, v156, v152, s59
  v_mfma_f32_16x16x32_bf16 v[96:99], v[224:227], a[204:207], v[96:99]
  buffer_load_dwordx4 v[196:199], v237, s[12:15], s60 offen
  v_mfma_f32_16x16x32_bf16 v[4:7], v[228:231], a[192:195], v[4:7]
  v_perm_b32 v224, v133, v129, s58
  v_perm_b32 v225, v141, v137, s58
  v_mfma_f32_16x16x32_bf16 v[36:39], v[228:231], a[196:199], v[36:39]
  v_perm_b32 v226, v149, v145, s58
  ds_read_b128 a[212:215], v245 offset:21504
  v_mfma_f32_16x16x32_bf16 v[68:71], v[228:231], a[200:203], v[68:71]
  v_perm_b32 v227, v157, v153, s58
  v_mfma_f32_16x16x32_bf16 v[100:103], v[228:231], a[204:207], v[100:103]
  buffer_load_dwordx4 v[200:203], v238, s[12:15], s60 offen
  v_mfma_f32_16x16x32_bf16 v[8:11], v[224:227], a[192:195], v[8:11]
  v_perm_b32 v228, v133, v129, s59
  v_perm_b32 v229, v141, v137, s59
  v_mfma_f32_16x16x32_bf16 v[40:43], v[224:227], a[196:199], v[40:43]
  v_perm_b32 v230, v149, v145, s59
  ds_read_b128 a[216:219], v245 offset:22528
  v_mfma_f32_16x16x32_bf16 v[72:75], v[224:227], a[200:203], v[72:75]
  v_perm_b32 v231, v157, v153, s59
  v_mfma_f32_16x16x32_bf16 v[104:107], v[224:227], a[204:207], v[104:107]
  buffer_load_dwordx4 v[204:207], v239, s[12:15], s60 offen
  v_mfma_f32_16x16x32_bf16 v[12:15], v[228:231], a[192:195], v[12:15]
  v_perm_b32 v224, v134, v130, s58
  v_perm_b32 v225, v142, v138, s58
  v_mfma_f32_16x16x32_bf16 v[44:47], v[228:231], a[196:199], v[44:47]
  v_perm_b32 v226, v150, v146, s58
  ds_read_b128 a[220:223], v245 offset:23552
  v_mfma_f32_16x16x32_bf16 v[76:79], v[228:231], a[200:203], v[76:79]
  v_perm_b32 v227, v158, v154, s58
  v_mfma_f32_16x16x32_bf16 v[108:111], v[228:231], a[204:207], v[108:111]
  buffer_load_dwordx4 v[208:211], v240, s[12:15], s60 offen
  v_mfma_f32_16x16x32_bf16 v[16:19], v[224:227], a[192:195], v[16:19]
  v_perm_b32 v228, v134, v130, s59
  v_perm_b32 v229, v142, v138, s59
  v_mfma_f32_16x16x32_bf16 v[48:51], v[224:227], a[196:199], v[48:51]
  v_perm_b32 v230, v150, v146, s59
  v_mfma_f32_16x16x32_bf16 v[80:83], v[224:227], a[200:203], v[80:83]
  v_perm_b32 v231, v158, v154, s59
  v_mfma_f32_16x16x32_bf16 v[112:115], v[224:227], a[204:207], v[112:115]
  buffer_load_dwordx4 v[212:215], v241, s[12:15], s60 offen
  v_mfma_f32_16x16x32_bf16 v[20:23], v[228:231], a[192:195], v[20:23]
  v_perm_b32 v224, v135, v131, s58
  v_perm_b32 v225, v143, v139, s58
  v_mfma_f32_16x16x32_bf16 v[52:55], v[228:231], a[196:199], v[52:55]
  v_perm_b32 v226, v151, v147, s58
  v_mfma_f32_16x16x32_bf16 v[84:87], v[228:231], a[200:203], v[84:87]
  v_perm_b32 v227, v159, v155, s58
  v_mfma_f32_16x16x32_bf16 v[116:119], v[228:231], a[204:207], v[116:119]
  buffer_load_dwordx4 v[216:219], v242, s[12:15], s60 offen
  v_mfma_f32_16x16x32_bf16 v[24:27], v[224:227], a[192:195], v[24:27]
  v_perm_b32 v228, v135, v131, s59
  v_perm_b32 v229, v143, v139, s59
  v_mfma_f32_16x16x32_bf16 v[56:59], v[224:227], a[196:199], v[56:59]
  v_perm_b32 v230, v151, v147, s59
  v_mfma_f32_16x16x32_bf16 v[88:91], v[224:227], a[200:203], v[88:91]
  v_perm_b32 v231, v159, v155, s59
  v_mfma_f32_16x16x32_bf16 v[120:123], v[224:227], a[204:207], v[120:123]
  buffer_load_dwordx4 v[220:223], v243, s[12:15], s60 offen
  s_add_u32 s60, s60, 262144
  v_mfma_f32_16x16x32_bf16 v[28:31], v[228:231], a[192:195], v[28:31]
  s_waitcnt vmcnt(12)
  v_perm_b32 v224, v164, v160, s58
  v_perm_b32 v225, v172, v168, s58
  v_mfma_f32_16x16x32_bf16 v[60:63], v[228:231], a[196:199], v[60:63]
  s_waitcnt vmcnt(8)
  v_perm_b32 v226, v180, v176, s58
  v_mfma_f32_16x16x32_bf16 v[92:95], v[228:231], a[200:203], v[92:95]
  v_perm_b32 v227, v188, v184, s58
  v_mfma_f32_16x16x32_bf16 v[124:127], v[228:231], a[204:207], v[124:127]
  buffer_load_dwordx4 v[128:131], v236, s[12:15], s60 offen
  s_waitcnt lgkmcnt(0)
  v_mfma_f32_16x16x32_bf16 v[0:3], v[224:227], a[208:211], v[0:3]
  v_perm_b32 v228, v164, v160, s59
  v_perm_b32 v229, v172, v168, s59
  v_mfma_f32_16x16x32_bf16 v[32:35], v[224:227], a[212:215], v[32:35]
  v_perm_b32 v230, v180, v176, s59
  ds_read_b128 a[192:195], v245 offset:24576
  v_mfma_f32_16x16x32_bf16 v[64:67], v[224:227], a[216:219], v[64:67]
  v_perm_b32 v231, v188, v184, s59
  v_mfma_f32_16x16x32_bf16 v[96:99], v[224:227], a[220:223], v[96:99]
  buffer_load_dwordx4 v[132:135], v237, s[12:15], s60 offen
  v_mfma_f32_16x16x32_bf16 v[4:7], v[228:231], a[208:211], v[4:7]
  v_perm_b32 v224, v165, v161, s58
  v_perm_b32 v225, v173, v169, s58
  v_mfma_f32_16x16x32_bf16 v[36:39], v[228:231], a[212:215], v[36:39]
  v_perm_b32 v226, v181, v177, s58
  ds_read_b128 a[196:199], v245 offset:25600
  v_mfma_f32_16x16x32_bf16 v[68:71], v[228:231], a[216:219], v[68:71]
  v_perm_b32 v227, v189, v185, s58
  v_mfma_f32_16x16x32_bf16 v[100:103], v[228:231], a[220:223], v[100:103]
  buffer_load_dwordx4 v[136:139], v238, s[12:15], s60 offen
  v_mfma_f32_16x16x32_bf16 v[8:11], v[224:227], a[208:211], v[8:11]
  v_perm_b32 v228, v165, v161, s59
  v_perm_b32 v229, v173, v169, s59
  v_mfma_f32_16x16x32_bf16 v[40:43], v[224:227], a[212:215], v[40:43]
  v_perm_b32 v230, v181, v177, s59
  ds_read_b128 a[200:203], v245 offset:26624
  v_mfma_f32_16x16x32_bf16 v[72:75], v[224:227], a[216:219], v[72:75]
  v_perm_b32 v231, v189, v185, s59
  v_mfma_f32_16x16x32_bf16 v[104:107], v[224:227], a[220:223], v[104:107]
  buffer_load_dwordx4 v[140:143], v239, s[12:15], s60 offen
  v_mfma_f32_16x16x32_bf16 v[12:15], v[228:231], a[208:211], v[12:15]
  v_perm_b32 v224, v166, v162, s58
  v_perm_b32 v225, v174, v170, s58
  v_mfma_f32_16x16x32_bf16 v[44:47], v[228:231], a[212:215], v[44:47]
  v_perm_b32 v226, v182, v178, s58
  ds_read_b128 a[204:207], v245 offset:27648
  v_mfma_f32_16x16x32_bf16 v[76:79], v[228:231], a[216:219], v[76:79]
  v_perm_b32 v227, v190, v186, s58
  v_mfma_f32_16x16x32_bf16 v[108:111], v[228:231], a[220:223], v[108:111]
  buffer_load_dwordx4 v[144:147], v240, s[12:15], s60 offen
  v_mfma_f32_16x16x32_bf16 v[16:19], v[224:227], a[208:211], v[16:19]
  v_perm_b32 v228, v166, v162, s59
  v_perm_b32 v229, v174, v170, s59
  v_mfma_f32_16x16x32_bf16 v[48:51], v[224:227], a[212:215], v[48:51]
  v_perm_b32 v230, v182, v178, s59
  v_mfma_f32_16x16x32_bf16 v[80:83], v[224:227], a[216:219], v[80:83]
  v_perm_b32 v231, v190, v186, s59
  v_mfma_f32_16x16x32_bf16 v[112:115], v[224:227], a[220:223], v[112:115]
  buffer_load_dwordx4 v[148:151], v241, s[12:15], s60 offen
  v_mfma_f32_16x16x32_bf16 v[20:23], v[228:231], a[208:211], v[20:23]
  v_perm_b32 v224, v167, v163, s58
  v_perm_b32 v225, v175, v171, s58
  v_mfma_f32_16x16x32_bf16 v[52:55], v[228:231], a[212:215], v[52:55]
  v_perm_b32 v226, v183, v179, s58
  v_mfma_f32_16x16x32_bf16 v[84:87], v[228:231], a[216:219], v[84:87]
  v_perm_b32 v227, v191, v187, s58
  v_mfma_f32_16x16x32_bf16 v[116:119], v[228:231], a[220:223], v[116:119]
  buffer_load_dwordx4 v[152:155], v242, s[12:15], s60 offen
  v_mfma_f32_16x16x32_bf16 v[24:27], v[224:227], a[208:211], v[24:27]
  v_perm_b32 v228, v167, v163, s59
  v_perm_b32 v229, v175, v171, s59
  v_mfma_f32_16x16x32_bf16 v[56:59], v[224:227], a[212:215], v[56:59]
  v_perm_b32 v230, v183, v179, s59
  v_mfma_f32_16x16x32_bf16 v[88:91], v[224:227], a[216:219], v[88:91]
  v_perm_b32 v231, v191, v187, s59
  v_mfma_f32_16x16x32_bf16 v[120:123], v[224:227], a[220:223], v[120:123]
  buffer_load_dwordx4 v[156:159], v243, s[12:15], s60 offen
  s_add_u32 s60, s60, 262144
  v_mfma_f32_16x16x32_bf16 v[28:31], v[228:231], a[208:211], v[28:31]
  s_waitcnt vmcnt(12)
  v_perm_b32 v224, v196, v192, s58
  v_perm_b32 v225, v204, v200, s58
  v_mfma_f32_16x16x32_bf16 v[60:63], v[228:231], a[212:215], v[60:63]
  s_waitcnt vmcnt(8)
  v_perm_b32 v226, v212, v208, s58
  v_mfma_f32_16x16x32_bf16 v[92:95], v[228:231], a[216:219], v[92:95]
  v_perm_b32 v227, v220, v216, s58
  v_mfma_f32_16x16x32_bf16 v[124:127], v[228:231], a[220:223], v[124:127]
  s_add_u32 m0, s63, 32768
  s_mov_b32 s61, 0
  buffer_load_dwordx4 v247, s[20:23], s61 offen lds
  s_waitcnt lgkmcnt(0)
  v_mfma_f32_16x16x32_bf16 v[0:3], v[224:227], a[192:195], v[0:3]
  v_perm_b32 v228, v196, v192, s59
  v_perm_b32 v229, v204, v200, s59
  v_mfma_f32_16x16x32_bf16 v[32:35], v[224:227], a[196:199], v[32:35]
  v_perm_b32 v230, v212, v208, s59
  ds_read_b128 a[208:211], v245 offset:28672
  v_mfma_f32_16x16x32_bf16 v[64:67], v[224:227], a[200:203], v[64:67]
  v_perm_b32 v231, v220, v216, s59
  v_mfma_f32_16x16x32_bf16 v[96:99], v[224:227], a[204:207], v[96:99]
  buffer_load_dwordx4 v248, s[20:23], s61 offen offset:1024 lds
  v_mfma_f32_16x16x32_bf16 v[4:7], v[228:231], a[192:195], v[4:7]
  v_perm_b32 v224, v197, v193, s58
  v_perm_b32 v225, v205, v201, s58
  v_mfma_f32_16x16x32_bf16 v[36:39], v[228:231], a[196:199], v[36:39]
  v_perm_b32 v226, v213, v209, s58
  ds_read_b128 a[212:215], v245 offset:29696
  v_mfma_f32_16x16x32_bf16 v[68:71], v[228:231], a[200:203], v[68:71]
  v_perm_b32 v227, v221, v217, s58
  v_mfma_f32_16x16x32_bf16 v[100:103], v[228:231], a[204:207], v[100:103]
  s_add_u32 m0, s63, 40960
  s_mov_b32 s61, 8192
  buffer_load_dwordx4 v247, s[20:23], s61 offen lds
  v_mfma_f32_16x16x32_bf16 v[8:11], v[224:227], a[192:195], v[8:11]
  v_perm_b32 v228, v197, v193, s59
  v_perm_b32 v229, v205, v201, s59
  v_mfma_f32_16x16x32_bf16 v[40:43], v[224:227], a[196:199], v[40:43]
  v_perm_b32 v230, v213, v209, s59
  ds_read_b128 a[216:219], v245 offset:30720
  v_mfma_f32_16x16x32_bf16 v[72:75], v[224:227], a[200:203], v[72:75]
  v_perm_b32 v231, v221, v217, s59
  v_mfma_f32_16x16x32_bf16 v[104:107], v[224:227], a[204:207], v[104:107]
  buffer_load_dwordx4 v248, s[20:23], s61 offen offset:1024 lds
  v_mfma_f32_16x16x32_bf16 v[12:15], v[228:231], a[192:195], v[12:15]
  v_perm_b32 v224, v198, v194, s58
  v_perm_b32 v225, v206, v202, s58
  v_mfma_f32_16x16x32_bf16 v[44:47], v[228:231], a[196:199], v[44:47]
  v_perm_b32 v226, v214, v210, s58
  ds_read_b128 a[220:223], v245 offset:31744
  v_mfma_f32_16x16x32_bf16 v[76:79], v[228:231], a[200:203], v[76:79]
  v_perm_b32 v227, v222, v218, s58
  v_mfma_f32_16x16x32_bf16 v[108:111], v[228:231], a[204:207], v[108:111]
  s_add_u32 m0, s63, 98304
  s_mov_b32 s62, 0
  buffer_load_dwordx4 v249, s[24:27], s62 offen lds
  v_mfma_f32_16x16x32_bf16 v[16:19], v[224:227], a[192:195], v[16:19]
  v_perm_b32 v228, v198, v194, s59
  v_perm_b32 v229, v206, v202, s59
  v_mfma_f32_16x16x32_bf16 v[48:51], v[224:227], a[196:199], v[48:51]
  v_perm_b32 v230, v214, v210, s59
  v_mfma_f32_16x16x32_bf16 v[80:83], v[224:227], a[200:203], v[80:83]
  v_perm_b32 v231, v222, v218, s59
  v_mfma_f32_16x16x32_bf16 v[112:115], v[224:227], a[204:207], v[112:115]
  buffer_load_dwordx4 v249, s[24:27], s62 offen offset:1024 lds
  v_mfma_f32_16x16x32_bf16 v[20:23], v[228:231], a[192:195], v[20:23]
  v_perm_b32 v224, v199, v195, s58
  v_perm_b32 v225, v207, v203, s58
  v_mfma_f32_16x16x32_bf16 v[52:55], v[228:231], a[196:199], v[52:55]
  v_perm_b32 v226, v215, v211, s58
  v_mfma_f32_16x16x32_bf16 v[84:87], v[228:231], a[200:203], v[84:87]
  v_perm_b32 v227, v223, v219, s58
  v_mfma_f32_16x16x32_bf16 v[116:119], v[228:231], a[204:207], v[116:119]
  s_add_u32 m0, s63, 49152
  s_mov_b32 s61, 16384
  buffer_load_dwordx4 v247, s[20:23], s61 offen lds
  v_mfma_f32_16x16x32_bf16 v[24:27], v[224:227], a[192:195], v[24:27]
  v_perm_b32 v228, v199, v195, s59
  v_perm_b32 v229, v207, v203, s59
  v_mfma_f32_16x16x32_bf16 v[56:59], v[224:227], a[196:199], v[56:59]
  v_perm_b32 v230, v215, v211, s59
  v_mfma_f32_16x16x32_bf16 v[88:91], v[224:227], a[200:203], v[88:91]
  v_perm_b32 v231, v223, v219, s59
  v_mfma_f32_16x16x32_bf16 v[120:123], v[224:227], a[204:207], v[120:123]
  buffer_load_dwordx4 v248, s[20:23], s61 offen offset:1024 lds
  v_mfma_f32_16x16x32_bf16 v[28:31], v[228:231], a[192:195], v[28:31]
  s_waitcnt vmcnt(12)
  v_perm_b32 v224, v132, v128, s58
  v_perm_b32 v225, v140, v136, s58
  v_mfma_f32_16x16x32_bf16 v[60:63], v[228:231], a[196:199], v[60:63]
  s_waitcnt vmcnt(8)
  v_perm_b32 v226, v148, v144, s58
  v_mfma_f32_16x16x32_bf16 v[92:95], v[228:231], a[200:203], v[92:95]
  v_perm_b32 v227, v156, v152, s58
  v_mfma_f32_16x16x32_bf16 v[124:127], v[228:231], a[204:207], v[124:127]
  s_add_u32 m0, s63, 106496
  s_mov_b32 s62, 8192
  buffer_load_dwordx4 v249, s[24:27], s62 offen lds
  s_waitcnt lgkmcnt(0)
  v_mfma_f32_16x16x32_bf16 v[0:3], v[224:227], a[208:211], v[0:3]
  v_perm_b32 v228, v132, v128, s59
  v_perm_b32 v229, v140, v136, s59
  v_mfma_f32_16x16x32_bf16 v[32:35], v[224:227], a[212:215], v[32:35]
  v_perm_b32 v230, v148, v144, s59
  v_mfma_f32_16x16x32_bf16 v[64:67], v[224:227], a[216:219], v[64:67]
  v_perm_b32 v231, v156, v152, s59
  v_mfma_f32_16x16x32_bf16 v[96:99], v[224:227], a[220:223], v[96:99]
  buffer_load_dwordx4 v249, s[24:27], s62 offen offset:1024 lds
  v_mfma_f32_16x16x32_bf16 v[4:7], v[228:231], a[208:211], v[4:7]
  v_perm_b32 v224, v133, v129, s58
  v_perm_b32 v225, v141, v137, s58
  v_mfma_f32_16x16x32_bf16 v[36:39], v[228:231], a[212:215], v[36:39]
  v_perm_b32 v226, v149, v145, s58
  v_mfma_f32_16x16x32_bf16 v[68:71], v[228:231], a[216:219], v[68:71]
  v_perm_b32 v227, v157, v153, s58
  v_mfma_f32_16x16x32_bf16 v[100:103], v[228:231], a[220:223], v[100:103]
  s_add_u32 m0, s63, 57344
  s_mov_b32 s61, 24576
  buffer_load_dwordx4 v247, s[20:23], s61 offen lds
  v_mfma_f32_16x16x32_bf16 v[8:11], v[224:227], a[208:211], v[8:11]
  v_perm_b32 v228, v133, v129, s59
  v_perm_b32 v229, v141, v137, s59
  v_mfma_f32_16x16x32_bf16 v[40:43], v[224:227], a[212:215], v[40:43]
  v_perm_b32 v230, v149, v145, s59
  v_mfma_f32_16x16x32_bf16 v[72:75], v[224:227], a[216:219], v[72:75]
  v_perm_b32 v231, v157, v153, s59
  v_mfma_f32_16x16x32_bf16 v[104:107], v[224:227], a[220:223], v[104:107]
  buffer_load_dwordx4 v248, s[20:23], s61 offen offset:1024 lds
  v_mfma_f32_16x16x32_bf16 v[12:15], v[228:231], a[208:211], v[12:15]
  v_perm_b32 v224, v134, v130, s58
  v_perm_b32 v225, v142, v138, s58
  v_mfma_f32_16x16x32_bf16 v[44:47], v[228:231], a[212:215], v[44:47]
  v_perm_b32 v226, v150, v146, s58
  v_mfma_f32_16x16x32_bf16 v[76:79], v[228:231], a[216:219], v[76:79]
  v_perm_b32 v227, v158, v154, s58
  v_mfma_f32_16x16x32_bf16 v[108:111], v[228:231], a[220:223], v[108:111]
  s_add_u32 m0, s63, 114688
  s_mov_b32 s62, 16384
  buffer_load_dwordx4 v249, s[24:27], s62 offen lds
  v_mfma_f32_16x16x32_bf16 v[16:19], v[224:227], a[208:211], v[16:19]
  v_perm_b32 v228, v134, v130, s59
  v_perm_b32 v229, v142, v138, s59
  v_mfma_f32_16x16x32_bf16 v[48:51], v[224:227], a[212:215], v[48:51]
  v_perm_b32 v230, v150, v146, s59
  v_mfma_f32_16x16x32_bf16 v[80:83], v[224:227], a[216:219], v[80:83]
  v_perm_b32 v231, v158, v154, s59
  v_mfma_f32_16x16x32_bf16 v[112:115], v[224:227], a[220:223], v[112:115]
  buffer_load_dwordx4 v249, s[24:27], s62 offen offset:1024 lds
  v_mfma_f32_16x16x32_bf16 v[20:23], v[228:231], a[208:211], v[20:23]
  v_perm_b32 v224, v135, v131, s58
  v_perm_b32 v225, v143, v139, s58
  v_mfma_f32_16x16x32_bf16 v[52:55], v[228:231], a[212:215], v[52:55]
  v_perm_b32 v226, v151, v147, s58
  v_mfma_f32_16x16x32_bf16 v[84:87], v[228:231], a[216:219], v[84:87]
  v_perm_b32 v227, v159, v155, s58
  v_mfma_f32_16x16x32_bf16 v[116:119], v[228:231], a[220:223], v[116:119]
  s_nop 0
  v_mfma_f32_16x16x32_bf16 v[24:27], v[224:227], a[208:211], v[24:27]
  v_perm_b32 v228, v135, v131, s59
  v_perm_b32 v229, v143, v139, s59
  v_mfma_f32_16x16x32_bf16 v[56:59], v[224:227], a[212:215], v[56:59]
  v_perm_b32 v230, v151, v147, s59
  v_mfma_f32_16x16x32_bf16 v[88:91], v[224:227], a[216:219], v[88:91]
  v_perm_b32 v231, v159, v155, s59
  v_mfma_f32_16x16x32_bf16 v[120:123], v[224:227], a[220:223], v[120:123]
  s_nop 0
  v_mfma_f32_16x16x32_bf16 v[28:31], v[228:231], a[208:211], v[28:31]
  v_mfma_f32_16x16x32_bf16 v[60:63], v[228:231], a[212:215], v[60:63]
  v_mfma_f32_16x16x32_bf16 v[92:95], v[228:231], a[216:219], v[92:95]
  v_mfma_f32_16x16x32_bf16 v[124:127], v[228:231], a[220:223], v[124:127]
  v_and_b32 v250, 31, v255
  v_lshrrev_b32 v251, 5, v255
  v_and_b32 v252, 15, v255
  v_lshlrev_b32 v253, 3, v251
  v_xor_b32 v253, v253, v252
  v_lshlrev_b32 v253, 4, v253
  v_lshl_add_u32 v246, v250, 8, v253
  v_lshrrev_b32 v250, 2, v252
  v_lshl_add_u32 v253, v251, 2, v250
  v_lshlrev_b32 v253, 8, v253
  v_bfe_u32 v254, v255, 4, 1
  v_lshlrev_b32 v254, 1, v254
  v_bfe_u32 v251, v255, 1, 1
  v_add_u32 v254, v254, v251
  v_lshl_add_u32 v253, v254, 4, v253
  v_and_b32 v251, 1, v255
  v_lshl_add_u32 v253, v251, 3, v253
  v_add_u32 v244, 0x10000, v253
  v_lshlrev_b32 v245, 6, v250
  s_waitcnt vmcnt(8)
  s_barrier
  v_xor_b32 v236, 0, v246
  v_xor_b32 v237, 16, v246
  v_xor_b32 v238, 32, v246
  v_xor_b32 v239, 48, v246
  v_xor_b32 v240, 64, v246
  v_xor_b32 v241, 80, v246
  v_xor_b32 v242, 96, v246
  v_xor_b32 v243, 112, v246
  ds_read_b128 a[128:131], v236 offset:32768
  ds_read_b128 a[132:135], v237 offset:32768
  ds_read_b128 a[136:139], v238 offset:32768
  ds_read_b128 a[140:143], v239 offset:32768
  ds_read_b128 a[144:147], v240 offset:32768
  ds_read_b128 a[148:151], v241 offset:32768
  ds_read_b128 a[152:155], v242 offset:32768
  ds_read_b128 a[156:159], v243 offset:32768
  s_add_u32 m0, s63, 0
  s_mov_b32 s61, 32768
  buffer_load_dwordx4 v247, s[20:23], s61 offen lds
  buffer_load_dwordx4 v248, s[20:23], s61 offen offset:1024 lds
  s_add_u32 m0, s63, 65536
  s_mov_b32 s62, 24576
  buffer_load_dwordx4 v249, s[24:27], s62 offen lds
  buffer_load_dwordx4 v249, s[24:27], s62 offen offset:1024 lds
  s_lshl_b32 s69, s3, 21
  s_lshl_b32 s6, s4, 16
  s_add_u32 s69, s69, s6
  s_lshl_b32 s6, s5, 8
  s_add_u32 s69, s69, s6
  s_mov_b32 s64, 0x3f803f80
  v_cvt_pk_bf16_f32 v128, v0, v4
  v_cvt_pk_bf16_f32 v129, v8, v12
  v_cvt_pk_bf16_f32 v130, v16, v20
  v_cvt_pk_bf16_f32 v131, v24, v28
  v_cvt_pk_bf16_f32 v132, v1, v5
  v_cvt_pk_bf16_f32 v133, v9, v13
  v_cvt_pk_bf16_f32 v134, v17, v21
  v_cvt_pk_bf16_f32 v135, v25, v29
  v_cvt_pk_bf16_f32 v136, v2, v6
  v_cvt_pk_bf16_f32 v137, v10, v14
  v_cvt_pk_bf16_f32 v138, v18, v22
  v_cvt_pk_bf16_f32 v139, v26, v30
  v_cvt_pk_bf16_f32 v140, v3, v7
  v_cvt_pk_bf16_f32 v141, v11, v15
  v_cvt_pk_bf16_f32 v142, v19, v23
  v_cvt_pk_bf16_f32 v143, v27, v31
  v_cvt_pk_bf16_f32 v144, v32, v36
  v_cvt_pk_bf16_f32 v145, v40, v44
  v_cvt_pk_bf16_f32 v146, v48, v52
  v_cvt_pk_bf16_f32 v147, v56, v60
  v_cvt_pk_bf16_f32 v148, v33, v37
  v_cvt_pk_bf16_f32 v149, v41, v45
  v_cvt_pk_bf16_f32 v150, v49, v53
  v_cvt_pk_bf16_f32 v151, v57, v61
  v_cvt_pk_bf16_f32 v152, v34, v38
  v_cvt_pk_bf16_f32 v153, v42, v46
  v_cvt_pk_bf16_f32 v154, v50, v54
  v_cvt_pk_bf16_f32 v155, v58, v62
  v_cvt_pk_bf16_f32 v156, v35, v39
  v_cvt_pk_bf16_f32 v157, v43, v47
  v_cvt_pk_bf16_f32 v158, v51, v55
  v_cvt_pk_bf16_f32 v159, v59, v63
  v_permlane16_swap_b32 v128, v144
  v_permlane16_swap_b32 v129, v145
  v_permlane16_swap_b32 v130, v146
  v_permlane16_swap_b32 v131, v147
  v_permlane16_swap_b32 v132, v148
  v_permlane16_swap_b32 v133, v149
  v_permlane16_swap_b32 v134, v150
  v_permlane16_swap_b32 v135, v151
  v_permlane16_swap_b32 v136, v152
  v_permlane16_swap_b32 v137, v153
  v_permlane16_swap_b32 v138, v154
  v_permlane16_swap_b32 v139, v155
  v_permlane16_swap_b32 v140, v156
  v_permlane16_swap_b32 v141, v157
  v_permlane16_swap_b32 v142, v158
  v_permlane16_swap_b32 v143, v159
  s_waitcnt lgkmcnt(0)
  s_nop 0
  v_mfma_f32_32x32x16_bf16 v[32:47], a[128:131], v[128:131], 0
  v_cvt_pk_bf16_f32 v0, v64, v68
  v_cvt_pk_bf16_f32 v1, v72, v76
  v_cvt_pk_bf16_f32 v2, v80, v84
  v_cvt_pk_bf16_f32 v3, v88, v92
  v_cvt_pk_bf16_f32 v4, v65, v69
  v_cvt_pk_bf16_f32 v5, v73, v77
  v_cvt_pk_bf16_f32 v6, v81, v85
  v_cvt_pk_bf16_f32 v7, v89, v93
  v_mfma_f32_32x32x16_bf16 v[32:47], a[132:135], v[132:135], v[32:47]
  v_cvt_pk_bf16_f32 v8, v66, v70
  v_cvt_pk_bf16_f32 v9, v74, v78
  v_cvt_pk_bf16_f32 v10, v82, v86
  v_cvt_pk_bf16_f32 v11, v90, v94
  v_cvt_pk_bf16_f32 v12, v67, v71
  v_cvt_pk_bf16_f32 v13, v75, v79
  v_cvt_pk_bf16_f32 v14, v83, v87
  v_cvt_pk_bf16_f32 v15, v91, v95
  v_mfma_f32_32x32x16_bf16 v[32:47], a[136:139], v[136:139], v[32:47]
  v_cvt_pk_bf16_f32 v16, v96, v100
  v_cvt_pk_bf16_f32 v17, v104, v108
  v_cvt_pk_bf16_f32 v18, v112, v116
  v_cvt_pk_bf16_f32 v19, v120, v124
  v_cvt_pk_bf16_f32 v20, v97, v101
  v_cvt_pk_bf16_f32 v21, v105, v109
  v_cvt_pk_bf16_f32 v22, v113, v117
  v_cvt_pk_bf16_f32 v23, v121, v125
  v_mfma_f32_32x32x16_bf16 v[32:47], a[140:143], v[140:143], v[32:47]
  v_cvt_pk_bf16_f32 v24, v98, v102
  v_cvt_pk_bf16_f32 v25, v106, v110
  v_cvt_pk_bf16_f32 v26, v114, v118
  v_cvt_pk_bf16_f32 v27, v122, v126
  v_cvt_pk_bf16_f32 v28, v99, v103
  v_cvt_pk_bf16_f32 v29, v107, v111
  v_cvt_pk_bf16_f32 v30, v115, v119
  v_cvt_pk_bf16_f32 v31, v123, v127
  v_mfma_f32_32x32x16_bf16 v[32:47], a[144:147], v[144:147], v[32:47]
  v_permlane16_swap_b32 v0, v16
  v_permlane16_swap_b32 v1, v17
  v_permlane16_swap_b32 v2, v18
  v_permlane16_swap_b32 v3, v19
  v_mfma_f32_32x32x16_bf16 v[32:47], a[148:151], v[148:151], v[32:47]
  v_permlane16_swap_b32 v4, v20
  v_permlane16_swap_b32 v5, v21
  v_permlane16_swap_b32 v6, v22
  v_permlane16_swap_b32 v7, v23
  v_mfma_f32_32x32x16_bf16 v[32:47], a[152:155], v[152:155], v[32:47]
  v_permlane16_swap_b32 v8, v24
  v_permlane16_swap_b32 v9, v25
  v_permlane16_swap_b32 v10, v26
  v_permlane16_swap_b32 v11, v27
  v_mfma_f32_32x32x16_bf16 v[32:47], a[156:159], v[156:159], v[32:47]
  v_permlane16_swap_b32 v12, v28
  v_permlane16_swap_b32 v13, v29
  v_permlane16_swap_b32 v14, v30
  v_permlane16_swap_b32 v15, v31
  v_mfma_f32_32x32x16_bf16 v[48:63], a[128:131], v[0:3], 0
  v_mov_b32 v80, v236
  v_mov_b32 v81, v237
  v_mov_b32 v82, v238
  v_mov_b32 v83, v239
  v_mov_b32 v84, v240
  v_mov_b32 v85, v241
  v_mov_b32 v86, v242
  v_mov_b32 v87, v243
  v_mfma_f32_32x32x16_bf16 v[48:63], a[132:135], v[4:7], v[48:63]
  v_xor_b32 v88, 0, v245
  v_add_u32 v88, v88, v244
  v_xor_b32 v89, 64, v245
  v_add_u32 v89, v89, v244
  v_xor_b32 v90, 128, v245
  v_add_u32 v90, v90, v244
  v_xor_b32 v91, 192, v245
  v_add_u32 v91, v91, v244
  v_mfma_f32_32x32x16_bf16 v[48:63], a[136:139], v[8:11], v[48:63]
  v_mfma_f32_32x32x16_bf16 v[48:63], a[140:143], v[12:15], v[48:63]
  v_exp_f32 v32, v32
  v_exp_f32 v33, v33
  v_exp_f32 v34, v34
  v_exp_f32 v35, v35
  ds_read_b128 a[128:131], v80 offset:40960
  v_mfma_f32_32x32x16_bf16 v[48:63], a[144:147], v[16:19], v[48:63]
  v_exp_f32 v36, v36
  v_mov_b32 v92, v32
  v_exp_f32 v37, v37
  v_mov_b32 v93, v33
  ds_read_b128 a[132:135], v81 offset:40960
  v_mfma_f32_32x32x16_bf16 v[48:63], a[148:151], v[20:23], v[48:63]
  v_cvt_pk_bf16_f32 v64, v32, v33
  v_exp_f32 v38, v38
  v_add_f32 v92, v92, v34
  v_exp_f32 v39, v39
  ds_read_b128 a[136:139], v82 offset:40960
  v_mfma_f32_32x32x16_bf16 v[48:63], a[152:155], v[24:27], v[48:63]
  v_add_f32 v93, v93, v35
  v_cvt_pk_bf16_f32 v65, v34, v35
  v_exp_f32 v40, v40
  v_add_f32 v92, v92, v36
  ds_read_b128 a[140:143], v83 offset:40960
  v_mfma_f32_32x32x16_bf16 v[48:63], a[156:159], v[28:31], v[48:63]
  v_exp_f32 v41, v41
  v_add_f32 v93, v93, v37
  v_cvt_pk_bf16_f32 v66, v36, v37
  v_exp_f32 v42, v42
  ds_read_b128 a[144:147], v84 offset:40960
  v_add_f32 v92, v92, v38
  v_exp_f32 v43, v43
  v_add_f32 v93, v93, v39
  v_cvt_pk_bf16_f32 v67, v38, v39
  ds_read_b64_tr_b16 a[160:161], v88 offset:32768
  ds_read_b64_tr_b16 a[162:163], v88 offset:34816
  ds_read_b64_tr_b16 a[168:169], v89 offset:32768
  ds_read_b64_tr_b16 a[170:171], v89 offset:34816
  ds_read_b64_tr_b16 a[176:177], v90 offset:32768
  ds_read_b64_tr_b16 a[178:179], v90 offset:34816
  ds_read_b64_tr_b16 a[184:185], v91 offset:32768
  ds_read_b64_tr_b16 a[186:187], v91 offset:34816
  ds_read_b64_tr_b16 a[164:165], v88 offset:36864
  ds_read_b64_tr_b16 a[166:167], v88 offset:38912
  ds_read_b64_tr_b16 a[172:173], v89 offset:36864
  ds_read_b64_tr_b16 a[174:175], v89 offset:38912
  ds_read_b64_tr_b16 a[180:181], v90 offset:36864
  ds_read_b64_tr_b16 a[182:183], v90 offset:38912
  ds_read_b64_tr_b16 a[188:189], v91 offset:36864
  ds_read_b64_tr_b16 a[190:191], v91 offset:38912
  ds_read_b128 a[148:151], v85 offset:40960
  ds_read_b128 a[152:155], v86 offset:40960
  ds_read_b128 a[156:159], v87 offset:40960
  v_exp_f32 v44, v44
  v_add_f32 v92, v92, v40
  v_exp_f32 v45, v45
  v_add_f32 v93, v93, v41
  v_cvt_pk_bf16_f32 v68, v40, v41
  v_exp_f32 v46, v46
  v_add_f32 v92, v92, v42
  v_exp_f32 v47, v47
  v_add_f32 v93, v93, v43
  v_cvt_pk_bf16_f32 v69, v42, v43
  v_add_f32 v92, v92, v44
  v_add_f32 v93, v93, v45
  v_cvt_pk_bf16_f32 v70, v44, v45
  v_add_f32 v92, v92, v46
  v_add_f32 v93, v93, v47
  v_cvt_pk_bf16_f32 v71, v46, v47
  s_waitcnt lgkmcnt(15)
  v_mfma_f32_32x32x16_bf16 v[32:47], a[128:131], v[128:131], 0
  v_exp_f32 v48, v48
  v_exp_f32 v49, v49
  v_exp_f32 v50, v50
  v_mfma_f32_32x32x16_bf16 v[32:47], a[132:135], v[132:135], v[32:47]
  v_exp_f32 v51, v51
  v_exp_f32 v52, v52
  v_mov_b32 v94, v48
  v_mfma_f32_32x32x16_bf16 v[32:47], a[136:139], v[136:139], v[32:47]
  v_exp_f32 v53, v53
  v_mov_b32 v95, v49
  v_cvt_pk_bf16_f32 v72, v48, v49
  v_exp_f32 v54, v54
  v_mfma_f32_32x32x16_bf16 v[32:47], a[140:143], v[140:143], v[32:47]
  v_add_f32 v94, v94, v50
  v_exp_f32 v55, v55
  v_add_f32 v95, v95, v51
  v_cvt_pk_bf16_f32 v73, v50, v51
  s_waitcnt lgkmcnt(0)
  v_mfma_f32_32x32x16_bf16 v[32:47], a[144:147], v[144:147], v[32:47]
  v_exp_f32 v56, v56
  v_add_f32 v94, v94, v52
  v_exp_f32 v57, v57
  v_add_f32 v95, v95, v53
  v_mfma_f32_32x32x16_bf16 v[32:47], a[148:151], v[148:151], v[32:47]
  v_cvt_pk_bf16_f32 v74, v52, v53
  v_exp_f32 v58, v58
  v_add_f32 v94, v94, v54
  v_exp_f32 v59, v59
  v_mfma_f32_32x32x16_bf16 v[32:47], a[152:155], v[152:155], v[32:47]
  v_add_f32 v95, v95, v55
  v_cvt_pk_bf16_f32 v75, v54, v55
  v_exp_f32 v60, v60
  v_add_f32 v94, v94, v56
  v_mfma_f32_32x32x16_bf16 v[32:47], a[156:159], v[156:159], v[32:47]
  v_exp_f32 v61, v61
  v_add_f32 v95, v95, v57
  v_cvt_pk_bf16_f32 v76, v56, v57
  v_exp_f32 v62, v62
  s_waitcnt lgkmcnt(11)
  v_mfma_f32_32x32x16_bf16 a[0:15], a[160:163], v[64:67], 0
  s_add_u32 m0, s63, 8192
  s_mov_b32 s61, 40960
  buffer_load_dwordx4 v247, s[20:23], s61 offen lds
  v_mfma_f32_32x32x16_bf16 a[16:31], a[168:171], v[64:67], 0
  v_add_f32 v94, v94, v58
  buffer_load_dwordx4 v248, s[20:23], s61 offen offset:1024 lds
  v_mfma_f32_32x32x16_bf16 a[32:47], a[176:179], v[64:67], 0
  v_exp_f32 v63, v63
  v_add_f32 v95, v95, v59
  v_cvt_pk_bf16_f32 v77, v58, v59
  s_add_u32 m0, s63, 73728
  s_mov_b32 s62, 32768
  v_mfma_f32_32x32x16_bf16 a[48:63], a[184:187], v[64:67], 0
  v_add_f32 v94, v94, v60
  v_add_f32 v95, v95, v61
  buffer_load_dwordx4 v249, s[24:27], s62 offen lds
  s_waitcnt lgkmcnt(3)
  v_mfma_f32_32x32x16_bf16 a[0:15], a[164:167], v[68:71], a[0:15]
  buffer_load_dwordx4 v249, s[24:27], s62 offen offset:1024 lds
  s_add_u32 m0, s63, 16384
  s_mov_b32 s61, 49152
  v_mfma_f32_32x32x16_bf16 a[16:31], a[172:175], v[68:71], a[16:31]
  v_cvt_pk_bf16_f32 v78, v60, v61
  v_add_f32 v94, v94, v62
  buffer_load_dwordx4 v247, s[20:23], s61 offen lds
  v_mfma_f32_32x32x16_bf16 a[32:47], a[180:183], v[68:71], a[32:47]
  v_add_f32 v95, v95, v63
  buffer_load_dwordx4 v248, s[20:23], s61 offen offset:1024 lds
  v_and_b32 v250, 31, v255
  v_mfma_f32_32x32x16_bf16 a[48:63], a[188:191], v[68:71], a[48:63]
  v_cvt_pk_bf16_f32 v79, v62, v63
  v_lshlrev_b32 v250, 2, v250
  buffer_load_dword a196, v250, s[36:39], 0 offen sc1
  s_waitcnt vmcnt(11)
  s_barrier
  v_mfma_f32_32x32x16_bf16 v[48:63], a[128:131], v[0:3], 0
  v_exp_f32 v32, v32
  s_lshr_b32 s6, s5, 1
  s_lshl_b32 s6, s6, 5
  s_lshl_b32 s7, s3, 6
  s_add_u32 s6, s6, s7
  v_mfma_f32_32x32x16_bf16 v[48:63], a[132:135], v[4:7], v[48:63]
  v_lshrrev_b32 v250, 3, v255
  v_add_u32 v250, s6, v250
  s_movk_i32 s7, 3584
  v_mul_lo_u32 v251, v250, s7
  v_and_b32 v252, 7, v255
  v_mfma_f32_32x32x16_bf16 v[48:63], a[136:139], v[8:11], v[48:63]
  v_exp_f32 v33, v33
  v_lshl_add_u32 v251, v252, 4, v251
  s_min_u32 s7, s4, 27
  s_lshl_b32 s7, s7, 7
  v_add_u32 v251, s7, v251
  v_mfma_f32_32x32x16_bf16 v[48:63], a[140:143], v[12:15], v[48:63]
  v_exp_f32 v34, v34
  s_and_b32 s6, s5, 1
  s_cmp_eq_u32 s6, 0
  s_cselect_b32 s98, s46, s48
  s_cselect_b32 s99, s47, s49
  v_mfma_f32_32x32x16_bf16 v[48:63], a[144:147], v[16:19], v[48:63]
  global_load_dwordx4 a[224:227], v251, s[98:99]
  v_add_u32 v251, 28672, v251
  v_mfma_f32_32x32x16_bf16 v[48:63], a[148:151], v[20:23], v[48:63]
  global_load_dwordx4 a[228:231], v251, s[98:99]
  v_add_u32 v251, 28672, v251
  v_mfma_f32_32x32x16_bf16 v[48:63], a[152:155], v[24:27], v[48:63]
  v_exp_f32 v35, v35
  global_load_dwordx4 a[232:235], v251, s[98:99]
  v_mfma_f32_32x32x16_bf16 v[48:63], a[156:159], v[28:31], v[48:63]
  v_add_u32 v251, 28672, v251
  global_load_dwordx4 a[236:239], v251, s[98:99]
  v_mfma_f32_32x32x16_bf16 a[64:79], a[160:163], v[72:75], 0
  v_exp_f32 v36, v36
  v_add_f32 v92, v92, v32
  ds_read_b128 a[128:131], v80 offset:49152
  v_mfma_f32_32x32x16_bf16 a[80:95], a[168:171], v[72:75], 0
  v_exp_f32 v37, v37
  v_add_f32 v93, v93, v33
  ds_read_b128 a[132:135], v81 offset:49152
  v_mfma_f32_32x32x16_bf16 a[96:111], a[176:179], v[72:75], 0
  v_cvt_pk_bf16_f32 v64, v32, v33
  v_exp_f32 v38, v38
  ds_read_b128 a[136:139], v82 offset:49152
  v_mfma_f32_32x32x16_bf16 a[112:127], a[184:187], v[72:75], 0
  v_add_f32 v92, v92, v34
  v_exp_f32 v39, v39
  ds_read_b128 a[140:143], v83 offset:49152
  v_mfma_f32_32x32x16_bf16 a[64:79], a[164:167], v[76:79], a[64:79]
  v_add_f32 v93, v93, v35
  v_cvt_pk_bf16_f32 v65, v34, v35
  ds_read_b128 a[144:147], v84 offset:49152
  v_mfma_f32_32x32x16_bf16 a[80:95], a[172:175], v[76:79], a[80:95]
  v_exp_f32 v40, v40
  v_add_f32 v92, v92, v36
  ds_read_b128 a[148:151], v85 offset:49152
  v_mfma_f32_32x32x16_bf16 a[96:111], a[180:183], v[76:79], a[96:111]
  v_exp_f32 v41, v41
  v_add_f32 v93, v93, v37
  ds_read_b128 a[152:155], v86 offset:49152
  v_mfma_f32_32x32x16_bf16 a[112:127], a[188:191], v[76:79], a[112:127]
  v_cvt_pk_bf16_f32 v66, v36, v37
  v_exp_f32 v42, v42
  v_add_f32 v92, v92, v38
  v_exp_f32 v43, v43
  v_add_f32 v93, v93, v39
  v_cvt_pk_bf16_f32 v67, v38, v39
  v_exp_f32 v44, v44
  v_add_f32 v92, v92, v40
  v_exp_f32 v45, v45
  v_add_f32 v93, v93, v41
  v_cvt_pk_bf16_f32 v68, v40, v41
  v_exp_f32 v46, v46
  v_add_f32 v92, v92, v42
  v_exp_f32 v47, v47
  v_add_f32 v93, v93, v43
  v_cvt_pk_bf16_f32 v69, v42, v43
  v_add_f32 v92, v92, v44
  v_add_f32 v93, v93, v45
  v_cvt_pk_bf16_f32 v70, v44, v45
  v_add_f32 v92, v92, v46
  v_add_f32 v93, v93, v47
  v_cvt_pk_bf16_f32 v71, v46, v47
  ds_read_b128 a[156:159], v87 offset:49152
  s_waitcnt lgkmcnt(4)
  v_mfma_f32_32x32x16_bf16 v[32:47], a[128:131], v[128:131], 0
  v_exp_f32 v48, v48
  ds_read_b64_tr_b16 a[160:161], v88 offset:40960
  ds_read_b64_tr_b16 a[162:163], v88 offset:43008
  v_mfma_f32_32x32x16_bf16 v[32:47], a[132:135], v[132:135], v[32:47]
  v_exp_f32 v49, v49
  ds_read_b64_tr_b16 a[168:169], v89 offset:40960
  ds_read_b64_tr_b16 a[170:171], v89 offset:43008
  v_mfma_f32_32x32x16_bf16 v[32:47], a[136:139], v[136:139], v[32:47]
  v_exp_f32 v50, v50
  ds_read_b64_tr_b16 a[176:177], v90 offset:40960
  ds_read_b64_tr_b16 a[178:179], v90 offset:43008
  v_mfma_f32_32x32x16_bf16 v[32:47], a[140:143], v[140:143], v[32:47]
  v_exp_f32 v51, v51
  ds_read_b64_tr_b16 a[184:185], v91 offset:40960
  ds_read_b64_tr_b16 a[186:187], v91 offset:43008
  s_waitcnt lgkmcnt(8)
  v_mfma_f32_32x32x16_bf16 v[32:47], a[144:147], v[144:147], v[32:47]
  v_exp_f32 v52, v52
  ds_read_b64_tr_b16 a[164:165], v88 offset:45056
  ds_read_b64_tr_b16 a[166:167], v88 offset:47104
  v_mfma_f32_32x32x16_bf16 v[32:47], a[148:151], v[148:151], v[32:47]
  v_add_f32 v94, v94, v48
  ds_read_b64_tr_b16 a[172:173], v89 offset:45056
  ds_read_b64_tr_b16 a[174:175], v89 offset:47104
  v_mfma_f32_32x32x16_bf16 v[32:47], a[152:155], v[152:155], v[32:47]
  v_exp_f32 v53, v53
  ds_read_b64_tr_b16 a[180:181], v90 offset:45056
  ds_read_b64_tr_b16 a[182:183], v90 offset:47104
  v_mfma_f32_32x32x16_bf16 v[32:47], a[156:159], v[156:159], v[32:47]
  v_add_f32 v95, v95, v49
  v_cvt_pk_bf16_f32 v72, v48, v49
  ds_read_b64_tr_b16 a[188:189], v91 offset:45056
  ds_read_b64_tr_b16 a[190:191], v91 offset:47104
  s_waitcnt lgkmcnt(8)
  v_mfma_f32_32x32x16_bf16 a[0:15], a[160:163], v[64:67], a[0:15]
  s_add_u32 m0, s63, 81920
  s_mov_b32 s62, 40960
  buffer_load_dwordx4 v249, s[24:27], s62 offen lds
  v_mfma_f32_32x32x16_bf16 a[16:31], a[168:171], v[64:67], a[16:31]
  v_exp_f32 v54, v54
  buffer_load_dwordx4 v249, s[24:27], s62 offen offset:1024 lds
  v_mfma_f32_32x32x16_bf16 a[32:47], a[176:179], v[64:67], a[32:47]
  v_add_f32 v94, v94, v50
  v_exp_f32 v55, v55
  v_add_f32 v95, v95, v51
  s_add_u32 m0, s63, 24576
  s_mov_b32 s61, 57344
  v_mfma_f32_32x32x16_bf16 a[48:63], a[184:187], v[64:67], a[48:63]
  buffer_load_dwordx4 v247, s[20:23], s61 offen lds
  buffer_load_dwordx4 v248, s[20:23], s61 offen offset:1024 lds
  s_waitcnt lgkmcnt(0)
  v_mfma_f32_32x32x16_bf16 a[0:15], a[164:167], v[68:71], a[0:15]
  v_cvt_pk_bf16_f32 v73, v50, v51
  v_exp_f32 v56, v56
  v_add_f32 v94, v94, v52
  s_add_u32 m0, s63, 90112
  s_mov_b32 s62, 49152
  v_mfma_f32_32x32x16_bf16 a[16:31], a[172:175], v[68:71], a[16:31]
  v_exp_f32 v57, v57
  buffer_load_dwordx4 v249, s[24:27], s62 offen lds
  v_mfma_f32_32x32x16_bf16 a[32:47], a[180:183], v[68:71], a[32:47]
  buffer_load_dwordx4 v249, s[24:27], s62 offen offset:1024 lds
  s_waitcnt vmcnt(10)
  v_accvgpr_read_b32 v120, a196
  v_mfma_f32_32x32x16_bf16 a[48:63], a[188:191], v[68:71], a[48:63]
  v_add_f32 v95, v95, v53
  v_cvt_pk_bf16_f32 v74, v52, v53
  v_exp_f32 v58, v58
  v_add_f32 v94, v94, v54
  v_exp_f32 v59, v59
  v_add_f32 v95, v95, v55
  v_cvt_pk_bf16_f32 v75, v54, v55
  v_exp_f32 v60, v60
  v_add_f32 v94, v94, v56
  v_exp_f32 v61, v61
  v_add_f32 v95, v95, v57
  v_cvt_pk_bf16_f32 v76, v56, v57
  v_exp_f32 v62, v62
  v_add_f32 v94, v94, v58
  v_exp_f32 v63, v63
  v_add_f32 v95, v95, v59
  v_cvt_pk_bf16_f32 v77, v58, v59
  v_add_f32 v94, v94, v60
  v_add_f32 v95, v95, v61
  v_cvt_pk_bf16_f32 v78, v60, v61
  v_add_f32 v94, v94, v62
  v_add_f32 v95, v95, v63
  v_cvt_pk_bf16_f32 v79, v62, v63
  s_nop 0
  v_cmp_eq_u32 vcc, 0, v120
  s_nop 4
  s_cbranch_vccnz L_keyspin
  L_keyok:
  v_max_u32_dpp v120, v120, v120 row_ror:1 row_mask:0xf bank_mask:0xf
  v_mfma_f32_32x32x16_bf16 v[48:63], a[128:131], v[0:3], 0
  s_nop 1
  v_max_u32_dpp v120, v120, v120 row_ror:2 row_mask:0xf bank_mask:0xf
  s_nop 1
  v_max_u32_dpp v120, v120, v120 row_ror:4 row_mask:0xf bank_mask:0xf
  s_nop 1
  v_mfma_f32_32x32x16_bf16 v[48:63], a[132:135], v[4:7], v[48:63]
  v_max_u32_dpp v120, v120, v120 row_ror:8 row_mask:0xf bank_mask:0xf
  s_nop 0
  v_readlane_b32 s6, v120, 0
  v_readlane_b32 s7, v120, 16
  v_lshrrev_b32 v250, 3, v255
  v_lshlrev_b32 v250, 1, v250
  v_mfma_f32_32x32x16_bf16 v[48:63], a[136:139], v[8:11], v[48:63]
  v_mov_b32 v251, 0
  s_max_u32 s68, s6, s7
  s_bfe_u32 s67, s68, 0xb0001
  s_sub_u32 s67, 2047, s67
  s_lshl_b32 s6, s67, 10
  v_mfma_f32_32x32x16_bf16 v[48:63], a[140:143], v[12:15], v[48:63]
  s_lshr_b32 s7, s5, 1
  s_lshl_b32 s7, s7, 6
  s_add_u32 s6, s6, s7
  s_lshl_b32 s7, s3, 7
  s_add_u32 s6, s6, s7
  v_mfma_f32_32x32x16_bf16 v[48:63], a[144:147], v[16:19], v[48:63]
  s_lshl_b32 s7, s67, 3
  s_add_u32 s7, s7, 16777216
  buffer_load_ushort a192, v250, s[8:11], s6 offen offset:0
  v_mfma_f32_32x32x16_bf16 v[48:63], a[148:151], v[20:23], v[48:63]
  v_exp_f32 v32, v32
  buffer_load_ushort a193, v250, s[8:11], s6 offen offset:16
  v_mfma_f32_32x32x16_bf16 v[48:63], a[152:155], v[24:27], v[48:63]
  buffer_load_ushort a194, v250, s[8:11], s6 offen offset:32
  buffer_load_ushort a195, v250, s[8:11], s6 offen offset:48
  v_mfma_f32_32x32x16_bf16 v[48:63], a[156:159], v[28:31], v[48:63]
  v_exp_f32 v33, v33
  buffer_load_dwordx2 a[198:199], v251, s[28:31], s7 offen sc1
  v_mfma_f32_32x32x16_bf16 a[64:79], a[160:163], v[72:75], a[64:79]
  v_exp_f32 v34, v34
  ds_read_b128 a[128:131], v80 offset:57344
  v_mfma_f32_32x32x16_bf16 a[80:95], a[168:171], v[72:75], a[80:95]
  v_exp_f32 v35, v35
  ds_read_b128 a[132:135], v81 offset:57344
  v_mfma_f32_32x32x16_bf16 a[96:111], a[176:179], v[72:75], a[96:111]
  v_exp_f32 v36, v36
  v_add_f32 v92, v92, v32
  ds_read_b128 a[136:139], v82 offset:57344
  v_mfma_f32_32x32x16_bf16 a[112:127], a[184:187], v[72:75], a[112:127]
  v_exp_f32 v37, v37
  v_add_f32 v93, v93, v33
  ds_read_b128 a[140:143], v83 offset:57344
  v_mfma_f32_32x32x16_bf16 a[64:79], a[164:167], v[76:79], a[64:79]
  v_cvt_pk_bf16_f32 v64, v32, v33
  v_exp_f32 v38, v38
  ds_read_b128 a[144:147], v84 offset:57344
  v_mfma_f32_32x32x16_bf16 a[80:95], a[172:175], v[76:79], a[80:95]
  v_add_f32 v92, v92, v34
  v_exp_f32 v39, v39
  ds_read_b128 a[148:151], v85 offset:57344
  v_mfma_f32_32x32x16_bf16 a[96:111], a[180:183], v[76:79], a[96:111]
  v_add_f32 v93, v93, v35
  v_cvt_pk_bf16_f32 v65, v34, v35
  ds_read_b128 a[152:155], v86 offset:57344
  v_mfma_f32_32x32x16_bf16 a[112:127], a[188:191], v[76:79], a[112:127]
  v_exp_f32 v40, v40
  v_add_f32 v92, v92, v36
  v_exp_f32 v41, v41
  v_add_f32 v93, v93, v37
  v_cvt_pk_bf16_f32 v66, v36, v37
  v_exp_f32 v42, v42
  v_add_f32 v92, v92, v38
  v_exp_f32 v43, v43
  v_add_f32 v93, v93, v39
  v_cvt_pk_bf16_f32 v67, v38, v39
  v_exp_f32 v44, v44
  v_add_f32 v92, v92, v40
  v_exp_f32 v45, v45
  v_add_f32 v93, v93, v41
  v_cvt_pk_bf16_f32 v68, v40, v41
  v_exp_f32 v46, v46
  v_add_f32 v92, v92, v42
  v_exp_f32 v47, v47
  v_add_f32 v93, v93, v43
  v_cvt_pk_bf16_f32 v69, v42, v43
  v_add_f32 v92, v92, v44
  v_add_f32 v93, v93, v45
  v_cvt_pk_bf16_f32 v70, v44, v45
  v_add_f32 v92, v92, v46
  v_add_f32 v93, v93, v47
  v_cvt_pk_bf16_f32 v71, v46, v47
  ds_read_b128 a[156:159], v87 offset:57344
  s_waitcnt lgkmcnt(4)
  v_mfma_f32_32x32x16_bf16 v[32:47], a[128:131], v[128:131], 0
  v_exp_f32 v48, v48
  ds_read_b64_tr_b16 a[160:161], v88 offset:49152
  ds_read_b64_tr_b16 a[162:163], v88 offset:51200
  v_mfma_f32_32x32x16_bf16 v[32:47], a[132:135], v[132:135], v[32:47]
  v_exp_f32 v49, v49
  ds_read_b64_tr_b16 a[168:169], v89 offset:49152
  ds_read_b64_tr_b16 a[170:171], v89 offset:51200
  v_mfma_f32_32x32x16_bf16 v[32:47], a[136:139], v[136:139], v[32:47]
  v_exp_f32 v50, v50
  ds_read_b64_tr_b16 a[176:177], v90 offset:49152
  ds_read_b64_tr_b16 a[178:179], v90 offset:51200
  v_mfma_f32_32x32x16_bf16 v[32:47], a[140:143], v[140:143], v[32:47]
  v_exp_f32 v51, v51
  ds_read_b64_tr_b16 a[184:185], v91 offset:49152
  ds_read_b64_tr_b16 a[186:187], v91 offset:51200
  s_waitcnt lgkmcnt(8)
  v_mfma_f32_32x32x16_bf16 v[32:47], a[144:147], v[144:147], v[32:47]
  v_exp_f32 v52, v52
  ds_read_b64_tr_b16 a[164:165], v88 offset:53248
  ds_read_b64_tr_b16 a[166:167], v88 offset:55296
  v_mfma_f32_32x32x16_bf16 v[32:47], a[148:151], v[148:151], v[32:47]
  v_add_f32 v94, v94, v48
  ds_read_b64_tr_b16 a[172:173], v89 offset:53248
  ds_read_b64_tr_b16 a[174:175], v89 offset:55296
  v_mfma_f32_32x32x16_bf16 v[32:47], a[152:155], v[152:155], v[32:47]
  v_exp_f32 v53, v53
  ds_read_b64_tr_b16 a[180:181], v90 offset:53248
  ds_read_b64_tr_b16 a[182:183], v90 offset:55296
  v_mfma_f32_32x32x16_bf16 v[32:47], a[156:159], v[156:159], v[32:47]
  v_add_f32 v95, v95, v49
  v_cvt_pk_bf16_f32 v72, v48, v49
  ds_read_b64_tr_b16 a[188:189], v91 offset:53248
  ds_read_b64_tr_b16 a[190:191], v91 offset:55296
  s_waitcnt lgkmcnt(8)
  v_mfma_f32_32x32x16_bf16 a[0:15], a[160:163], v[64:67], a[0:15]
  v_exp_f32 v54, v54
  v_add_f32 v94, v94, v50
  v_exp_f32 v55, v55
  v_add_f32 v95, v95, v51
  v_mfma_f32_32x32x16_bf16 a[16:31], a[168:171], v[64:67], a[16:31]
  v_cvt_pk_bf16_f32 v73, v50, v51
  v_exp_f32 v56, v56
  v_add_f32 v94, v94, v52
  v_exp_f32 v57, v57
  v_mfma_f32_32x32x16_bf16 a[32:47], a[176:179], v[64:67], a[32:47]
  v_add_f32 v95, v95, v53
  v_cvt_pk_bf16_f32 v74, v52, v53
  v_exp_f32 v58, v58
  v_mfma_f32_32x32x16_bf16 a[48:63], a[184:187], v[64:67], a[48:63]
  v_add_f32 v94, v94, v54
  v_exp_f32 v59, v59
  v_add_f32 v95, v95, v55
  v_cvt_pk_bf16_f32 v75, v54, v55
  s_waitcnt lgkmcnt(0)
  v_mfma_f32_32x32x16_bf16 a[0:15], a[164:167], v[68:71], a[0:15]
  v_exp_f32 v60, v60
  v_add_f32 v94, v94, v56
  v_exp_f32 v61, v61
  v_mfma_f32_32x32x16_bf16 a[16:31], a[172:175], v[68:71], a[16:31]
  v_add_f32 v95, v95, v57
  v_cvt_pk_bf16_f32 v76, v56, v57
  v_exp_f32 v62, v62
  v_add_f32 v94, v94, v58
  v_mfma_f32_32x32x16_bf16 a[32:47], a[180:183], v[68:71], a[32:47]
  v_exp_f32 v63, v63
  v_add_f32 v95, v95, v59
  v_cvt_pk_bf16_f32 v77, v58, v59
  v_add_f32 v94, v94, v60
  v_mfma_f32_32x32x16_bf16 a[48:63], a[188:191], v[68:71], a[48:63]
  v_add_f32 v95, v95, v61
  v_cvt_pk_bf16_f32 v78, v60, v61
  v_add_f32 v94, v94, v62
  v_add_f32 v95, v95, v63
  v_cvt_pk_bf16_f32 v79, v62, v63
  s_waitcnt vmcnt(5)
  s_barrier
  v_mfma_f32_32x32x16_bf16 v[48:63], a[128:131], v[0:3], 0
  v_exp_f32 v32, v32
  v_exp_f32 v33, v33
  v_mfma_f32_32x32x16_bf16 v[48:63], a[132:135], v[4:7], v[48:63]
  v_exp_f32 v34, v34
  v_exp_f32 v35, v35
  v_exp_f32 v36, v36
  v_mfma_f32_32x32x16_bf16 v[48:63], a[136:139], v[8:11], v[48:63]
  v_add_f32 v92, v92, v32
  v_exp_f32 v37, v37
  v_add_f32 v93, v93, v33
  v_mfma_f32_32x32x16_bf16 v[48:63], a[140:143], v[12:15], v[48:63]
  v_cvt_pk_bf16_f32 v64, v32, v33
  v_exp_f32 v38, v38
  v_add_f32 v92, v92, v34
  v_mfma_f32_32x32x16_bf16 v[48:63], a[144:147], v[16:19], v[48:63]
  v_exp_f32 v39, v39
  v_add_f32 v93, v93, v35
  v_cvt_pk_bf16_f32 v65, v34, v35
  v_exp_f32 v40, v40
  v_mfma_f32_32x32x16_bf16 v[48:63], a[148:151], v[20:23], v[48:63]
  v_add_f32 v92, v92, v36
  v_exp_f32 v41, v41
  v_add_f32 v93, v93, v37
  v_mfma_f32_32x32x16_bf16 v[48:63], a[152:155], v[24:27], v[48:63]
  v_cvt_pk_bf16_f32 v66, v36, v37
  v_exp_f32 v42, v42
  v_add_f32 v92, v92, v38
  v_mfma_f32_32x32x16_bf16 v[48:63], a[156:159], v[28:31], v[48:63]
  v_exp_f32 v43, v43
  v_add_f32 v93, v93, v39
  v_cvt_pk_bf16_f32 v67, v38, v39
  v_exp_f32 v44, v44
  v_mfma_f32_32x32x16_bf16 a[64:79], a[160:163], v[72:75], a[64:79]
  v_add_f32 v92, v92, v40
  ds_read_b128 a[128:131], v80 offset:0
  v_mfma_f32_32x32x16_bf16 a[80:95], a[168:171], v[72:75], a[80:95]
  v_exp_f32 v45, v45
  v_add_f32 v93, v93, v41
  ds_read_b128 a[132:135], v81 offset:0
  v_mfma_f32_32x32x16_bf16 a[96:111], a[176:179], v[72:75], a[96:111]
  v_cvt_pk_bf16_f32 v68, v40, v41
  v_exp_f32 v46, v46
  ds_read_b128 a[136:139], v82 offset:0
  v_mfma_f32_32x32x16_bf16 a[112:127], a[184:187], v[72:75], a[112:127]
  v_add_f32 v92, v92, v42
  ds_read_b128 a[140:143], v83 offset:0
  v_mfma_f32_32x32x16_bf16 a[64:79], a[164:167], v[76:79], a[64:79]
  v_exp_f32 v47, v47
  v_add_f32 v93, v93, v43
  ds_read_b128 a[144:147], v84 offset:0
  v_mfma_f32_32x32x16_bf16 a[80:95], a[172:175], v[76:79], a[80:95]
  v_cvt_pk_bf16_f32 v69, v42, v43
  v_add_f32 v92, v92, v44
  ds_read_b128 a[148:151], v85 offset:0
  v_mfma_f32_32x32x16_bf16 a[96:111], a[180:183], v[76:79], a[96:111]
  v_add_f32 v93, v93, v45
  v_cvt_pk_bf16_f32 v70, v44, v45
  v_add_f32 v92, v92, v46
  ds_read_b128 a[152:155], v86 offset:0
  v_mfma_f32_32x32x16_bf16 a[112:127], a[188:191], v[76:79], a[112:127]
  v_add_f32 v93, v93, v47
  v_cvt_pk_bf16_f32 v71, v46, v47
  ds_read_b128 a[156:159], v87 offset:0
  s_waitcnt lgkmcnt(4)
  v_mfma_f32_32x32x16_bf16 v[32:47], a[128:131], v[128:131], 0
  v_exp_f32 v48, v48
  ds_read_b64_tr_b16 a[160:161], v88 offset:0
  ds_read_b64_tr_b16 a[162:163], v88 offset:2048
  v_mfma_f32_32x32x16_bf16 v[32:47], a[132:135], v[132:135], v[32:47]
  v_exp_f32 v49, v49
  ds_read_b64_tr_b16 a[168:169], v89 offset:0
  ds_read_b64_tr_b16 a[170:171], v89 offset:2048
  v_mfma_f32_32x32x16_bf16 v[32:47], a[136:139], v[136:139], v[32:47]
  v_exp_f32 v50, v50
  ds_read_b64_tr_b16 a[176:177], v90 offset:0
  ds_read_b64_tr_b16 a[178:179], v90 offset:2048
  v_mfma_f32_32x32x16_bf16 v[32:47], a[140:143], v[140:143], v[32:47]
  v_exp_f32 v51, v51
  ds_read_b64_tr_b16 a[184:185], v91 offset:0
  ds_read_b64_tr_b16 a[186:187], v91 offset:2048
  s_waitcnt lgkmcnt(8)
  v_mfma_f32_32x32x16_bf16 v[32:47], a[144:147], v[144:147], v[32:47]
  v_exp_f32 v52, v52
  ds_read_b64_tr_b16 a[164:165], v88 offset:4096
  ds_read_b64_tr_b16 a[166:167], v88 offset:6144
  v_mfma_f32_32x32x16_bf16 v[32:47], a[148:151], v[148:151], v[32:47]
  v_add_f32 v94, v94, v48
  ds_read_b64_tr_b16 a[172:173], v89 offset:4096
  ds_read_b64_tr_b16 a[174:175], v89 offset:6144
  v_mfma_f32_32x32x16_bf16 v[32:47], a[152:155], v[152:155], v[32:47]
  v_exp_f32 v53, v53
  ds_read_b64_tr_b16 a[180:181], v90 offset:4096
  ds_read_b64_tr_b16 a[182:183], v90 offset:6144
  v_mfma_f32_32x32x16_bf16 v[32:47], a[156:159], v[156:159], v[32:47]
  v_add_f32 v95, v95, v49
  v_cvt_pk_bf16_f32 v72, v48, v49
  ds_read_b64_tr_b16 a[188:189], v91 offset:4096
  ds_read_b64_tr_b16 a[190:191], v91 offset:6144
  s_waitcnt lgkmcnt(8)
  v_mfma_f32_32x32x16_bf16 a[0:15], a[160:163], v[64:67], a[0:15]
  v_exp_f32 v54, v54
  v_add_f32 v94, v94, v50
  s_add_u32 m0, s63, 32768
  s_mov_b32 s61, 65536
  v_mfma_f32_32x32x16_bf16 a[16:31], a[168:171], v[64:67], a[16:31]
  v_exp_f32 v55, v55
  buffer_load_dwordx4 v247, s[20:23], s61 offen lds
  v_mfma_f32_32x32x16_bf16 a[32:47], a[176:179], v[64:67], a[32:47]
  v_add_f32 v95, v95, v51
  buffer_load_dwordx4 v248, s[20:23], s61 offen offset:1024 lds
  s_add_u32 m0, s63, 98304
  v_mfma_f32_32x32x16_bf16 a[48:63], a[184:187], v[64:67], a[48:63]
  v_cvt_pk_bf16_f32 v73, v50, v51
  s_mov_b32 s62, 57344
  buffer_load_dwordx4 v249, s[24:27], s62 offen lds
  s_waitcnt lgkmcnt(0)
  v_mfma_f32_32x32x16_bf16 a[0:15], a[164:167], v[68:71], a[0:15]
  v_exp_f32 v56, v56
  buffer_load_dwordx4 v249, s[24:27], s62 offen offset:1024 lds
  v_mfma_f32_32x32x16_bf16 a[16:31], a[172:175], v[68:71], a[16:31]
  v_add_f32 v94, v94, v52
  v_exp_f32 v57, v57
  v_add_f32 v95, v95, v53
  s_add_u32 m0, s63, 40960
  s_mov_b32 s61, 73728
  v_mfma_f32_32x32x16_bf16 a[32:47], a[180:183], v[68:71], a[32:47]
  v_cvt_pk_bf16_f32 v74, v52, v53
  buffer_load_dwordx4 v247, s[20:23], s61 offen lds
  v_mfma_f32_32x32x16_bf16 a[48:63], a[188:191], v[68:71], a[48:63]
  v_exp_f32 v58, v58
  v_add_f32 v94, v94, v54
  v_exp_f32 v59, v59
  v_add_f32 v95, v95, v55
  v_cvt_pk_bf16_f32 v75, v54, v55
  v_exp_f32 v60, v60
  v_add_f32 v94, v94, v56
  v_exp_f32 v61, v61
  v_add_f32 v95, v95, v57
  v_cvt_pk_bf16_f32 v76, v56, v57
  v_exp_f32 v62, v62
  v_add_f32 v94, v94, v58
  v_exp_f32 v63, v63
  v_add_f32 v95, v95, v59
  v_cvt_pk_bf16_f32 v77, v58, v59
  v_add_f32 v94, v94, v60
  v_add_f32 v95, v95, v61
  v_cvt_pk_bf16_f32 v78, v60, v61
  v_add_f32 v94, v94, v62
  v_add_f32 v95, v95, v63
  v_cvt_pk_bf16_f32 v79, v62, v63
  buffer_load_dwordx4 v248, s[20:23], s61 offen offset:1024 lds
  v_mfma_f32_32x32x16_bf16 v[48:63], a[128:131], v[0:3], 0
  s_waitcnt vmcnt(6)
  v_accvgpr_read_b32 v162, a198
  v_accvgpr_read_b32 v163, a199
  v_accvgpr_read_b32 v164, a192
  v_accvgpr_read_b32 v165, a193
  v_mfma_f32_32x32x16_bf16 v[48:63], a[132:135], v[4:7], v[48:63]
  v_accvgpr_read_b32 v166, a194
  v_accvgpr_read_b32 v167, a195
  v_lshlrev_b32 v164, 16, v164
  v_lshlrev_b32 v165, 16, v165
  v_lshlrev_b32 v166, 16, v166
  v_mfma_f32_32x32x16_bf16 v[48:63], a[136:139], v[8:11], v[48:63]
  v_exp_f32 v32, v32
  v_lshlrev_b32 v167, 16, v167
  v_sub_f32 v164, v164, v162
  v_sub_f32 v165, v165, v162
  v_sub_f32 v166, v166, v162
  v_mfma_f32_32x32x16_bf16 v[48:63], a[140:143], v[12:15], v[48:63]
  v_exp_f32 v33, v33
  v_sub_f32 v167, v167, v162
  v_cvt_pk_bf16_f32 v164, v164, v165
  v_cvt_pk_bf16_f32 v166, v166, v167
  v_and_b32 v165, s65, v164
  v_mfma_f32_32x32x16_bf16 v[48:63], a[144:147], v[16:19], v[48:63]
  v_and_b32 v167, s65, v166
  v_lshlrev_b32 v164, 16, v164
  v_lshlrev_b32 v166, 16, v166
  v_mul_f32 v164, v164, v163
  v_mul_f32 v165, v165, v163
  v_mfma_f32_32x32x16_bf16 v[48:63], a[148:151], v[20:23], v[48:63]
  v_exp_f32 v34, v34
  v_mul_f32 v166, v166, v163
  v_mul_f32 v167, v167, v163
  v_cvt_pk_bf16_f32 v160, v164, v165
  v_cvt_pk_bf16_f32 v161, v166, v167
  v_mfma_f32_32x32x16_bf16 v[48:63], a[152:155], v[24:27], v[48:63]
  v_accvgpr_read_b32 v168, a224
  v_accvgpr_read_b32 v169, a225
  v_accvgpr_read_b32 v170, a226
  v_accvgpr_read_b32 v171, a227
  v_accvgpr_read_b32 v172, a228
  v_mfma_f32_32x32x16_bf16 v[48:63], a[156:159], v[28:31], v[48:63]
  v_exp_f32 v35, v35
  v_accvgpr_read_b32 v173, a229
  v_accvgpr_read_b32 v174, a230
  v_accvgpr_read_b32 v175, a231
  v_accvgpr_read_b32 v176, a232
  v_mfma_f32_32x32x16_bf16 a[64:79], a[160:163], v[72:75], a[64:79]
  v_exp_f32 v36, v36
  v_add_f32 v92, v92, v32
  ds_read_b128 a[128:131], v80 offset:8192
  v_mfma_f32_32x32x16_bf16 a[80:95], a[168:171], v[72:75], a[80:95]
  v_exp_f32 v37, v37
  v_add_f32 v93, v93, v33
  ds_read_b128 a[132:135], v81 offset:8192
  v_mfma_f32_32x32x16_bf16 a[96:111], a[176:179], v[72:75], a[96:111]
  v_cvt_pk_bf16_f32 v64, v32, v33
  v_exp_f32 v38, v38
  ds_read_b128 a[136:139], v82 offset:8192
  v_mfma_f32_32x32x16_bf16 a[112:127], a[184:187], v[72:75], a[112:127]
  v_add_f32 v92, v92, v34
  v_exp_f32 v39, v39
  ds_read_b128 a[140:143], v83 offset:8192
  v_mfma_f32_32x32x16_bf16 a[64:79], a[164:167], v[76:79], a[64:79]
  v_add_f32 v93, v93, v35
  v_cvt_pk_bf16_f32 v65, v34, v35
  ds_read_b128 a[144:147], v84 offset:8192
  v_mfma_f32_32x32x16_bf16 a[80:95], a[172:175], v[76:79], a[80:95]
  v_exp_f32 v40, v40
  v_add_f32 v92, v92, v36
  ds_read_b128 a[148:151], v85 offset:8192
  v_mfma_f32_32x32x16_bf16 a[96:111], a[180:183], v[76:79], a[96:111]
  v_exp_f32 v41, v41
  v_add_f32 v93, v93, v37
  ds_read_b128 a[152:155], v86 offset:8192
  v_mfma_f32_32x32x16_bf16 a[112:127], a[188:191], v[76:79], a[112:127]
  v_cvt_pk_bf16_f32 v66, v36, v37
  v_exp_f32 v42, v42
  v_add_f32 v92, v92, v38
  v_exp_f32 v43, v43
  v_add_f32 v93, v93, v39
  v_cvt_pk_bf16_f32 v67, v38, v39
  v_exp_f32 v44, v44
  v_add_f32 v92, v92, v40
  v_exp_f32 v45, v45
  v_add_f32 v93, v93, v41
  v_cvt_pk_bf16_f32 v68, v40, v41
  v_exp_f32 v46, v46
  v_add_f32 v92, v92, v42
  v_exp_f32 v47, v47
  v_add_f32 v93, v93, v43
  v_cvt_pk_bf16_f32 v69, v42, v43
  v_add_f32 v92, v92, v44
  v_add_f32 v93, v93, v45
  v_cvt_pk_bf16_f32 v70, v44, v45
  v_add_f32 v92, v92, v46
  v_add_f32 v93, v93, v47
  v_cvt_pk_bf16_f32 v71, v46, v47
  ds_read_b128 a[156:159], v87 offset:8192
  s_waitcnt lgkmcnt(4)
  v_mfma_f32_32x32x16_bf16 v[32:47], a[128:131], v[128:131], 0
  v_exp_f32 v48, v48
  ds_read_b64_tr_b16 a[160:161], v88 offset:8192
  ds_read_b64_tr_b16 a[162:163], v88 offset:10240
  v_mfma_f32_32x32x16_bf16 v[32:47], a[132:135], v[132:135], v[32:47]
  v_exp_f32 v49, v49
  ds_read_b64_tr_b16 a[168:169], v89 offset:8192
  ds_read_b64_tr_b16 a[170:171], v89 offset:10240
  v_mfma_f32_32x32x16_bf16 v[32:47], a[136:139], v[136:139], v[32:47]
  v_exp_f32 v50, v50
  ds_read_b64_tr_b16 a[176:177], v90 offset:8192
  ds_read_b64_tr_b16 a[178:179], v90 offset:10240
  v_mfma_f32_32x32x16_bf16 v[32:47], a[140:143], v[140:143], v[32:47]
  v_exp_f32 v51, v51
  ds_read_b64_tr_b16 a[184:185], v91 offset:8192
  ds_read_b64_tr_b16 a[186:187], v91 offset:10240
  s_waitcnt lgkmcnt(8)
  v_mfma_f32_32x32x16_bf16 v[32:47], a[144:147], v[144:147], v[32:47]
  v_exp_f32 v52, v52
  ds_read_b64_tr_b16 a[164:165], v88 offset:12288
  ds_read_b64_tr_b16 a[166:167], v88 offset:14336
  v_mfma_f32_32x32x16_bf16 v[32:47], a[148:151], v[148:151], v[32:47]
  v_add_f32 v94, v94, v48
  ds_read_b64_tr_b16 a[172:173], v89 offset:12288
  ds_read_b64_tr_b16 a[174:175], v89 offset:14336
  v_mfma_f32_32x32x16_bf16 v[32:47], a[152:155], v[152:155], v[32:47]
  v_exp_f32 v53, v53
  ds_read_b64_tr_b16 a[180:181], v90 offset:12288
  ds_read_b64_tr_b16 a[182:183], v90 offset:14336
  v_mfma_f32_32x32x16_bf16 v[32:47], a[156:159], v[156:159], v[32:47]
  v_add_f32 v95, v95, v49
  v_cvt_pk_bf16_f32 v72, v48, v49
  ds_read_b64_tr_b16 a[188:189], v91 offset:12288
  ds_read_b64_tr_b16 a[190:191], v91 offset:14336
  s_waitcnt lgkmcnt(8)
  v_mfma_f32_32x32x16_bf16 a[0:15], a[160:163], v[64:67], a[0:15]
  v_exp_f32 v54, v54
  v_add_f32 v94, v94, v50
  s_add_u32 m0, s63, 106496
  s_mov_b32 s62, 65536
  v_mfma_f32_32x32x16_bf16 a[16:31], a[168:171], v[64:67], a[16:31]
  v_exp_f32 v55, v55
  buffer_load_dwordx4 v249, s[24:27], s62 offen lds
  v_mfma_f32_32x32x16_bf16 a[32:47], a[176:179], v[64:67], a[32:47]
  buffer_load_dwordx4 v249, s[24:27], s62 offen offset:1024 lds
  s_add_u32 m0, s63, 49152
  s_mov_b32 s61, 81920
  v_mfma_f32_32x32x16_bf16 a[48:63], a[184:187], v[64:67], a[48:63]
  v_add_f32 v95, v95, v51
  v_cvt_pk_bf16_f32 v73, v50, v51
  buffer_load_dwordx4 v247, s[20:23], s61 offen lds
  s_waitcnt lgkmcnt(0)
  v_mfma_f32_32x32x16_bf16 a[0:15], a[164:167], v[68:71], a[0:15]
  v_exp_f32 v56, v56
  buffer_load_dwordx4 v248, s[20:23], s61 offen offset:1024 lds
  v_mfma_f32_32x32x16_bf16 a[16:31], a[172:175], v[68:71], a[16:31]
  v_add_f32 v94, v94, v52
  v_exp_f32 v57, v57
  v_add_f32 v95, v95, v53
  s_add_u32 m0, s63, 114688
  s_mov_b32 s62, 73728
  v_mfma_f32_32x32x16_bf16 a[32:47], a[180:183], v[68:71], a[32:47]
  v_cvt_pk_bf16_f32 v74, v52, v53
  buffer_load_dwordx4 v249, s[24:27], s62 offen lds
  v_mfma_f32_32x32x16_bf16 a[48:63], a[188:191], v[68:71], a[48:63]
  v_exp_f32 v58, v58
  v_add_f32 v94, v94, v54
  v_exp_f32 v59, v59
  v_add_f32 v95, v95, v55
  v_cvt_pk_bf16_f32 v75, v54, v55
  v_exp_f32 v60, v60
  v_add_f32 v94, v94, v56
  v_exp_f32 v61, v61
  v_add_f32 v95, v95, v57
  v_cvt_pk_bf16_f32 v76, v56, v57
  v_exp_f32 v62, v62
  v_add_f32 v94, v94, v58
  v_exp_f32 v63, v63
  v_add_f32 v95, v95, v59
  v_cvt_pk_bf16_f32 v77, v58, v59
  v_add_f32 v94, v94, v60
  v_add_f32 v95, v95, v61
  v_cvt_pk_bf16_f32 v78, v60, v61
  v_add_f32 v94, v94, v62
  v_add_f32 v95, v95, v63
  v_cvt_pk_bf16_f32 v79, v62, v63
  buffer_load_dwordx4 v249, s[24:27], s62 offen offset:1024 lds
  v_accvgpr_read_b32 v177, a233
  v_accvgpr_read_b32 v178, a234
  v_mfma_f32_32x32x16_bf16 v[48:63], a[128:131], v[0:3], 0
  v_accvgpr_read_b32 v179, a235
  v_accvgpr_read_b32 v180, a236
  v_accvgpr_read_b32 v181, a237
  v_accvgpr_read_b32 v182, a238
  v_accvgpr_read_b32 v183, a239
  v_mfma_f32_32x32x16_bf16 v[48:63], a[132:135], v[4:7], v[48:63]
  v_exp_f32 v32, v32
  v_perm_b32 v184, v172, v168, s58
  v_perm_b32 v185, v172, v168, s59
  v_perm_b32 v186, v173, v169, s58
  v_perm_b32 v187, v173, v169, s59
  v_mfma_f32_32x32x16_bf16 v[48:63], a[136:139], v[8:11], v[48:63]
  v_perm_b32 v188, v174, v170, s58
  v_perm_b32 v189, v174, v170, s59
  v_perm_b32 v190, v175, v171, s58
  v_perm_b32 v191, v175, v171, s59
  v_perm_b32 v192, v180, v176, s58
  v_mfma_f32_32x32x16_bf16 v[48:63], a[140:143], v[12:15], v[48:63]
  v_exp_f32 v33, v33
  v_perm_b32 v193, v180, v176, s59
  v_perm_b32 v194, v181, v177, s58
  v_perm_b32 v195, v181, v177, s59
  v_perm_b32 v196, v182, v178, s58
  v_mfma_f32_32x32x16_bf16 v[48:63], a[144:147], v[16:19], v[48:63]
  v_perm_b32 v197, v182, v178, s59
  v_perm_b32 v198, v183, v179, s58
  v_perm_b32 v199, v183, v179, s59
  v_dot2_f32_bf16 v200, v184, v160, 0
  v_dot2_f32_bf16 v201, v185, v160, 0
  v_mfma_f32_32x32x16_bf16 v[48:63], a[148:151], v[20:23], v[48:63]
  v_dot2_f32_bf16 v202, v186, v160, 0
  v_dot2_f32_bf16 v203, v187, v160, 0
  v_dot2_f32_bf16 v204, v188, v160, 0
  v_dot2_f32_bf16 v205, v189, v160, 0
  v_dot2_f32_bf16 v206, v190, v160, 0
  v_mfma_f32_32x32x16_bf16 v[48:63], a[152:155], v[24:27], v[48:63]
  v_exp_f32 v34, v34
  v_dot2_f32_bf16 v207, v191, v160, 0
  v_dot2_f32_bf16 v200, v192, v161, v200
  v_dot2_f32_bf16 v201, v193, v161, v201
  v_dot2_f32_bf16 v202, v194, v161, v202
  v_mfma_f32_32x32x16_bf16 v[48:63], a[156:159], v[28:31], v[48:63]
  v_dot2_f32_bf16 v203, v195, v161, v203
  v_dot2_f32_bf16 v204, v196, v161, v204
  v_dot2_f32_bf16 v205, v197, v161, v205
  v_dot2_f32_bf16 v206, v198, v161, v206
  v_dot2_f32_bf16 v207, v199, v161, v207
  v_mfma_f32_32x32x16_bf16 a[64:79], a[160:163], v[72:75], a[64:79]
  v_exp_f32 v35, v35
  ds_read_b128 a[128:131], v80 offset:16384
  v_mfma_f32_32x32x16_bf16 a[80:95], a[168:171], v[72:75], a[80:95]
  v_exp_f32 v36, v36
  v_add_f32 v92, v92, v32
  ds_read_b128 a[132:135], v81 offset:16384
  v_mfma_f32_32x32x16_bf16 a[96:111], a[176:179], v[72:75], a[96:111]
  v_exp_f32 v37, v37
  v_add_f32 v93, v93, v33
  ds_read_b128 a[136:139], v82 offset:16384
  v_mfma_f32_32x32x16_bf16 a[112:127], a[184:187], v[72:75], a[112:127]
  v_cvt_pk_bf16_f32 v64, v32, v33
  v_exp_f32 v38, v38
  ds_read_b128 a[140:143], v83 offset:16384
  v_mfma_f32_32x32x16_bf16 a[64:79], a[164:167], v[76:79], a[64:79]
  v_add_f32 v92, v92, v34
  v_exp_f32 v39, v39
  ds_read_b128 a[144:147], v84 offset:16384
  v_mfma_f32_32x32x16_bf16 a[80:95], a[172:175], v[76:79], a[80:95]
  v_add_f32 v93, v93, v35
  v_cvt_pk_bf16_f32 v65, v34, v35
  ds_read_b128 a[148:151], v85 offset:16384
  v_mfma_f32_32x32x16_bf16 a[96:111], a[180:183], v[76:79], a[96:111]
  v_exp_f32 v40, v40
  v_add_f32 v92, v92, v36
  ds_read_b128 a[152:155], v86 offset:16384
  v_mfma_f32_32x32x16_bf16 a[112:127], a[188:191], v[76:79], a[112:127]
  v_exp_f32 v41, v41
  v_add_f32 v93, v93, v37
  v_cvt_pk_bf16_f32 v66, v36, v37
  v_exp_f32 v42, v42
  v_add_f32 v92, v92, v38
  v_exp_f32 v43, v43
  v_add_f32 v93, v93, v39
  v_cvt_pk_bf16_f32 v67, v38, v39
  v_exp_f32 v44, v44
  v_add_f32 v92, v92, v40
  v_exp_f32 v45, v45
  v_add_f32 v93, v93, v41
  v_cvt_pk_bf16_f32 v68, v40, v41
  v_exp_f32 v46, v46
  v_add_f32 v92, v92, v42
  v_exp_f32 v47, v47
  v_add_f32 v93, v93, v43
  v_cvt_pk_bf16_f32 v69, v42, v43
  v_add_f32 v92, v92, v44
  v_add_f32 v93, v93, v45
  v_cvt_pk_bf16_f32 v70, v44, v45
  v_add_f32 v92, v92, v46
  v_add_f32 v93, v93, v47
  v_cvt_pk_bf16_f32 v71, v46, v47
  ds_read_b128 a[156:159], v87 offset:16384
  s_waitcnt lgkmcnt(4)
  v_mfma_f32_32x32x16_bf16 v[32:47], a[128:131], v[128:131], 0
  v_exp_f32 v48, v48
  ds_read_b64_tr_b16 a[160:161], v88 offset:16384
  ds_read_b64_tr_b16 a[162:163], v88 offset:18432
  v_mfma_f32_32x32x16_bf16 v[32:47], a[132:135], v[132:135], v[32:47]
  v_exp_f32 v49, v49
  ds_read_b64_tr_b16 a[168:169], v89 offset:16384
  ds_read_b64_tr_b16 a[170:171], v89 offset:18432
  v_mfma_f32_32x32x16_bf16 v[32:47], a[136:139], v[136:139], v[32:47]
  v_exp_f32 v50, v50
  ds_read_b64_tr_b16 a[176:177], v90 offset:16384
  ds_read_b64_tr_b16 a[178:179], v90 offset:18432
  v_mfma_f32_32x32x16_bf16 v[32:47], a[140:143], v[140:143], v[32:47]
  v_exp_f32 v51, v51
  ds_read_b64_tr_b16 a[184:185], v91 offset:16384
  ds_read_b64_tr_b16 a[186:187], v91 offset:18432
  s_waitcnt lgkmcnt(8)
  v_mfma_f32_32x32x16_bf16 v[32:47], a[144:147], v[144:147], v[32:47]
  v_exp_f32 v52, v52
  ds_read_b64_tr_b16 a[164:165], v88 offset:20480
  ds_read_b64_tr_b16 a[166:167], v88 offset:22528
  v_mfma_f32_32x32x16_bf16 v[32:47], a[148:151], v[148:151], v[32:47]
  v_add_f32 v94, v94, v48
  ds_read_b64_tr_b16 a[172:173], v89 offset:20480
  ds_read_b64_tr_b16 a[174:175], v89 offset:22528
  v_mfma_f32_32x32x16_bf16 v[32:47], a[152:155], v[152:155], v[32:47]
  v_exp_f32 v53, v53
  ds_read_b64_tr_b16 a[180:181], v90 offset:20480
  ds_read_b64_tr_b16 a[182:183], v90 offset:22528
  v_mfma_f32_32x32x16_bf16 v[32:47], a[156:159], v[156:159], v[32:47]
  v_add_f32 v95, v95, v49
  v_cvt_pk_bf16_f32 v72, v48, v49
  ds_read_b64_tr_b16 a[188:189], v91 offset:20480
  ds_read_b64_tr_b16 a[190:191], v91 offset:22528
  s_waitcnt lgkmcnt(8)
  v_mfma_f32_32x32x16_bf16 a[0:15], a[160:163], v[64:67], a[0:15]
  s_add_u32 m0, s63, 57344
  s_mov_b32 s61, 90112
  buffer_load_dwordx4 v247, s[20:23], s61 offen lds
  v_mfma_f32_32x32x16_bf16 a[16:31], a[168:171], v[64:67], a[16:31]
  buffer_load_dwordx4 v248, s[20:23], s61 offen offset:1024 lds
  s_add_u32 m0, s63, 122880
  s_mov_b32 s62, 81920
  v_mfma_f32_32x32x16_bf16 a[32:47], a[176:179], v[64:67], a[32:47]
  v_exp_f32 v54, v54
  buffer_load_dwordx4 v249, s[24:27], s62 offen lds
  v_mfma_f32_32x32x16_bf16 a[48:63], a[184:187], v[64:67], a[48:63]
  buffer_load_dwordx4 v249, s[24:27], s62 offen offset:1024 lds
  s_nop 1
  v_permlane32_swap_b32 v200, v204
  s_waitcnt lgkmcnt(0)
  v_mfma_f32_32x32x16_bf16 a[0:15], a[164:167], v[68:71], a[0:15]
  v_permlane32_swap_b32 v201, v205
  v_permlane32_swap_b32 v202, v206
  v_permlane32_swap_b32 v203, v207
  v_add_f32 v200, v200, v204
  v_mfma_f32_32x32x16_bf16 a[16:31], a[172:175], v[68:71], a[16:31]
  v_add_f32 v201, v201, v205
  v_add_f32 v202, v202, v206
  v_add_f32 v203, v203, v207
  s_nop 1
  v_permlane16_swap_b32 v200, v202
  v_mfma_f32_32x32x16_bf16 a[32:47], a[180:183], v[68:71], a[32:47]
  v_permlane16_swap_b32 v201, v203
  v_add_f32 v200, v200, v202
  v_add_f32 v201, v201, v203
  v_and_b32 v250, 8, v255
  v_cmp_ne_u32 vcc, 0, v250
  v_mfma_f32_32x32x16_bf16 a[48:63], a[188:191], v[68:71], a[48:63]
  v_add_f32 v94, v94, v50
  v_exp_f32 v55, v55
  v_add_f32 v95, v95, v51
  v_cvt_pk_bf16_f32 v73, v50, v51
  v_exp_f32 v56, v56
  v_add_f32 v94, v94, v52
  v_exp_f32 v57, v57
  v_add_f32 v95, v95, v53
  v_cvt_pk_bf16_f32 v74, v52, v53
  v_exp_f32 v58, v58
  v_add_f32 v94, v94, v54
  v_exp_f32 v59, v59
  v_add_f32 v95, v95, v55
  v_cvt_pk_bf16_f32 v75, v54, v55
  v_exp_f32 v60, v60
  v_add_f32 v94, v94, v56
  v_exp_f32 v61, v61
  v_add_f32 v95, v95, v57
  v_cvt_pk_bf16_f32 v76, v56, v57
  v_exp_f32 v62, v62
  v_add_f32 v94, v94, v58
  v_exp_f32 v63, v63
  v_add_f32 v95, v95, v59
  v_cvt_pk_bf16_f32 v77, v58, v59
  v_add_f32 v94, v94, v60
  v_add_f32 v95, v95, v61
  v_cvt_pk_bf16_f32 v78, v60, v61
  v_add_f32 v94, v94, v62
  v_add_f32 v95, v95, v63
  v_cvt_pk_bf16_f32 v79, v62, v63
  v_add_f32_dpp v200, v200, v200 row_ror:8 row_mask:0xf bank_mask:0xf
  v_add_f32_dpp v201, v201, v201 row_ror:8 row_mask:0xf bank_mask:0xf
  v_lshrrev_b32 v250, 3, v255
  v_and_b32 v251, 7, v255
  v_cndmask_b32 v200, v200, v201, vcc
  v_lshl_add_u32 v250, v251, 3, v250
  v_mfma_f32_32x32x16_bf16 v[48:63], a[128:131], v[0:3], 0
  v_lshlrev_b32 v250, 2, v250
  s_and_b32 s6, s5, 1
  s_lshl_b32 s6, s6, 4
  s_lshl_b32 s7, s3, 1
  s_add_u32 s6, s6, s7
  s_lshr_b32 s7, s5, 1
  s_add_u32 s6, s6, s7
  v_mfma_f32_32x32x16_bf16 v[48:63], a[132:135], v[4:7], v[48:63]
  s_mul_i32 s6, s6, 7168
  s_lshl_b32 s7, s4, 8
  s_add_u32 s6, s6, s7
  s_add_u32 s6, s6, 16834560
  s_cmp_lt_u32 s4, 28
  s_cselect_b32 s6, s6, 268435456
  v_mfma_f32_32x32x16_bf16 v[48:63], a[136:139], v[8:11], v[48:63]
  buffer_store_dword v200, v250, s[28:31], s6 offen sc1
  s_lshl_b32 s6, s5, 6
  v_add_u32 v250, s6, v255
  v_lshlrev_b32 v250, 2, v250
  s_mul_i32 s6, s3, 28
  v_mfma_f32_32x32x16_bf16 v[48:63], a[140:143], v[12:15], v[48:63]
  s_min_u32 s7, s4, 27
  s_add_u32 s6, s6, s7
  s_lshl_b32 s6, s6, 13
  s_add_u32 s7, s6, 4096
  buffer_load_dword a244, v250, s[32:35], s6 offen offset:0
  v_mfma_f32_32x32x16_bf16 v[48:63], a[144:147], v[16:19], v[48:63]
  buffer_load_dword a245, v250, s[32:35], s6 offen offset:1024
  buffer_load_dword a246, v250, s[32:35], s6 offen offset:2048
  v_mfma_f32_32x32x16_bf16 v[48:63], a[148:151], v[20:23], v[48:63]
  v_exp_f32 v32, v32
  buffer_load_dword a247, v250, s[32:35], s6 offen offset:3072
  v_mfma_f32_32x32x16_bf16 v[48:63], a[152:155], v[24:27], v[48:63]
  buffer_load_dword a248, v250, s[32:35], s7 offen offset:0
  buffer_load_dword a249, v250, s[32:35], s7 offen offset:1024
  v_mfma_f32_32x32x16_bf16 v[48:63], a[156:159], v[28:31], v[48:63]
  buffer_load_dword a250, v250, s[32:35], s7 offen offset:2048
  buffer_load_dword a251, v250, s[32:35], s7 offen offset:3072
  v_mfma_f32_32x32x16_bf16 a[64:79], a[160:163], v[72:75], a[64:79]
  v_exp_f32 v33, v33
  ds_read_b128 a[128:131], v80 offset:24576
  v_mfma_f32_32x32x16_bf16 a[80:95], a[168:171], v[72:75], a[80:95]
  v_exp_f32 v34, v34
  ds_read_b128 a[132:135], v81 offset:24576
  v_mfma_f32_32x32x16_bf16 a[96:111], a[176:179], v[72:75], a[96:111]
  v_exp_f32 v35, v35
  ds_read_b128 a[136:139], v82 offset:24576
  v_mfma_f32_32x32x16_bf16 a[112:127], a[184:187], v[72:75], a[112:127]
  v_exp_f32 v36, v36
  v_add_f32 v92, v92, v32
  ds_read_b128 a[140:143], v83 offset:24576
  v_mfma_f32_32x32x16_bf16 a[64:79], a[164:167], v[76:79], a[64:79]
  v_exp_f32 v37, v37
  v_add_f32 v93, v93, v33
  ds_read_b128 a[144:147], v84 offset:24576
  v_mfma_f32_32x32x16_bf16 a[80:95], a[172:175], v[76:79], a[80:95]
  v_cvt_pk_bf16_f32 v64, v32, v33
  v_exp_f32 v38, v38
  ds_read_b128 a[148:151], v85 offset:24576
  v_mfma_f32_32x32x16_bf16 a[96:111], a[180:183], v[76:79], a[96:111]
  v_add_f32 v92, v92, v34
  v_exp_f32 v39, v39
  ds_read_b128 a[152:155], v86 offset:24576
  v_mfma_f32_32x32x16_bf16 a[112:127], a[188:191], v[76:79], a[112:127]
  v_add_f32 v93, v93, v35
  v_cvt_pk_bf16_f32 v65, v34, v35
  v_exp_f32 v40, v40
  v_add_f32 v92, v92, v36
  v_exp_f32 v41, v41
  v_add_f32 v93, v93, v37
  v_cvt_pk_bf16_f32 v66, v36, v37
  v_exp_f32 v42, v42
  v_add_f32 v92, v92, v38
  v_exp_f32 v43, v43
  v_add_f32 v93, v93, v39
  v_cvt_pk_bf16_f32 v67, v38, v39
  v_exp_f32 v44, v44
  v_add_f32 v92, v92, v40
  v_exp_f32 v45, v45
  v_add_f32 v93, v93, v41
  v_cvt_pk_bf16_f32 v68, v40, v41
  v_exp_f32 v46, v46
  v_add_f32 v92, v92, v42
  v_exp_f32 v47, v47
  v_add_f32 v93, v93, v43
  v_cvt_pk_bf16_f32 v69, v42, v43
  v_add_f32 v92, v92, v44
  v_add_f32 v93, v93, v45
  v_cvt_pk_bf16_f32 v70, v44, v45
  v_add_f32 v92, v92, v46
  v_add_f32 v93, v93, v47
  v_cvt_pk_bf16_f32 v71, v46, v47
  ds_read_b128 a[156:159], v87 offset:24576
  s_waitcnt lgkmcnt(4)
  v_mfma_f32_32x32x16_bf16 v[32:47], a[128:131], v[128:131], 0
  v_exp_f32 v48, v48
  ds_read_b64_tr_b16 a[160:161], v88 offset:24576
  ds_read_b64_tr_b16 a[162:163], v88 offset:26624
  v_mfma_f32_32x32x16_bf16 v[32:47], a[132:135], v[132:135], v[32:47]
  v_exp_f32 v49, v49
  ds_read_b64_tr_b16 a[168:169], v89 offset:24576
  ds_read_b64_tr_b16 a[170:171], v89 offset:26624
  v_mfma_f32_32x32x16_bf16 v[32:47], a[136:139], v[136:139], v[32:47]
  v_exp_f32 v50, v50
  ds_read_b64_tr_b16 a[176:177], v90 offset:24576
  ds_read_b64_tr_b16 a[178:179], v90 offset:26624
  v_mfma_f32_32x32x16_bf16 v[32:47], a[140:143], v[140:143], v[32:47]
  v_exp_f32 v51, v51
  ds_read_b64_tr_b16 a[184:185], v91 offset:24576
  ds_read_b64_tr_b16 a[186:187], v91 offset:26624
  s_waitcnt lgkmcnt(8)
  v_mfma_f32_32x32x16_bf16 v[32:47], a[144:147], v[144:147], v[32:47]
  v_exp_f32 v52, v52
  ds_read_b64_tr_b16 a[164:165], v88 offset:28672
  ds_read_b64_tr_b16 a[166:167], v88 offset:30720
  v_mfma_f32_32x32x16_bf16 v[32:47], a[148:151], v[148:151], v[32:47]
  v_add_f32 v94, v94, v48
  ds_read_b64_tr_b16 a[172:173], v89 offset:28672
  ds_read_b64_tr_b16 a[174:175], v89 offset:30720
  v_mfma_f32_32x32x16_bf16 v[32:47], a[152:155], v[152:155], v[32:47]
  v_exp_f32 v53, v53
  ds_read_b64_tr_b16 a[180:181], v90 offset:28672
  ds_read_b64_tr_b16 a[182:183], v90 offset:30720
  v_mfma_f32_32x32x16_bf16 v[32:47], a[156:159], v[156:159], v[32:47]
  v_add_f32 v95, v95, v49
  v_cvt_pk_bf16_f32 v72, v48, v49
  ds_read_b64_tr_b16 a[188:189], v91 offset:28672
  ds_read_b64_tr_b16 a[190:191], v91 offset:30720
  s_waitcnt lgkmcnt(8)
  v_mfma_f32_32x32x16_bf16 a[0:15], a[160:163], v[64:67], a[0:15]
  v_exp_f32 v54, v54
  v_add_f32 v94, v94, v50
  v_exp_f32 v55, v55
  v_add_f32 v95, v95, v51
  v_mfma_f32_32x32x16_bf16 a[16:31], a[168:171], v[64:67], a[16:31]
  v_cvt_pk_bf16_f32 v73, v50, v51
  v_exp_f32 v56, v56
  v_add_f32 v94, v94, v52
  v_exp_f32 v57, v57
  v_mfma_f32_32x32x16_bf16 a[32:47], a[176:179], v[64:67], a[32:47]
  v_add_f32 v95, v95, v53
  v_cvt_pk_bf16_f32 v74, v52, v53
  v_exp_f32 v58, v58
  v_mfma_f32_32x32x16_bf16 a[48:63], a[184:187], v[64:67], a[48:63]
  v_add_f32 v94, v94, v54
  v_exp_f32 v59, v59
  v_add_f32 v95, v95, v55
  v_cvt_pk_bf16_f32 v75, v54, v55
  s_waitcnt lgkmcnt(0)
  v_mfma_f32_32x32x16_bf16 a[0:15], a[164:167], v[68:71], a[0:15]
  v_exp_f32 v60, v60
  v_add_f32 v94, v94, v56
  v_exp_f32 v61, v61
  v_mfma_f32_32x32x16_bf16 a[16:31], a[172:175], v[68:71], a[16:31]
  v_add_f32 v95, v95, v57
  v_cvt_pk_bf16_f32 v76, v56, v57
  v_exp_f32 v62, v62
  v_add_f32 v94, v94, v58
  v_mfma_f32_32x32x16_bf16 a[32:47], a[180:183], v[68:71], a[32:47]
  v_exp_f32 v63, v63
  v_add_f32 v95, v95, v59
  v_cvt_pk_bf16_f32 v77, v58, v59
  v_add_f32 v94, v94, v60
  v_mfma_f32_32x32x16_bf16 a[48:63], a[188:191], v[68:71], a[48:63]
  v_add_f32 v95, v95, v61
  v_cvt_pk_bf16_f32 v78, v60, v61
  v_add_f32 v94, v94, v62
  v_add_f32 v95, v95, v63
  v_cvt_pk_bf16_f32 v79, v62, v63
  s_waitcnt vmcnt(8)
  s_barrier
  v_mfma_f32_32x32x16_bf16 v[48:63], a[128:131], v[0:3], 0
  v_exp_f32 v32, v32
  v_exp_f32 v33, v33
  v_mfma_f32_32x32x16_bf16 v[48:63], a[132:135], v[4:7], v[48:63]
  v_exp_f32 v34, v34
  v_exp_f32 v35, v35
  v_exp_f32 v36, v36
  v_mfma_f32_32x32x16_bf16 v[48:63], a[136:139], v[8:11], v[48:63]
  v_add_f32 v92, v92, v32
  v_exp_f32 v37, v37
  v_add_f32 v93, v93, v33
  v_mfma_f32_32x32x16_bf16 v[48:63], a[140:143], v[12:15], v[48:63]
  v_cvt_pk_bf16_f32 v64, v32, v33
  v_exp_f32 v38, v38
  v_add_f32 v92, v92, v34
  v_mfma_f32_32x32x16_bf16 v[48:63], a[144:147], v[16:19], v[48:63]
  v_exp_f32 v39, v39
  v_add_f32 v93, v93, v35
  v_cvt_pk_bf16_f32 v65, v34, v35
  v_exp_f32 v40, v40
  v_mfma_f32_32x32x16_bf16 v[48:63], a[148:151], v[20:23], v[48:63]
  v_add_f32 v92, v92, v36
  v_exp_f32 v41, v41
  v_add_f32 v93, v93, v37
  v_mfma_f32_32x32x16_bf16 v[48:63], a[152:155], v[24:27], v[48:63]
  v_cvt_pk_bf16_f32 v66, v36, v37
  v_exp_f32 v42, v42
  v_add_f32 v92, v92, v38
  v_mfma_f32_32x32x16_bf16 v[48:63], a[156:159], v[28:31], v[48:63]
  v_exp_f32 v43, v43
  v_add_f32 v93, v93, v39
  v_cvt_pk_bf16_f32 v67, v38, v39
  v_exp_f32 v44, v44
  v_mfma_f32_32x32x16_bf16 a[64:79], a[160:163], v[72:75], a[64:79]
  v_add_f32 v92, v92, v40
  ds_read_b128 a[128:131], v80 offset:32768
  v_mfma_f32_32x32x16_bf16 a[80:95], a[168:171], v[72:75], a[80:95]
  v_exp_f32 v45, v45
  v_add_f32 v93, v93, v41
  ds_read_b128 a[132:135], v81 offset:32768
  v_mfma_f32_32x32x16_bf16 a[96:111], a[176:179], v[72:75], a[96:111]
  v_cvt_pk_bf16_f32 v68, v40, v41
  v_exp_f32 v46, v46
  ds_read_b128 a[136:139], v82 offset:32768
  v_mfma_f32_32x32x16_bf16 a[112:127], a[184:187], v[72:75], a[112:127]
  v_add_f32 v92, v92, v42
  ds_read_b128 a[140:143], v83 offset:32768
  v_mfma_f32_32x32x16_bf16 a[64:79], a[164:167], v[76:79], a[64:79]
  v_exp_f32 v47, v47
  v_add_f32 v93, v93, v43
  ds_read_b128 a[144:147], v84 offset:32768
  v_mfma_f32_32x32x16_bf16 a[80:95], a[172:175], v[76:79], a[80:95]
  v_cvt_pk_bf16_f32 v69, v42, v43
  v_add_f32 v92, v92, v44
  ds_read_b128 a[148:151], v85 offset:32768
  v_mfma_f32_32x32x16_bf16 a[96:111], a[180:183], v[76:79], a[96:111]
  v_add_f32 v93, v93, v45
  v_cvt_pk_bf16_f32 v70, v44, v45
  v_add_f32 v92, v92, v46
  ds_read_b128 a[152:155], v86 offset:32768
  v_mfma_f32_32x32x16_bf16 a[112:127], a[188:191], v[76:79], a[112:127]
  v_add_f32 v93, v93, v47
  v_cvt_pk_bf16_f32 v71, v46, v47
  ds_read_b128 a[156:159], v87 offset:32768
  s_waitcnt lgkmcnt(4)
  v_mfma_f32_32x32x16_bf16 v[32:47], a[128:131], v[128:131], 0
  v_exp_f32 v48, v48
  ds_read_b64_tr_b16 a[160:161], v88 offset:32768
  ds_read_b64_tr_b16 a[162:163], v88 offset:34816
  v_mfma_f32_32x32x16_bf16 v[32:47], a[132:135], v[132:135], v[32:47]
  v_exp_f32 v49, v49
  ds_read_b64_tr_b16 a[168:169], v89 offset:32768
  ds_read_b64_tr_b16 a[170:171], v89 offset:34816
  v_mfma_f32_32x32x16_bf16 v[32:47], a[136:139], v[136:139], v[32:47]
  v_exp_f32 v50, v50
  ds_read_b64_tr_b16 a[176:177], v90 offset:32768
  ds_read_b64_tr_b16 a[178:179], v90 offset:34816
  v_mfma_f32_32x32x16_bf16 v[32:47], a[140:143], v[140:143], v[32:47]
  v_exp_f32 v51, v51
  ds_read_b64_tr_b16 a[184:185], v91 offset:32768
  ds_read_b64_tr_b16 a[186:187], v91 offset:34816
  s_waitcnt lgkmcnt(8)
  v_mfma_f32_32x32x16_bf16 v[32:47], a[144:147], v[144:147], v[32:47]
  v_exp_f32 v52, v52
  ds_read_b64_tr_b16 a[164:165], v88 offset:36864
  ds_read_b64_tr_b16 a[166:167], v88 offset:38912
  v_mfma_f32_32x32x16_bf16 v[32:47], a[148:151], v[148:151], v[32:47]
  v_add_f32 v94, v94, v48
  ds_read_b64_tr_b16 a[172:173], v89 offset:36864
  ds_read_b64_tr_b16 a[174:175], v89 offset:38912
  v_mfma_f32_32x32x16_bf16 v[32:47], a[152:155], v[152:155], v[32:47]
  v_exp_f32 v53, v53
  ds_read_b64_tr_b16 a[180:181], v90 offset:36864
  ds_read_b64_tr_b16 a[182:183], v90 offset:38912
  v_mfma_f32_32x32x16_bf16 v[32:47], a[156:159], v[156:159], v[32:47]
  v_add_f32 v95, v95, v49
  v_cvt_pk_bf16_f32 v72, v48, v49
  ds_read_b64_tr_b16 a[188:189], v91 offset:36864
  ds_read_b64_tr_b16 a[190:191], v91 offset:38912
  s_waitcnt lgkmcnt(8)
  v_mfma_f32_32x32x16_bf16 a[0:15], a[160:163], v[64:67], a[0:15]
  v_exp_f32 v54, v54
  v_add_f32 v94, v94, v50
  s_add_u32 m0, s63, 0
  s_mov_b32 s61, 98304
  v_mfma_f32_32x32x16_bf16 a[16:31], a[168:171], v[64:67], a[16:31]
  v_exp_f32 v55, v55
  buffer_load_dwordx4 v247, s[20:23], s61 offen lds
  v_mfma_f32_32x32x16_bf16 a[32:47], a[176:179], v[64:67], a[32:47]
  v_add_f32 v95, v95, v51
  v_cvt_pk_bf16_f32 v73, v50, v51
  buffer_load_dwordx4 v248, s[20:23], s61 offen offset:1024 lds
  v_mfma_f32_32x32x16_bf16 a[48:63], a[184:187], v[64:67], a[48:63]
  v_exp_f32 v56, v56
  v_add_f32 v94, v94, v52
  s_add_u32 m0, s63, 65536
  s_mov_b32 s62, 90112
  s_waitcnt lgkmcnt(0)
  v_mfma_f32_32x32x16_bf16 a[0:15], a[164:167], v[68:71], a[0:15]
  v_exp_f32 v57, v57
  buffer_load_dwordx4 v249, s[24:27], s62 offen lds
  v_mfma_f32_32x32x16_bf16 a[16:31], a[172:175], v[68:71], a[16:31]
  v_add_f32 v95, v95, v53
  v_cvt_pk_bf16_f32 v74, v52, v53
  buffer_load_dwordx4 v249, s[24:27], s62 offen offset:1024 lds
  v_mfma_f32_32x32x16_bf16 a[32:47], a[180:183], v[68:71], a[32:47]
  v_exp_f32 v58, v58
  v_add_f32 v94, v94, v54
  s_add_u32 m0, s63, 8192
  s_mov_b32 s61, 106496
  v_mfma_f32_32x32x16_bf16 a[48:63], a[188:191], v[68:71], a[48:63]
  v_exp_f32 v59, v59
  v_add_f32 v95, v95, v55
  v_cvt_pk_bf16_f32 v75, v54, v55
  v_exp_f32 v60, v60
  v_add_f32 v94, v94, v56
  v_exp_f32 v61, v61
  v_add_f32 v95, v95, v57
  v_cvt_pk_bf16_f32 v76, v56, v57
  v_exp_f32 v62, v62
  v_add_f32 v94, v94, v58
  v_exp_f32 v63, v63
  v_add_f32 v95, v95, v59
  v_cvt_pk_bf16_f32 v77, v58, v59
  v_add_f32 v94, v94, v60
  v_add_f32 v95, v95, v61
  v_cvt_pk_bf16_f32 v78, v60, v61
  v_add_f32 v94, v94, v62
  v_add_f32 v95, v95, v63
  v_cvt_pk_bf16_f32 v79, v62, v63
  buffer_load_dwordx4 v247, s[20:23], s61 offen lds
  v_mfma_f32_32x32x16_bf16 v[48:63], a[128:131], v[0:3], 0
  v_exp_f32 v32, v32
  buffer_load_dwordx4 v248, s[20:23], s61 offen offset:1024 lds
  v_mfma_f32_32x32x16_bf16 v[48:63], a[132:135], v[4:7], v[48:63]
  v_exp_f32 v33, v33
  s_and_b32 s6, s4, 15
  s_lshl_b32 s6, s6, 2
  s_add_u32 s6, s6, s5
  v_mfma_f32_32x32x16_bf16 v[48:63], a[136:139], v[8:11], v[48:63]
  v_exp_f32 v34, v34
  s_mul_i32 s6, s6, 64
  v_and_b32 v252, 63, v255
  v_add_u32 v252, s6, v252
  v_mfma_f32_32x32x16_bf16 v[48:63], a[140:143], v[12:15], v[48:63]
  v_exp_f32 v35, v35
  v_exp_f32 v36, v36
  v_lshlrev_b32 v253, 7, v252
  s_lshl_b32 s7, s3, 19
  v_mfma_f32_32x32x16_bf16 v[48:63], a[144:147], v[16:19], v[48:63]
  v_add_f32 v92, v92, v32
  buffer_load_dword v232, v253, s[16:19], s7 offen
  s_lshl_b32 s6, s4, 8
  v_mfma_f32_32x32x16_bf16 v[48:63], a[148:151], v[20:23], v[48:63]
  v_exp_f32 v37, v37
  s_add_u32 s6, s6, 16810112
  s_cmp_eq_u32 s5, 0
  s_cselect_b32 s6, s6, 268435456
  v_cmp_eq_u32 vcc, 0, v255
  v_mfma_f32_32x32x16_bf16 v[48:63], a[152:155], v[24:27], v[48:63]
  v_add_f32 v93, v93, v33
  v_cvt_pk_bf16_f32 v64, v32, v33
  v_mov_b32 v251, 1
  v_mov_b32 v250, 268435456
  v_cndmask_b32 v250, v250, 0, vcc
  v_mfma_f32_32x32x16_bf16 v[48:63], a[156:159], v[28:31], v[48:63]
  v_exp_f32 v38, v38
  buffer_atomic_add v251, v250, s[28:31], s6 offen sc1
  v_mfma_f32_32x32x16_bf16 a[64:79], a[160:163], v[72:75], a[64:79]
  v_add_f32 v92, v92, v34
  v_exp_f32 v39, v39
  ds_read_b128 a[128:131], v80 offset:40960
  v_mfma_f32_32x32x16_bf16 a[80:95], a[168:171], v[72:75], a[80:95]
  v_add_f32 v93, v93, v35
  v_cvt_pk_bf16_f32 v65, v34, v35
  ds_read_b128 a[132:135], v81 offset:40960
  v_mfma_f32_32x32x16_bf16 a[96:111], a[176:179], v[72:75], a[96:111]
  v_exp_f32 v40, v40
  v_add_f32 v92, v92, v36
  ds_read_b128 a[136:139], v82 offset:40960
  v_mfma_f32_32x32x16_bf16 a[112:127], a[184:187], v[72:75], a[112:127]
  v_exp_f32 v41, v41
  v_add_f32 v93, v93, v37
  ds_read_b128 a[140:143], v83 offset:40960
  v_mfma_f32_32x32x16_bf16 a[64:79], a[164:167], v[76:79], a[64:79]
  v_cvt_pk_bf16_f32 v66, v36, v37
  v_exp_f32 v42, v42
  ds_read_b128 a[144:147], v84 offset:40960
  v_mfma_f32_32x32x16_bf16 a[80:95], a[172:175], v[76:79], a[80:95]
  v_add_f32 v92, v92, v38
  v_exp_f32 v43, v43
  ds_read_b128 a[148:151], v85 offset:40960
  v_mfma_f32_32x32x16_bf16 a[96:111], a[180:183], v[76:79], a[96:111]
  v_add_f32 v93, v93, v39
  v_cvt_pk_bf16_f32 v67, v38, v39
  ds_read_b128 a[152:155], v86 offset:40960
  v_mfma_f32_32x32x16_bf16 a[112:127], a[188:191], v[76:79], a[112:127]
  v_exp_f32 v44, v44
  v_add_f32 v92, v92, v40
  v_exp_f32 v45, v45
  v_add_f32 v93, v93, v41
  v_cvt_pk_bf16_f32 v68, v40, v41
  v_exp_f32 v46, v46
  v_add_f32 v92, v92, v42
  v_exp_f32 v47, v47
  v_add_f32 v93, v93, v43
  v_cvt_pk_bf16_f32 v69, v42, v43
  v_add_f32 v92, v92, v44
  v_add_f32 v93, v93, v45
  v_cvt_pk_bf16_f32 v70, v44, v45
  v_add_f32 v92, v92, v46
  v_add_f32 v93, v93, v47
  v_cvt_pk_bf16_f32 v71, v46, v47
  ds_read_b128 a[156:159], v87 offset:40960
  s_waitcnt lgkmcnt(4)
  v_mfma_f32_32x32x16_bf16 v[32:47], a[128:131], v[128:131], 0
  v_exp_f32 v48, v48
  ds_read_b64_tr_b16 a[160:161], v88 offset:40960
  ds_read_b64_tr_b16 a[162:163], v88 offset:43008
  v_mfma_f32_32x32x16_bf16 v[32:47], a[132:135], v[132:135], v[32:47]
  v_exp_f32 v49, v49
  ds_read_b64_tr_b16 a[168:169], v89 offset:40960
  ds_read_b64_tr_b16 a[170:171], v89 offset:43008
  v_mfma_f32_32x32x16_bf16 v[32:47], a[136:139], v[136:139], v[32:47]
  v_exp_f32 v50, v50
  ds_read_b64_tr_b16 a[176:177], v90 offset:40960
  ds_read_b64_tr_b16 a[178:179], v90 offset:43008
  v_mfma_f32_32x32x16_bf16 v[32:47], a[140:143], v[140:143], v[32:47]
  v_exp_f32 v51, v51
  ds_read_b64_tr_b16 a[184:185], v91 offset:40960
  ds_read_b64_tr_b16 a[186:187], v91 offset:43008
  s_waitcnt lgkmcnt(8)
  v_mfma_f32_32x32x16_bf16 v[32:47], a[144:147], v[144:147], v[32:47]
  v_exp_f32 v52, v52
  ds_read_b64_tr_b16 a[164:165], v88 offset:45056
  ds_read_b64_tr_b16 a[166:167], v88 offset:47104
  v_mfma_f32_32x32x16_bf16 v[32:47], a[148:151], v[148:151], v[32:47]
  v_add_f32 v94, v94, v48
  ds_read_b64_tr_b16 a[172:173], v89 offset:45056
  ds_read_b64_tr_b16 a[174:175], v89 offset:47104
  v_mfma_f32_32x32x16_bf16 v[32:47], a[152:155], v[152:155], v[32:47]
  v_exp_f32 v53, v53
  ds_read_b64_tr_b16 a[180:181], v90 offset:45056
  ds_read_b64_tr_b16 a[182:183], v90 offset:47104
  v_mfma_f32_32x32x16_bf16 v[32:47], a[156:159], v[156:159], v[32:47]
  v_add_f32 v95, v95, v49
  v_cvt_pk_bf16_f32 v72, v48, v49
  ds_read_b64_tr_b16 a[188:189], v91 offset:45056
  ds_read_b64_tr_b16 a[190:191], v91 offset:47104
  s_waitcnt lgkmcnt(8)
  v_mfma_f32_32x32x16_bf16 a[0:15], a[160:163], v[64:67], a[0:15]
  v_exp_f32 v54, v54
  v_add_f32 v94, v94, v50
  s_add_u32 m0, s63, 73728
  s_mov_b32 s62, 98304
  v_mfma_f32_32x32x16_bf16 a[16:31], a[168:171], v[64:67], a[16:31]
  v_exp_f32 v55, v55
  v_add_f32 v95, v95, v51
  v_cvt_pk_bf16_f32 v73, v50, v51
  v_exp_f32 v56, v56
  v_mfma_f32_32x32x16_bf16 a[32:47], a[176:179], v[64:67], a[32:47]
  v_add_f32 v94, v94, v52
  buffer_load_dwordx4 v249, s[24:27], s62 offen lds
  v_mfma_f32_32x32x16_bf16 a[48:63], a[184:187], v[64:67], a[48:63]
  v_exp_f32 v57, v57
  v_add_f32 v95, v95, v53
  v_cvt_pk_bf16_f32 v74, v52, v53
  v_exp_f32 v58, v58
  s_waitcnt lgkmcnt(0)
  v_mfma_f32_32x32x16_bf16 a[0:15], a[164:167], v[68:71], a[0:15]
  v_add_f32 v94, v94, v54
  buffer_load_dwordx4 v249, s[24:27], s62 offen offset:1024 lds
  v_mfma_f32_32x32x16_bf16 a[16:31], a[172:175], v[68:71], a[16:31]
  v_exp_f32 v59, v59
  v_add_f32 v95, v95, v55
  v_cvt_pk_bf16_f32 v75, v54, v55
  s_add_u32 m0, s63, 16384
  s_mov_b32 s61, 114688
  v_mfma_f32_32x32x16_bf16 a[32:47], a[180:183], v[68:71], a[32:47]
  v_exp_f32 v60, v60
  v_add_f32 v94, v94, v56
  v_exp_f32 v61, v61
  v_add_f32 v95, v95, v57
  v_mfma_f32_32x32x16_bf16 a[48:63], a[188:191], v[68:71], a[48:63]
  v_cvt_pk_bf16_f32 v76, v56, v57
  v_exp_f32 v62, v62
  v_add_f32 v94, v94, v58
  v_exp_f32 v63, v63
  v_add_f32 v95, v95, v59
  v_cvt_pk_bf16_f32 v77, v58, v59
  v_add_f32 v94, v94, v60
  v_add_f32 v95, v95, v61
  v_cvt_pk_bf16_f32 v78, v60, v61
  v_add_f32 v94, v94, v62
  v_add_f32 v95, v95, v63
  v_cvt_pk_bf16_f32 v79, v62, v63
  buffer_load_dwordx4 v247, s[20:23], s61 offen lds
  v_mfma_f32_32x32x16_bf16 v[48:63], a[128:131], v[0:3], 0
  v_exp_f32 v32, v32
  v_exp_f32 v33, v33
  v_exp_f32 v34, v34
  v_mfma_f32_32x32x16_bf16 v[48:63], a[132:135], v[4:7], v[48:63]
  v_exp_f32 v35, v35
  buffer_load_dwordx4 v248, s[20:23], s61 offen offset:1024 lds
  v_mfma_f32_32x32x16_bf16 v[48:63], a[136:139], v[8:11], v[48:63]
  v_exp_f32 v36, v36
  v_add_f32 v92, v92, v32
  v_exp_f32 v37, v37
  s_add_u32 m0, s63, 81920
  v_mfma_f32_32x32x16_bf16 v[48:63], a[140:143], v[12:15], v[48:63]
  v_add_f32 v93, v93, v33
  v_cvt_pk_bf16_f32 v64, v32, v33
  v_exp_f32 v38, v38
  s_mov_b32 s62, 106496
  v_mfma_f32_32x32x16_bf16 v[48:63], a[144:147], v[16:19], v[48:63]
  v_add_f32 v92, v92, v34
  buffer_load_dwordx4 v249, s[24:27], s62 offen lds
  v_mfma_f32_32x32x16_bf16 v[48:63], a[148:151], v[20:23], v[48:63]
  v_exp_f32 v39, v39
  v_add_f32 v93, v93, v35
  v_cvt_pk_bf16_f32 v65, v34, v35
  v_exp_f32 v40, v40
  v_mfma_f32_32x32x16_bf16 v[48:63], a[152:155], v[24:27], v[48:63]
  v_add_f32 v92, v92, v36
  buffer_load_dwordx4 v249, s[24:27], s62 offen offset:1024 lds
  v_mfma_f32_32x32x16_bf16 v[48:63], a[156:159], v[28:31], v[48:63]
  v_exp_f32 v41, v41
  v_add_f32 v93, v93, v37
  v_cvt_pk_bf16_f32 v66, v36, v37
  v_exp_f32 v42, v42
  v_mfma_f32_32x32x16_bf16 a[64:79], a[160:163], v[72:75], a[64:79]
  v_add_f32 v92, v92, v38
  v_exp_f32 v43, v43
  ds_read_b128 a[128:131], v80 offset:49152
  v_mfma_f32_32x32x16_bf16 a[80:95], a[168:171], v[72:75], a[80:95]
  v_add_f32 v93, v93, v39
  v_cvt_pk_bf16_f32 v67, v38, v39
  ds_read_b128 a[132:135], v81 offset:49152
  v_mfma_f32_32x32x16_bf16 a[96:111], a[176:179], v[72:75], a[96:111]
  v_exp_f32 v44, v44
  v_add_f32 v92, v92, v40
  ds_read_b128 a[136:139], v82 offset:49152
  v_mfma_f32_32x32x16_bf16 a[112:127], a[184:187], v[72:75], a[112:127]
  v_exp_f32 v45, v45
  v_add_f32 v93, v93, v41
  ds_read_b128 a[140:143], v83 offset:49152
  v_mfma_f32_32x32x16_bf16 a[64:79], a[164:167], v[76:79], a[64:79]
  v_cvt_pk_bf16_f32 v68, v40, v41
  v_exp_f32 v46, v46
  ds_read_b128 a[144:147], v84 offset:49152
  v_mfma_f32_32x32x16_bf16 a[80:95], a[172:175], v[76:79], a[80:95]
  v_add_f32 v92, v92, v42
  v_exp_f32 v47, v47
  ds_read_b128 a[148:151], v85 offset:49152
  v_mfma_f32_32x32x16_bf16 a[96:111], a[180:183], v[76:79], a[96:111]
  v_add_f32 v93, v93, v43
  v_cvt_pk_bf16_f32 v69, v42, v43
  v_add_f32 v92, v92, v44
  ds_read_b128 a[152:155], v86 offset:49152
  v_mfma_f32_32x32x16_bf16 a[112:127], a[188:191], v[76:79], a[112:127]
  v_add_f32 v93, v93, v45
  v_cvt_pk_bf16_f32 v70, v44, v45
  v_add_f32 v92, v92, v46
  v_add_f32 v93, v93, v47
  v_cvt_pk_bf16_f32 v71, v46, v47
  ds_read_b128 a[156:159], v87 offset:49152
  s_waitcnt lgkmcnt(4)
  v_mfma_f32_32x32x16_bf16 v[32:47], a[128:131], v[128:131], 0
  v_exp_f32 v48, v48
  ds_read_b64_tr_b16 a[160:161], v88 offset:49152
  ds_read_b64_tr_b16 a[162:163], v88 offset:51200
  v_mfma_f32_32x32x16_bf16 v[32:47], a[132:135], v[132:135], v[32:47]
  v_exp_f32 v49, v49
  ds_read_b64_tr_b16 a[168:169], v89 offset:49152
  ds_read_b64_tr_b16 a[170:171], v89 offset:51200
  v_mfma_f32_32x32x16_bf16 v[32:47], a[136:139], v[136:139], v[32:47]
  v_exp_f32 v50, v50
  ds_read_b64_tr_b16 a[176:177], v90 offset:49152
  ds_read_b64_tr_b16 a[178:179], v90 offset:51200
  v_mfma_f32_32x32x16_bf16 v[32:47], a[140:143], v[140:143], v[32:47]
  v_exp_f32 v51, v51
  ds_read_b64_tr_b16 a[184:185], v91 offset:49152
  ds_read_b64_tr_b16 a[186:187], v91 offset:51200
  s_waitcnt lgkmcnt(8)
  v_mfma_f32_32x32x16_bf16 v[32:47], a[144:147], v[144:147], v[32:47]
  v_exp_f32 v52, v52
  ds_read_b64_tr_b16 a[164:165], v88 offset:53248
  ds_read_b64_tr_b16 a[166:167], v88 offset:55296
  v_mfma_f32_32x32x16_bf16 v[32:47], a[148:151], v[148:151], v[32:47]
  v_add_f32 v94, v94, v48
  ds_read_b64_tr_b16 a[172:173], v89 offset:53248
  ds_read_b64_tr_b16 a[174:175], v89 offset:55296
  v_mfma_f32_32x32x16_bf16 v[32:47], a[152:155], v[152:155], v[32:47]
  v_exp_f32 v53, v53
  ds_read_b64_tr_b16 a[180:181], v90 offset:53248
  ds_read_b64_tr_b16 a[182:183], v90 offset:55296
  v_mfma_f32_32x32x16_bf16 v[32:47], a[156:159], v[156:159], v[32:47]
  v_add_f32 v95, v95, v49
  v_cvt_pk_bf16_f32 v72, v48, v49
  ds_read_b64_tr_b16 a[188:189], v91 offset:53248
  ds_read_b64_tr_b16 a[190:191], v91 offset:55296
  s_waitcnt lgkmcnt(8)
  v_mfma_f32_32x32x16_bf16 a[0:15], a[160:163], v[64:67], a[0:15]
  v_exp_f32 v54, v54
  v_add_f32 v94, v94, v50
  s_add_u32 m0, s63, 24576
  s_mov_b32 s61, 122880
  v_mfma_f32_32x32x16_bf16 a[16:31], a[168:171], v[64:67], a[16:31]
  v_exp_f32 v55, v55
  buffer_load_dwordx4 v247, s[20:23], s61 offen lds
  v_mfma_f32_32x32x16_bf16 a[32:47], a[176:179], v[64:67], a[32:47]
  v_add_f32 v95, v95, v51
  v_cvt_pk_bf16_f32 v73, v50, v51
  v_exp_f32 v56, v56
  v_add_f32 v94, v94, v52
  v_mfma_f32_32x32x16_bf16 a[48:63], a[184:187], v[64:67], a[48:63]
  v_exp_f32 v57, v57
  buffer_load_dwordx4 v248, s[20:23], s61 offen offset:1024 lds
  s_waitcnt lgkmcnt(0)
  v_mfma_f32_32x32x16_bf16 a[0:15], a[164:167], v[68:71], a[0:15]
  v_add_f32 v95, v95, v53
  v_cvt_pk_bf16_f32 v74, v52, v53
  v_exp_f32 v58, v58
  s_add_u32 m0, s63, 90112
  s_mov_b32 s62, 114688
  v_mfma_f32_32x32x16_bf16 a[16:31], a[172:175], v[68:71], a[16:31]
  v_add_f32 v94, v94, v54
  buffer_load_dwordx4 v249, s[24:27], s62 offen lds
  v_mfma_f32_32x32x16_bf16 a[32:47], a[180:183], v[68:71], a[32:47]
  v_exp_f32 v59, v59
  buffer_load_dwordx4 v249, s[24:27], s62 offen offset:1024 lds
  v_mfma_f32_32x32x16_bf16 a[48:63], a[188:191], v[68:71], a[48:63]
  v_add_f32 v95, v95, v55
  v_cvt_pk_bf16_f32 v75, v54, v55
  v_exp_f32 v60, v60
  v_add_f32 v94, v94, v56
  v_exp_f32 v61, v61
  v_add_f32 v95, v95, v57
  v_cvt_pk_bf16_f32 v76, v56, v57
  v_exp_f32 v62, v62
  v_add_f32 v94, v94, v58
  v_exp_f32 v63, v63
  v_add_f32 v95, v95, v59
  v_cvt_pk_bf16_f32 v77, v58, v59
  v_add_f32 v94, v94, v60
  v_add_f32 v95, v95, v61
  v_cvt_pk_bf16_f32 v78, v60, v61
  v_add_f32 v94, v94, v62
  v_add_f32 v95, v95, v63
  v_cvt_pk_bf16_f32 v79, v62, v63
  v_lshrrev_b32 v250, 5, v255
  v_mfma_f32_32x32x16_bf16 v[48:63], a[128:131], v[0:3], 0
  v_exp_f32 v32, v32
  v_bfe_u32 v251, v255, 4, 1
  v_lshlrev_b32 v250, 14, v250
  v_lshl_add_u32 v250, v251, 12, v250
  v_mfma_f32_32x32x16_bf16 v[48:63], a[132:135], v[4:7], v[48:63]
  v_exp_f32 v33, v33
  v_and_b32 v251, 15, v255
  v_lshl_add_u32 v236, v251, 4, v250
  v_add_u32 v237, 8192, v236
  v_mfma_f32_32x32x16_bf16 v[48:63], a[136:139], v[8:11], v[48:63]
  v_exp_f32 v34, v34
  s_lshl_b32 s60, s3, 19
  s_lshl_b32 s6, s5, 8
  s_add_u32 s60, s60, s6
  v_mfma_f32_32x32x16_bf16 v[48:63], a[140:143], v[12:15], v[48:63]
  v_exp_f32 v35, v35
  s_lshl_b32 s6, s4, 6
  s_lshl_b32 s7, s3, 3
  s_add_u32 s6, s6, s7
  v_mfma_f32_32x32x16_bf16 v[48:63], a[144:147], v[16:19], v[48:63]
  v_exp_f32 v36, v36
  v_add_f32 v92, v92, v32
  s_lshl_b32 s6, s6, 10
  v_and_b32 v250, 7, v255
  v_lshlrev_b32 v250, 21, v250
  v_mfma_f32_32x32x16_bf16 v[48:63], a[148:151], v[20:23], v[48:63]
  v_exp_f32 v37, v37
  buffer_load_dword v232, v250, s[28:31], s6 offen
  v_mfma_f32_32x32x16_bf16 v[48:63], a[152:155], v[24:27], v[48:63]
  v_add_f32 v93, v93, v33
  v_cvt_pk_bf16_f32 v64, v32, v33
  v_exp_f32 v38, v38
  v_add_f32 v92, v92, v34
  v_mov_b32 v250, s6
  v_mfma_f32_32x32x16_bf16 v[48:63], a[156:159], v[28:31], v[48:63]
  v_exp_f32 v39, v39
  global_load_dword v232, v250, s[52:53]
  v_mfma_f32_32x32x16_bf16 a[64:79], a[160:163], v[72:75], a[64:79]
  v_add_f32 v93, v93, v35
  v_cvt_pk_bf16_f32 v65, v34, v35
  ds_read_b128 a[128:131], v80 offset:57344
  v_mfma_f32_32x32x16_bf16 a[80:95], a[168:171], v[72:75], a[80:95]
  v_exp_f32 v40, v40
  v_add_f32 v92, v92, v36
  ds_read_b128 a[132:135], v81 offset:57344
  v_mfma_f32_32x32x16_bf16 a[96:111], a[176:179], v[72:75], a[96:111]
  v_exp_f32 v41, v41
  v_add_f32 v93, v93, v37
  ds_read_b128 a[136:139], v82 offset:57344
  v_mfma_f32_32x32x16_bf16 a[112:127], a[184:187], v[72:75], a[112:127]
  v_cvt_pk_bf16_f32 v66, v36, v37
  v_exp_f32 v42, v42
  ds_read_b128 a[140:143], v83 offset:57344
  v_mfma_f32_32x32x16_bf16 a[64:79], a[164:167], v[76:79], a[64:79]
  v_add_f32 v92, v92, v38
  v_exp_f32 v43, v43
  ds_read_b128 a[144:147], v84 offset:57344
  v_mfma_f32_32x32x16_bf16 a[80:95], a[172:175], v[76:79], a[80:95]
  v_add_f32 v93, v93, v39
  v_cvt_pk_bf16_f32 v67, v38, v39
  ds_read_b128 a[148:151], v85 offset:57344
  v_mfma_f32_32x32x16_bf16 a[96:111], a[180:183], v[76:79], a[96:111]
  v_exp_f32 v44, v44
  v_add_f32 v92, v92, v40
  ds_read_b128 a[152:155], v86 offset:57344
  v_mfma_f32_32x32x16_bf16 a[112:127], a[188:191], v[76:79], a[112:127]
  v_exp_f32 v45, v45
  v_add_f32 v93, v93, v41
  v_cvt_pk_bf16_f32 v68, v40, v41
  v_exp_f32 v46, v46
  v_add_f32 v92, v92, v42
  v_exp_f32 v47, v47
  v_add_f32 v93, v93, v43
  v_cvt_pk_bf16_f32 v69, v42, v43
  v_add_f32 v92, v92, v44
  v_add_f32 v93, v93, v45
  v_cvt_pk_bf16_f32 v70, v44, v45
  v_add_f32 v92, v92, v46
  v_add_f32 v93, v93, v47
  v_cvt_pk_bf16_f32 v71, v46, v47
  ds_read_b128 a[156:159], v87 offset:57344
  s_waitcnt lgkmcnt(4)
  v_mfma_f32_32x32x16_bf16 v[32:47], a[128:131], v[128:131], 0
  v_exp_f32 v48, v48
  ds_read_b64_tr_b16 a[160:161], v88 offset:57344
  ds_read_b64_tr_b16 a[162:163], v88 offset:59392
  v_mfma_f32_32x32x16_bf16 v[32:47], a[132:135], v[132:135], v[32:47]
  v_exp_f32 v49, v49
  ds_read_b64_tr_b16 a[168:169], v89 offset:57344
  ds_read_b64_tr_b16 a[170:171], v89 offset:59392
  v_mfma_f32_32x32x16_bf16 v[32:47], a[136:139], v[136:139], v[32:47]
  v_exp_f32 v50, v50
  ds_read_b64_tr_b16 a[176:177], v90 offset:57344
  ds_read_b64_tr_b16 a[178:179], v90 offset:59392
  v_mfma_f32_32x32x16_bf16 v[32:47], a[140:143], v[140:143], v[32:47]
  v_exp_f32 v51, v51
  ds_read_b64_tr_b16 a[184:185], v91 offset:57344
  ds_read_b64_tr_b16 a[186:187], v91 offset:59392
  s_waitcnt lgkmcnt(8)
  v_mfma_f32_32x32x16_bf16 v[32:47], a[144:147], v[144:147], v[32:47]
  v_exp_f32 v52, v52
  ds_read_b64_tr_b16 a[164:165], v88 offset:61440
  ds_read_b64_tr_b16 a[166:167], v88 offset:63488
  v_mfma_f32_32x32x16_bf16 v[32:47], a[148:151], v[148:151], v[32:47]
  v_add_f32 v94, v94, v48
  ds_read_b64_tr_b16 a[172:173], v89 offset:61440
  ds_read_b64_tr_b16 a[174:175], v89 offset:63488
  v_mfma_f32_32x32x16_bf16 v[32:47], a[152:155], v[152:155], v[32:47]
  v_exp_f32 v53, v53
  ds_read_b64_tr_b16 a[180:181], v90 offset:61440
  ds_read_b64_tr_b16 a[182:183], v90 offset:63488
  v_mfma_f32_32x32x16_bf16 v[32:47], a[156:159], v[156:159], v[32:47]
  v_add_f32 v95, v95, v49
  v_cvt_pk_bf16_f32 v72, v48, v49
  ds_read_b64_tr_b16 a[188:189], v91 offset:61440
  ds_read_b64_tr_b16 a[190:191], v91 offset:63488
  s_waitcnt lgkmcnt(8)
  v_mfma_f32_32x32x16_bf16 a[0:15], a[160:163], v[64:67], a[0:15]
  v_exp_f32 v54, v54
  v_add_f32 v94, v94, v50
  v_exp_f32 v55, v55
  v_and_b32 v250, 31, v255
  v_mfma_f32_32x32x16_bf16 a[16:31], a[168:171], v[64:67], a[16:31]
  v_add_f32 v95, v95, v51
  v_cvt_pk_bf16_f32 v73, v50, v51
  v_exp_f32 v56, v56
  v_add_f32 v94, v94, v52
  v_lshlrev_b32 v250, 8, v250
  v_mfma_f32_32x32x16_bf16 a[32:47], a[176:179], v[64:67], a[32:47]
  v_exp_f32 v57, v57
  v_add_f32 v95, v95, v53
  v_cvt_pk_bf16_f32 v74, v52, v53
  s_mov_b32 s6, 16810112
  v_mfma_f32_32x32x16_bf16 a[48:63], a[184:187], v[64:67], a[48:63]
  v_exp_f32 v58, v58
  v_add_f32 v94, v94, v54
  v_exp_f32 v59, v59
  v_add_f32 v95, v95, v55
  s_waitcnt lgkmcnt(0)
  v_mfma_f32_32x32x16_bf16 a[0:15], a[164:167], v[68:71], a[0:15]
  v_cvt_pk_bf16_f32 v75, v54, v55
  v_exp_f32 v60, v60
  v_add_f32 v94, v94, v56
  v_exp_f32 v61, v61
  v_mfma_f32_32x32x16_bf16 a[16:31], a[172:175], v[68:71], a[16:31]
  v_add_f32 v95, v95, v57
  v_cvt_pk_bf16_f32 v76, v56, v57
  buffer_load_dword a200, v250, s[28:31], s6 offen sc1
  v_mfma_f32_32x32x16_bf16 a[32:47], a[180:183], v[68:71], a[32:47]
  v_exp_f32 v62, v62
  v_add_f32 v94, v94, v58
  v_exp_f32 v63, v63
  v_add_f32 v95, v95, v59
  v_mfma_f32_32x32x16_bf16 a[48:63], a[188:191], v[68:71], a[48:63]
  v_cvt_pk_bf16_f32 v77, v58, v59
  v_add_f32 v94, v94, v60
  v_add_f32 v95, v95, v61
  v_cvt_pk_bf16_f32 v78, v60, v61
  v_add_f32 v94, v94, v62
  v_add_f32 v95, v95, v63
  v_cvt_pk_bf16_f32 v79, v62, v63
  s_waitcnt vmcnt(3)
  s_barrier
  v_mfma_f32_32x32x16_bf16 v[48:63], a[128:131], v[0:3], 0
  v_exp_f32 v32, v32
  v_exp_f32 v33, v33
  v_mfma_f32_32x32x16_bf16 v[48:63], a[132:135], v[4:7], v[48:63]
  v_exp_f32 v34, v34
  v_exp_f32 v35, v35
  v_exp_f32 v36, v36
  v_mfma_f32_32x32x16_bf16 v[48:63], a[136:139], v[8:11], v[48:63]
  v_add_f32 v92, v92, v32
  v_exp_f32 v37, v37
  v_add_f32 v93, v93, v33
  v_mfma_f32_32x32x16_bf16 v[48:63], a[140:143], v[12:15], v[48:63]
  v_cvt_pk_bf16_f32 v64, v32, v33
  v_exp_f32 v38, v38
  v_add_f32 v92, v92, v34
  v_mfma_f32_32x32x16_bf16 v[48:63], a[144:147], v[16:19], v[48:63]
  v_exp_f32 v39, v39
  v_add_f32 v93, v93, v35
  v_cvt_pk_bf16_f32 v65, v34, v35
  v_exp_f32 v40, v40
  v_mfma_f32_32x32x16_bf16 v[48:63], a[148:151], v[20:23], v[48:63]
  v_add_f32 v92, v92, v36
  v_exp_f32 v41, v41
  v_add_f32 v93, v93, v37
  v_mfma_f32_32x32x16_bf16 v[48:63], a[152:155], v[24:27], v[48:63]
  v_cvt_pk_bf16_f32 v66, v36, v37
  v_exp_f32 v42, v42
  v_add_f32 v92, v92, v38
  v_mfma_f32_32x32x16_bf16 v[48:63], a[156:159], v[28:31], v[48:63]
  v_exp_f32 v43, v43
  v_add_f32 v93, v93, v39
  v_cvt_pk_bf16_f32 v67, v38, v39
  v_exp_f32 v44, v44
  v_mfma_f32_32x32x16_bf16 a[64:79], a[160:163], v[72:75], a[64:79]
  v_add_f32 v92, v92, v40
  ds_read_b128 a[128:131], v80 offset:0
  v_mfma_f32_32x32x16_bf16 a[80:95], a[168:171], v[72:75], a[80:95]
  v_exp_f32 v45, v45
  v_add_f32 v93, v93, v41
  ds_read_b128 a[132:135], v81 offset:0
  v_mfma_f32_32x32x16_bf16 a[96:111], a[176:179], v[72:75], a[96:111]
  v_cvt_pk_bf16_f32 v68, v40, v41
  v_exp_f32 v46, v46
  ds_read_b128 a[136:139], v82 offset:0
  v_mfma_f32_32x32x16_bf16 a[112:127], a[184:187], v[72:75], a[112:127]
  v_add_f32 v92, v92, v42
  ds_read_b128 a[140:143], v83 offset:0
  v_mfma_f32_32x32x16_bf16 a[64:79], a[164:167], v[76:79], a[64:79]
  v_exp_f32 v47, v47
  v_add_f32 v93, v93, v43
  ds_read_b128 a[144:147], v84 offset:0
  v_mfma_f32_32x32x16_bf16 a[80:95], a[172:175], v[76:79], a[80:95]
  v_cvt_pk_bf16_f32 v69, v42, v43
  v_add_f32 v92, v92, v44
  ds_read_b128 a[148:151], v85 offset:0
  v_mfma_f32_32x32x16_bf16 a[96:111], a[180:183], v[76:79], a[96:111]
  v_add_f32 v93, v93, v45
  v_cvt_pk_bf16_f32 v70, v44, v45
  v_add_f32 v92, v92, v46
  ds_read_b128 a[152:155], v86 offset:0
  v_mfma_f32_32x32x16_bf16 a[112:127], a[188:191], v[76:79], a[112:127]
  v_add_f32 v93, v93, v47
  v_cvt_pk_bf16_f32 v71, v46, v47
  ds_read_b128 a[156:159], v87 offset:0
  s_waitcnt lgkmcnt(4)
  v_mfma_f32_32x32x16_bf16 v[32:47], a[128:131], v[128:131], 0
  v_exp_f32 v48, v48
  ds_read_b64_tr_b16 a[160:161], v88 offset:0
  ds_read_b64_tr_b16 a[162:163], v88 offset:2048
  v_mfma_f32_32x32x16_bf16 v[32:47], a[132:135], v[132:135], v[32:47]
  v_exp_f32 v49, v49
  ds_read_b64_tr_b16 a[168:169], v89 offset:0
  ds_read_b64_tr_b16 a[170:171], v89 offset:2048
  v_mfma_f32_32x32x16_bf16 v[32:47], a[136:139], v[136:139], v[32:47]
  v_exp_f32 v50, v50
  ds_read_b64_tr_b16 a[176:177], v90 offset:0
  ds_read_b64_tr_b16 a[178:179], v90 offset:2048
  v_mfma_f32_32x32x16_bf16 v[32:47], a[140:143], v[140:143], v[32:47]
  v_exp_f32 v51, v51
  ds_read_b64_tr_b16 a[184:185], v91 offset:0
  ds_read_b64_tr_b16 a[186:187], v91 offset:2048
  s_waitcnt lgkmcnt(8)
  v_mfma_f32_32x32x16_bf16 v[32:47], a[144:147], v[144:147], v[32:47]
  v_exp_f32 v52, v52
  ds_read_b64_tr_b16 a[164:165], v88 offset:4096
  ds_read_b64_tr_b16 a[166:167], v88 offset:6144
  v_mfma_f32_32x32x16_bf16 v[32:47], a[148:151], v[148:151], v[32:47]
  v_add_f32 v94, v94, v48
  ds_read_b64_tr_b16 a[172:173], v89 offset:4096
  ds_read_b64_tr_b16 a[174:175], v89 offset:6144
  v_mfma_f32_32x32x16_bf16 v[32:47], a[152:155], v[152:155], v[32:47]
  v_exp_f32 v53, v53
  ds_read_b64_tr_b16 a[180:181], v90 offset:4096
  ds_read_b64_tr_b16 a[182:183], v90 offset:6144
  v_mfma_f32_32x32x16_bf16 v[32:47], a[156:159], v[156:159], v[32:47]
  v_add_f32 v95, v95, v49
  v_cvt_pk_bf16_f32 v72, v48, v49
  ds_read_b64_tr_b16 a[188:189], v91 offset:4096
  ds_read_b64_tr_b16 a[190:191], v91 offset:6144
  s_waitcnt lgkmcnt(8)
  v_mfma_f32_32x32x16_bf16 a[0:15], a[160:163], v[64:67], a[0:15]
  v_exp_f32 v54, v54
  v_add_f32 v94, v94, v50
  s_add_u32 m0, s63, 98304
  s_mov_b32 s62, 122880
  v_mfma_f32_32x32x16_bf16 a[16:31], a[168:171], v[64:67], a[16:31]
  v_exp_f32 v55, v55
  buffer_load_dwordx4 v249, s[24:27], s62 offen lds
  v_mfma_f32_32x32x16_bf16 a[32:47], a[176:179], v[64:67], a[32:47]
  v_add_f32 v95, v95, v51
  v_cvt_pk_bf16_f32 v73, v50, v51
  buffer_load_dwordx4 v249, s[24:27], s62 offen offset:1024 lds
  v_mfma_f32_32x32x16_bf16 a[48:63], a[184:187], v[64:67], a[48:63]
  v_exp_f32 v56, v56
  v_add_f32 v94, v94, v52
  s_waitcnt vmcnt(2)
  v_accvgpr_read_b32 v121, a200
  s_waitcnt lgkmcnt(0)
  v_mfma_f32_32x32x16_bf16 a[0:15], a[164:167], v[68:71], a[0:15]
  v_exp_f32 v57, v57
  v_add_f32 v95, v95, v53
  s_nop 0
  v_cmp_ne_u32 vcc, 8, v121
  s_nop 4
  v_mfma_f32_32x32x16_bf16 a[16:31], a[172:175], v[68:71], a[16:31]
  v_cvt_pk_bf16_f32 v74, v52, v53
  v_exp_f32 v58, v58
  v_add_f32 v94, v94, v54
  s_cbranch_vccnz L_cnt1spin
  L_cnt1ok:
  v_bfe_u32 v250, v255, 3, 1
  v_mfma_f32_32x32x16_bf16 a[32:47], a[180:183], v[68:71], a[32:47]
  v_exp_f32 v59, v59
  v_add_f32 v95, v95, v55
  v_lshlrev_b32 v250, 4, v250
  v_lshrrev_b32 v251, 4, v255
  v_lshl_add_u32 v250, v251, 2, v250
  v_mfma_f32_32x32x16_bf16 a[48:63], a[188:191], v[68:71], a[48:63]
  v_cvt_pk_bf16_f32 v75, v54, v55
  v_exp_f32 v60, v60
  v_add_f32 v94, v94, v56
  v_exp_f32 v61, v61
  v_add_f32 v95, v95, v57
  v_cvt_pk_bf16_f32 v76, v56, v57
  v_exp_f32 v62, v62
  v_add_f32 v94, v94, v58
  v_exp_f32 v63, v63
  v_add_f32 v95, v95, v59
  v_cvt_pk_bf16_f32 v77, v58, v59
  v_add_f32 v94, v94, v60
  v_add_f32 v95, v95, v61
  v_cvt_pk_bf16_f32 v78, v60, v61
  v_add_f32 v94, v94, v62
  v_add_f32 v95, v95, v63
  v_cvt_pk_bf16_f32 v79, v62, v63
  v_mul_u32_u24 v250, 7168, v250
  v_and_b32 v251, 7, v255
  v_lshl_add_u32 v250, v251, 2, v250
  v_mfma_f32_32x32x16_bf16 v[48:63], a[128:131], v[0:3], 0
  v_exp_f32 v32, v32
  s_mul_i32 s6, s3, 28
  s_min_u32 s7, s4, 27
  s_add_u32 s6, s6, s7
  v_mfma_f32_32x32x16_bf16 v[48:63], a[132:135], v[4:7], v[48:63]
  v_exp_f32 v33, v33
  v_exp_f32 v34, v34
  s_lshl_b32 s6, s6, 5
  s_add_u32 s6, s6, 16834560
  v_mfma_f32_32x32x16_bf16 v[48:63], a[136:139], v[8:11], v[48:63]
  v_exp_f32 v35, v35
  buffer_load_dword a204, v250, s[28:31], s6 offen sc1
  v_mfma_f32_32x32x16_bf16 v[48:63], a[140:143], v[12:15], v[48:63]
  s_add_u32 s6, s6, 7168
  buffer_load_dword a205, v250, s[28:31], s6 offen sc1
  v_mfma_f32_32x32x16_bf16 v[48:63], a[144:147], v[16:19], v[48:63]
  v_exp_f32 v36, v36
  v_add_f32 v92, v92, v32
  v_exp_f32 v37, v37
  s_add_u32 s6, s6, 7168
  v_mfma_f32_32x32x16_bf16 v[48:63], a[148:151], v[20:23], v[48:63]
  v_add_f32 v93, v93, v33
  v_cvt_pk_bf16_f32 v64, v32, v33
  buffer_load_dword a206, v250, s[28:31], s6 offen sc1
  v_mfma_f32_32x32x16_bf16 v[48:63], a[152:155], v[24:27], v[48:63]
  v_exp_f32 v38, v38
  v_add_f32 v92, v92, v34
  v_exp_f32 v39, v39
  s_add_u32 s6, s6, 7168
  v_mfma_f32_32x32x16_bf16 v[48:63], a[156:159], v[28:31], v[48:63]
  v_add_f32 v93, v93, v35
  buffer_load_dword a207, v250, s[28:31], s6 offen sc1
  s_add_u32 s6, s6, 7168
  v_mfma_f32_32x32x16_bf16 a[64:79], a[160:163], v[72:75], a[64:79]
  v_cvt_pk_bf16_f32 v65, v34, v35
  v_exp_f32 v40, v40
  ds_read_b128 a[128:131], v80 offset:8192
  v_mfma_f32_32x32x16_bf16 a[80:95], a[168:171], v[72:75], a[80:95]
  v_add_f32 v92, v92, v36
  v_exp_f32 v41, v41
  ds_read_b128 a[132:135], v81 offset:8192
  v_mfma_f32_32x32x16_bf16 a[96:111], a[176:179], v[72:75], a[96:111]
  v_add_f32 v93, v93, v37
  v_cvt_pk_bf16_f32 v66, v36, v37
  ds_read_b128 a[136:139], v82 offset:8192
  v_mfma_f32_32x32x16_bf16 a[112:127], a[184:187], v[72:75], a[112:127]
  v_exp_f32 v42, v42
  v_add_f32 v92, v92, v38
  ds_read_b128 a[140:143], v83 offset:8192
  v_mfma_f32_32x32x16_bf16 a[64:79], a[164:167], v[76:79], a[64:79]
  v_exp_f32 v43, v43
  v_add_f32 v93, v93, v39
  ds_read_b128 a[144:147], v84 offset:8192
  v_mfma_f32_32x32x16_bf16 a[80:95], a[172:175], v[76:79], a[80:95]
  v_cvt_pk_bf16_f32 v67, v38, v39
  v_exp_f32 v44, v44
  ds_read_b128 a[148:151], v85 offset:8192
  v_mfma_f32_32x32x16_bf16 a[96:111], a[180:183], v[76:79], a[96:111]
  v_add_f32 v92, v92, v40
  v_exp_f32 v45, v45
  ds_read_b128 a[152:155], v86 offset:8192
  v_mfma_f32_32x32x16_bf16 a[112:127], a[188:191], v[76:79], a[112:127]
  v_add_f32 v93, v93, v41
  v_cvt_pk_bf16_f32 v68, v40, v41
  v_exp_f32 v46, v46
  v_add_f32 v92, v92, v42
  v_exp_f32 v47, v47
  v_add_f32 v93, v93, v43
  v_cvt_pk_bf16_f32 v69, v42, v43
  v_add_f32 v92, v92, v44
  v_add_f32 v93, v93, v45
  v_cvt_pk_bf16_f32 v70, v44, v45
  v_add_f32 v92, v92, v46
  v_add_f32 v93, v93, v47
  v_cvt_pk_bf16_f32 v71, v46, v47
  ds_read_b128 a[156:159], v87 offset:8192
  s_waitcnt lgkmcnt(4)
  v_mfma_f32_32x32x16_bf16 v[32:47], a[128:131], v[128:131], 0
  v_exp_f32 v48, v48
  ds_read_b64_tr_b16 a[160:161], v88 offset:8192
  ds_read_b64_tr_b16 a[162:163], v88 offset:10240
  v_mfma_f32_32x32x16_bf16 v[32:47], a[132:135], v[132:135], v[32:47]
  v_exp_f32 v49, v49
  ds_read_b64_tr_b16 a[168:169], v89 offset:8192
  ds_read_b64_tr_b16 a[170:171], v89 offset:10240
  v_mfma_f32_32x32x16_bf16 v[32:47], a[136:139], v[136:139], v[32:47]
  v_exp_f32 v50, v50
  ds_read_b64_tr_b16 a[176:177], v90 offset:8192
  ds_read_b64_tr_b16 a[178:179], v90 offset:10240
  v_mfma_f32_32x32x16_bf16 v[32:47], a[140:143], v[140:143], v[32:47]
  v_exp_f32 v51, v51
  ds_read_b64_tr_b16 a[184:185], v91 offset:8192
  ds_read_b64_tr_b16 a[186:187], v91 offset:10240
  s_waitcnt lgkmcnt(8)
  v_mfma_f32_32x32x16_bf16 v[32:47], a[144:147], v[144:147], v[32:47]
  v_exp_f32 v52, v52
  ds_read_b64_tr_b16 a[164:165], v88 offset:12288
  ds_read_b64_tr_b16 a[166:167], v88 offset:14336
  v_mfma_f32_32x32x16_bf16 v[32:47], a[148:151], v[148:151], v[32:47]
  v_add_f32 v94, v94, v48
  ds_read_b64_tr_b16 a[172:173], v89 offset:12288
  ds_read_b64_tr_b16 a[174:175], v89 offset:14336
  v_mfma_f32_32x32x16_bf16 v[32:47], a[152:155], v[152:155], v[32:47]
  v_exp_f32 v53, v53
  ds_read_b64_tr_b16 a[180:181], v90 offset:12288
  ds_read_b64_tr_b16 a[182:183], v90 offset:14336
  v_mfma_f32_32x32x16_bf16 v[32:47], a[156:159], v[156:159], v[32:47]
  v_add_f32 v95, v95, v49
  v_cvt_pk_bf16_f32 v72, v48, v49
  ds_read_b64_tr_b16 a[188:189], v91 offset:12288
  ds_read_b64_tr_b16 a[190:191], v91 offset:14336
  s_waitcnt lgkmcnt(8)
  v_mfma_f32_32x32x16_bf16 a[0:15], a[160:163], v[64:67], a[0:15]
  v_exp_f32 v54, v54
  buffer_load_dwordx4 v[160:163], v236, s[16:19], s60 offen offset:0
  v_mfma_f32_32x32x16_bf16 a[16:31], a[168:171], v[64:67], a[16:31]
  v_add_f32 v94, v94, v50
  buffer_load_dwordx4 v[164:167], v236, s[16:19], s60 offen offset:1024
  v_mfma_f32_32x32x16_bf16 a[32:47], a[176:179], v[64:67], a[32:47]
  v_exp_f32 v55, v55
  buffer_load_dwordx4 v[168:171], v236, s[16:19], s60 offen offset:2048
  v_mfma_f32_32x32x16_bf16 a[48:63], a[184:187], v[64:67], a[48:63]
  v_add_f32 v95, v95, v51
  v_cvt_pk_bf16_f32 v73, v50, v51
  buffer_load_dwordx4 v[172:175], v236, s[16:19], s60 offen offset:3072
  s_waitcnt lgkmcnt(0)
  v_mfma_f32_32x32x16_bf16 a[0:15], a[164:167], v[68:71], a[0:15]
  buffer_load_dwordx4 v[176:179], v237, s[16:19], s60 offen offset:0
  s_cmp_lt_u32 s4, 28
  s_cselect_b32 s98, 1.0, 0
  v_mfma_f32_32x32x16_bf16 a[16:31], a[172:175], v[68:71], a[16:31]
  s_waitcnt vmcnt(5)
  v_accvgpr_read_b32 v108, a204
  v_accvgpr_read_b32 v109, a205
  v_accvgpr_read_b32 v110, a206
  v_accvgpr_read_b32 v111, a207
  v_mfma_f32_32x32x16_bf16 a[32:47], a[180:183], v[68:71], a[32:47]
  v_accvgpr_read_b32 v112, a244
  v_accvgpr_read_b32 v113, a245
  v_accvgpr_read_b32 v114, a246
  v_accvgpr_read_b32 v115, a247
  v_accvgpr_read_b32 v116, a248
  v_mfma_f32_32x32x16_bf16 a[48:63], a[188:191], v[68:71], a[48:63]
  v_exp_f32 v56, v56
  v_add_f32 v94, v94, v52
  v_exp_f32 v57, v57
  v_add_f32 v95, v95, v53
  v_cvt_pk_bf16_f32 v74, v52, v53
  v_exp_f32 v58, v58
  v_add_f32 v94, v94, v54
  v_exp_f32 v59, v59
  v_add_f32 v95, v95, v55
  v_cvt_pk_bf16_f32 v75, v54, v55
  v_exp_f32 v60, v60
  v_add_f32 v94, v94, v56
  v_exp_f32 v61, v61
  v_add_f32 v95, v95, v57
  v_cvt_pk_bf16_f32 v76, v56, v57
  v_exp_f32 v62, v62
  v_add_f32 v94, v94, v58
  v_exp_f32 v63, v63
  v_add_f32 v95, v95, v59
  v_cvt_pk_bf16_f32 v77, v58, v59
  v_add_f32 v94, v94, v60
  v_add_f32 v95, v95, v61
  v_cvt_pk_bf16_f32 v78, v60, v61
  v_add_f32 v94, v94, v62
  v_add_f32 v95, v95, v63
  v_cvt_pk_bf16_f32 v79, v62, v63
  v_accvgpr_read_b32 v117, a249
  v_accvgpr_read_b32 v118, a250
  v_accvgpr_read_b32 v119, a251
  v_add_f32 v108, v108, v109
  v_mfma_f32_32x32x16_bf16 v[48:63], a[128:131], v[0:3], 0
  v_add_f32 v110, v110, v111
  v_add_f32 v108, v108, v110
  s_nop 0
  v_mov_b32 v109, v108
  s_nop 1
  v_mfma_f32_32x32x16_bf16 v[48:63], a[132:135], v[4:7], v[48:63]
  v_permlane16_swap_b32 v108, v109
  s_nop 0
  v_add_f32 v108, v108, v109
  s_nop 0
  v_mfma_f32_32x32x16_bf16 v[48:63], a[136:139], v[8:11], v[48:63]
  v_mov_b32 v109, v108
  s_nop 1
  v_permlane32_swap_b32 v108, v109
  s_nop 0
  v_add_f32 v108, v108, v109
  v_mfma_f32_32x32x16_bf16 v[48:63], a[140:143], v[12:15], v[48:63]
  v_cvt_pk_bf16_f32 v108, v108, v108
  v_lshlrev_b32 v108, 16, v108
  v_mul_f32 v110, 0xbfb8aa3b, v108
  v_exp_f32 v110, v110
  v_mfma_f32_32x32x16_bf16 v[48:63], a[144:147], v[16:19], v[48:63]
  v_mov_b32_dpp v109, v108 row_ror:8 row_mask:0xf bank_mask:0xf
  v_add_f32 v110, 1.0, v110
  v_rcp_f32 v110, v110
  s_nop 0
  v_mfma_f32_32x32x16_bf16 v[48:63], a[148:151], v[20:23], v[48:63]
  v_mul_f32 v110, v108, v110
  v_cvt_pk_bf16_f32 v110, v110, v110
  v_lshlrev_b32 v110, 16, v110
  v_mul_f32 v110, v110, v109
  v_cvt_pk_bf16_f32 v110, v110, v110
  v_mfma_f32_32x32x16_bf16 v[48:63], a[152:155], v[24:27], v[48:63]
  v_lshlrev_b32 v110, 16, v110
  v_mul_f32 v110, s98, v110
  s_nop 0
  v_readlane_b32 s40, v110, 0
  v_readlane_b32 s41, v110, 1
  v_readlane_b32 s42, v110, 2
  v_mfma_f32_32x32x16_bf16 v[48:63], a[156:159], v[28:31], v[48:63]
  v_readlane_b32 s43, v110, 3
  v_readlane_b32 s44, v110, 4
  v_readlane_b32 s45, v110, 5
  v_readlane_b32 s46, v110, 6
  v_readlane_b32 s47, v110, 7
  v_mfma_f32_32x32x16_bf16 a[64:79], a[160:163], v[72:75], a[64:79]
  v_exp_f32 v32, v32
  ds_read_b128 a[128:131], v80 offset:16384
  v_mfma_f32_32x32x16_bf16 a[80:95], a[168:171], v[72:75], a[80:95]
  v_exp_f32 v33, v33
  ds_read_b128 a[132:135], v81 offset:16384
  v_mfma_f32_32x32x16_bf16 a[96:111], a[176:179], v[72:75], a[96:111]
  v_exp_f32 v34, v34
  ds_read_b128 a[136:139], v82 offset:16384
  v_mfma_f32_32x32x16_bf16 a[112:127], a[184:187], v[72:75], a[112:127]
  v_exp_f32 v35, v35
  ds_read_b128 a[140:143], v83 offset:16384
  v_mfma_f32_32x32x16_bf16 a[64:79], a[164:167], v[76:79], a[64:79]
  v_exp_f32 v36, v36
  v_add_f32 v92, v92, v32
  ds_read_b128 a[144:147], v84 offset:16384
  v_mfma_f32_32x32x16_bf16 a[80:95], a[172:175], v[76:79], a[80:95]
  v_exp_f32 v37, v37
  v_add_f32 v93, v93, v33
  ds_read_b128 a[148:151], v85 offset:16384
  v_mfma_f32_32x32x16_bf16 a[96:111], a[180:183], v[76:79], a[96:111]
  v_cvt_pk_bf16_f32 v64, v32, v33
  v_exp_f32 v38, v38
  ds_read_b128 a[152:155], v86 offset:16384
  v_mfma_f32_32x32x16_bf16 a[112:127], a[188:191], v[76:79], a[112:127]
  v_add_f32 v92, v92, v34
  v_exp_f32 v39, v39
  v_add_f32 v93, v93, v35
  v_cvt_pk_bf16_f32 v65, v34, v35
  v_exp_f32 v40, v40
  v_add_f32 v92, v92, v36
  v_exp_f32 v41, v41
  v_add_f32 v93, v93, v37
  v_cvt_pk_bf16_f32 v66, v36, v37
  v_exp_f32 v42, v42
  v_add_f32 v92, v92, v38
  v_exp_f32 v43, v43
  v_add_f32 v93, v93, v39
  v_cvt_pk_bf16_f32 v67, v38, v39
  v_exp_f32 v44, v44
  v_add_f32 v92, v92, v40
  v_exp_f32 v45, v45
  v_add_f32 v93, v93, v41
  v_cvt_pk_bf16_f32 v68, v40, v41
  v_exp_f32 v46, v46
  v_add_f32 v92, v92, v42
  v_exp_f32 v47, v47
  v_add_f32 v93, v93, v43
  v_cvt_pk_bf16_f32 v69, v42, v43
  v_add_f32 v92, v92, v44
  v_add_f32 v93, v93, v45
  v_cvt_pk_bf16_f32 v70, v44, v45
  v_add_f32 v92, v92, v46
  v_add_f32 v93, v93, v47
  v_cvt_pk_bf16_f32 v71, v46, v47
  ds_read_b128 a[156:159], v87 offset:16384
  s_waitcnt lgkmcnt(4)
  v_mfma_f32_32x32x16_bf16 v[32:47], a[128:131], v[128:131], 0
  v_exp_f32 v48, v48
  ds_read_b64_tr_b16 a[160:161], v88 offset:16384
  ds_read_b64_tr_b16 a[162:163], v88 offset:18432
  v_mfma_f32_32x32x16_bf16 v[32:47], a[132:135], v[132:135], v[32:47]
  v_exp_f32 v49, v49
  ds_read_b64_tr_b16 a[168:169], v89 offset:16384
  ds_read_b64_tr_b16 a[170:171], v89 offset:18432
  v_mfma_f32_32x32x16_bf16 v[32:47], a[136:139], v[136:139], v[32:47]
  v_exp_f32 v50, v50
  ds_read_b64_tr_b16 a[176:177], v90 offset:16384
  ds_read_b64_tr_b16 a[178:179], v90 offset:18432
  v_mfma_f32_32x32x16_bf16 v[32:47], a[140:143], v[140:143], v[32:47]
  v_exp_f32 v51, v51
  ds_read_b64_tr_b16 a[184:185], v91 offset:16384
  ds_read_b64_tr_b16 a[186:187], v91 offset:18432
  s_waitcnt lgkmcnt(8)
  v_mfma_f32_32x32x16_bf16 v[32:47], a[144:147], v[144:147], v[32:47]
  v_exp_f32 v52, v52
  ds_read_b64_tr_b16 a[164:165], v88 offset:20480
  ds_read_b64_tr_b16 a[166:167], v88 offset:22528
  v_mfma_f32_32x32x16_bf16 v[32:47], a[148:151], v[148:151], v[32:47]
  v_add_f32 v94, v94, v48
  ds_read_b64_tr_b16 a[172:173], v89 offset:20480
  ds_read_b64_tr_b16 a[174:175], v89 offset:22528
  v_mfma_f32_32x32x16_bf16 v[32:47], a[152:155], v[152:155], v[32:47]
  v_exp_f32 v53, v53
  ds_read_b64_tr_b16 a[180:181], v90 offset:20480
  ds_read_b64_tr_b16 a[182:183], v90 offset:22528
  v_mfma_f32_32x32x16_bf16 v[32:47], a[156:159], v[156:159], v[32:47]
  v_add_f32 v95, v95, v49
  v_cvt_pk_bf16_f32 v72, v48, v49
  ds_read_b64_tr_b16 a[188:189], v91 offset:20480
  ds_read_b64_tr_b16 a[190:191], v91 offset:22528
  s_waitcnt lgkmcnt(8)
  v_mfma_f32_32x32x16_bf16 a[0:15], a[160:163], v[64:67], a[0:15]
  v_exp_f32 v54, v54
  buffer_load_dwordx4 v[180:183], v237, s[16:19], s60 offen offset:1024
  v_mfma_f32_32x32x16_bf16 a[16:31], a[168:171], v[64:67], a[16:31]
  v_add_f32 v94, v94, v50
  buffer_load_dwordx4 v[184:187], v237, s[16:19], s60 offen offset:2048
  v_mfma_f32_32x32x16_bf16 a[32:47], a[176:179], v[64:67], a[32:47]
  v_exp_f32 v55, v55
  buffer_load_dwordx4 v[188:191], v237, s[16:19], s60 offen offset:3072
  v_mfma_f32_32x32x16_bf16 a[48:63], a[184:187], v[64:67], a[48:63]
  v_add_f32 v95, v95, v51
  s_add_u32 s60, s60, 32768
  buffer_load_dwordx4 v[192:195], v236, s[16:19], s60 offen offset:0
  s_waitcnt lgkmcnt(0)
  v_mfma_f32_32x32x16_bf16 a[0:15], a[164:167], v[68:71], a[0:15]
  v_cvt_pk_bf16_f32 v73, v50, v51
  buffer_load_dwordx4 v[196:199], v236, s[16:19], s60 offen offset:1024
  v_mfma_f32_32x32x16_bf16 a[16:31], a[172:175], v[68:71], a[16:31]
  v_exp_f32 v56, v56
  buffer_load_dwordx4 v[200:203], v236, s[16:19], s60 offen offset:2048
  v_mfma_f32_32x32x16_bf16 a[32:47], a[180:183], v[68:71], a[32:47]
  v_add_f32 v94, v94, v52
  v_exp_f32 v57, v57
  v_lshlrev_b32 v108, 16, v112
  v_and_b32 v109, s65, v112
  v_mul_f32 v104, s40, v108
  v_mfma_f32_32x32x16_bf16 a[48:63], a[188:191], v[68:71], a[48:63]
  v_add_f32 v95, v95, v53
  v_cvt_pk_bf16_f32 v74, v52, v53
  v_exp_f32 v58, v58
  v_add_f32 v94, v94, v54
  v_exp_f32 v59, v59
  v_add_f32 v95, v95, v55
  v_cvt_pk_bf16_f32 v75, v54, v55
  v_exp_f32 v60, v60
  v_add_f32 v94, v94, v56
  v_exp_f32 v61, v61
  v_add_f32 v95, v95, v57
  v_cvt_pk_bf16_f32 v76, v56, v57
  v_exp_f32 v62, v62
  v_add_f32 v94, v94, v58
  v_exp_f32 v63, v63
  v_add_f32 v95, v95, v59
  v_cvt_pk_bf16_f32 v77, v58, v59
  v_add_f32 v94, v94, v60
  v_add_f32 v95, v95, v61
  v_cvt_pk_bf16_f32 v78, v60, v61
  v_add_f32 v94, v94, v62
  v_add_f32 v95, v95, v63
  v_cvt_pk_bf16_f32 v79, v62, v63
  v_mul_f32 v105, s40, v109
  v_lshlrev_b32 v108, 16, v113
  v_and_b32 v109, s65, v113
  v_fmac_f32 v104, s41, v108
  v_mfma_f32_32x32x16_bf16 v[48:63], a[128:131], v[0:3], 0
  v_fmac_f32 v105, s41, v109
  v_lshlrev_b32 v108, 16, v114
  v_and_b32 v109, s65, v114
  v_fmac_f32 v104, s42, v108
  v_fmac_f32 v105, s42, v109
  v_mfma_f32_32x32x16_bf16 v[48:63], a[132:135], v[4:7], v[48:63]
  v_exp_f32 v32, v32
  v_lshlrev_b32 v108, 16, v115
  v_and_b32 v109, s65, v115
  v_fmac_f32 v104, s43, v108
  v_fmac_f32 v105, s43, v109
  v_mfma_f32_32x32x16_bf16 v[48:63], a[136:139], v[8:11], v[48:63]
  v_lshlrev_b32 v108, 16, v116
  v_and_b32 v109, s65, v116
  v_fmac_f32 v104, s44, v108
  v_fmac_f32 v105, s44, v109
  v_lshlrev_b32 v108, 16, v117
  v_mfma_f32_32x32x16_bf16 v[48:63], a[140:143], v[12:15], v[48:63]
  v_and_b32 v109, s65, v117
  v_fmac_f32 v104, s45, v108
  v_fmac_f32 v105, s45, v109
  v_lshlrev_b32 v108, 16, v118
  v_and_b32 v109, s65, v118
  v_mfma_f32_32x32x16_bf16 v[48:63], a[144:147], v[16:19], v[48:63]
  v_fmac_f32 v104, s46, v108
  v_fmac_f32 v105, s46, v109
  v_lshlrev_b32 v108, 16, v119
  v_and_b32 v109, s65, v119
  v_fmac_f32 v104, s47, v108
  v_mfma_f32_32x32x16_bf16 v[48:63], a[148:151], v[20:23], v[48:63]
  v_exp_f32 v33, v33
  v_fmac_f32 v105, s47, v109
  s_lshl_b32 s6, s5, 6
  v_add_u32 v250, s6, v255
  v_lshlrev_b32 v250, 2, v250
  v_mfma_f32_32x32x16_bf16 v[48:63], a[152:155], v[24:27], v[48:63]
  s_lshl_b32 s6, s3, 11
  s_add_u32 s6, s6, 16818176
  buffer_atomic_add_f32 v104, v250, s[28:31], s6 offen
  v_mfma_f32_32x32x16_bf16 v[48:63], a[156:159], v[28:31], v[48:63]
  v_exp_f32 v34, v34
  buffer_atomic_add_f32 v105, v250, s[28:31], s6 offen offset:1024
  v_mfma_f32_32x32x16_bf16 a[64:79], a[160:163], v[72:75], a[64:79]
  v_exp_f32 v35, v35
  ds_read_b128 a[128:131], v80 offset:24576
  v_mfma_f32_32x32x16_bf16 a[80:95], a[168:171], v[72:75], a[80:95]
  v_exp_f32 v36, v36
  v_add_f32 v92, v92, v32
  ds_read_b128 a[132:135], v81 offset:24576
  v_mfma_f32_32x32x16_bf16 a[96:111], a[176:179], v[72:75], a[96:111]
  v_exp_f32 v37, v37
  v_add_f32 v93, v93, v33
  ds_read_b128 a[136:139], v82 offset:24576
  v_mfma_f32_32x32x16_bf16 a[112:127], a[184:187], v[72:75], a[112:127]
  v_cvt_pk_bf16_f32 v64, v32, v33
  v_exp_f32 v38, v38
  ds_read_b128 a[140:143], v83 offset:24576
  v_mfma_f32_32x32x16_bf16 a[64:79], a[164:167], v[76:79], a[64:79]
  v_add_f32 v92, v92, v34
  v_exp_f32 v39, v39
  ds_read_b128 a[144:147], v84 offset:24576
  v_mfma_f32_32x32x16_bf16 a[80:95], a[172:175], v[76:79], a[80:95]
  v_add_f32 v93, v93, v35
  v_cvt_pk_bf16_f32 v65, v34, v35
  ds_read_b128 a[148:151], v85 offset:24576
  v_mfma_f32_32x32x16_bf16 a[96:111], a[180:183], v[76:79], a[96:111]
  v_exp_f32 v40, v40
  v_add_f32 v92, v92, v36
  ds_read_b128 a[152:155], v86 offset:24576
  v_mfma_f32_32x32x16_bf16 a[112:127], a[188:191], v[76:79], a[112:127]
  v_exp_f32 v41, v41
  v_add_f32 v93, v93, v37
  v_cvt_pk_bf16_f32 v66, v36, v37
  v_exp_f32 v42, v42
  v_add_f32 v92, v92, v38
  v_exp_f32 v43, v43
  v_add_f32 v93, v93, v39
  v_cvt_pk_bf16_f32 v67, v38, v39
  v_exp_f32 v44, v44
  v_add_f32 v92, v92, v40
  v_exp_f32 v45, v45
  v_add_f32 v93, v93, v41
  v_cvt_pk_bf16_f32 v68, v40, v41
  v_exp_f32 v46, v46
  v_add_f32 v92, v92, v42
  v_exp_f32 v47, v47
  v_add_f32 v93, v93, v43
  v_cvt_pk_bf16_f32 v69, v42, v43
  v_add_f32 v92, v92, v44
  v_add_f32 v93, v93, v45
  v_cvt_pk_bf16_f32 v70, v44, v45
  v_add_f32 v92, v92, v46
  v_add_f32 v93, v93, v47
  v_cvt_pk_bf16_f32 v71, v46, v47
  ds_read_b128 a[156:159], v87 offset:24576
  s_waitcnt lgkmcnt(4)
  v_mfma_f32_32x32x16_bf16 v[32:47], a[128:131], v[128:131], 0
  v_exp_f32 v48, v48
  ds_read_b64_tr_b16 a[160:161], v88 offset:24576
  ds_read_b64_tr_b16 a[162:163], v88 offset:26624
  v_mfma_f32_32x32x16_bf16 v[32:47], a[132:135], v[132:135], v[32:47]
  v_exp_f32 v49, v49
  ds_read_b64_tr_b16 a[168:169], v89 offset:24576
  ds_read_b64_tr_b16 a[170:171], v89 offset:26624
  v_mfma_f32_32x32x16_bf16 v[32:47], a[136:139], v[136:139], v[32:47]
  v_exp_f32 v50, v50
  ds_read_b64_tr_b16 a[176:177], v90 offset:24576
  ds_read_b64_tr_b16 a[178:179], v90 offset:26624
  v_mfma_f32_32x32x16_bf16 v[32:47], a[140:143], v[140:143], v[32:47]
  v_exp_f32 v51, v51
  ds_read_b64_tr_b16 a[184:185], v91 offset:24576
  ds_read_b64_tr_b16 a[186:187], v91 offset:26624
  s_waitcnt lgkmcnt(8)
  v_mfma_f32_32x32x16_bf16 v[32:47], a[144:147], v[144:147], v[32:47]
  v_exp_f32 v52, v52
  ds_read_b64_tr_b16 a[164:165], v88 offset:28672
  ds_read_b64_tr_b16 a[166:167], v88 offset:30720
  v_mfma_f32_32x32x16_bf16 v[32:47], a[148:151], v[148:151], v[32:47]
  v_add_f32 v94, v94, v48
  ds_read_b64_tr_b16 a[172:173], v89 offset:28672
  ds_read_b64_tr_b16 a[174:175], v89 offset:30720
  v_mfma_f32_32x32x16_bf16 v[32:47], a[152:155], v[152:155], v[32:47]
  v_exp_f32 v53, v53
  ds_read_b64_tr_b16 a[180:181], v90 offset:28672
  ds_read_b64_tr_b16 a[182:183], v90 offset:30720
  v_mfma_f32_32x32x16_bf16 v[32:47], a[156:159], v[156:159], v[32:47]
  v_add_f32 v95, v95, v49
  v_cvt_pk_bf16_f32 v72, v48, v49
  ds_read_b64_tr_b16 a[188:189], v91 offset:28672
  ds_read_b64_tr_b16 a[190:191], v91 offset:30720
  s_waitcnt lgkmcnt(8)
  v_mfma_f32_32x32x16_bf16 a[0:15], a[160:163], v[64:67], a[0:15]
  v_exp_f32 v54, v54
  buffer_load_dwordx4 v[204:207], v236, s[16:19], s60 offen offset:3072
  v_mfma_f32_32x32x16_bf16 a[16:31], a[168:171], v[64:67], a[16:31]
  v_add_f32 v94, v94, v50
  buffer_load_dwordx4 v[208:211], v237, s[16:19], s60 offen offset:0
  v_mfma_f32_32x32x16_bf16 a[32:47], a[176:179], v[64:67], a[32:47]
  v_exp_f32 v55, v55
  buffer_load_dwordx4 v[212:215], v237, s[16:19], s60 offen offset:1024
  v_mfma_f32_32x32x16_bf16 a[48:63], a[184:187], v[64:67], a[48:63]
  v_add_f32 v95, v95, v51
  v_cvt_pk_bf16_f32 v73, v50, v51
  v_exp_f32 v56, v56
  v_add_f32 v94, v94, v52
  s_waitcnt lgkmcnt(0)
  v_mfma_f32_32x32x16_bf16 a[0:15], a[164:167], v[68:71], a[0:15]
  v_exp_f32 v57, v57
  buffer_load_dwordx4 v[216:219], v237, s[16:19], s60 offen offset:2048
  v_mfma_f32_32x32x16_bf16 a[16:31], a[172:175], v[68:71], a[16:31]
  v_add_f32 v95, v95, v53
  v_cvt_pk_bf16_f32 v74, v52, v53
  buffer_load_dwordx4 v[220:223], v237, s[16:19], s60 offen offset:3072
  v_mfma_f32_32x32x16_bf16 a[32:47], a[180:183], v[68:71], a[32:47]
  v_exp_f32 v58, v58
  s_add_u32 s60, s60, 32768
  v_lshrrev_b32 v252, 4, v255
  v_and_b32 v251, 15, v255
  v_lshlrev_b32 v253, 12, v252
  v_mfma_f32_32x32x16_bf16 a[48:63], a[188:191], v[68:71], a[48:63]
  v_add_f32 v94, v94, v54
  v_exp_f32 v59, v59
  v_add_f32 v95, v95, v55
  v_cvt_pk_bf16_f32 v75, v54, v55
  v_exp_f32 v60, v60
  v_add_f32 v94, v94, v56
  v_exp_f32 v61, v61
  v_add_f32 v95, v95, v57
  v_cvt_pk_bf16_f32 v76, v56, v57
  v_exp_f32 v62, v62
  v_add_f32 v94, v94, v58
  v_exp_f32 v63, v63
  v_add_f32 v95, v95, v59
  v_cvt_pk_bf16_f32 v77, v58, v59
  v_add_f32 v94, v94, v60
  v_add_f32 v95, v95, v61
  v_cvt_pk_bf16_f32 v78, v60, v61
  v_add_f32 v94, v94, v62
  v_add_f32 v95, v95, v63
  v_cvt_pk_bf16_f32 v79, v62, v63
  v_lshl_add_u32 v238, v251, 4, v253
  v_add_u32 v239, 16384, v238
  v_add_u32 v240, 32768, v238
  s_waitcnt vmcnt(22)
  s_barrier
  v_mfma_f32_32x32x16_bf16 v[48:63], a[128:131], v[0:3], 0
  v_exp_f32 v32, v32
  v_add_u32 v241, 49152, v238
  s_lshr_b32 s66, s3, 1
  s_and_b32 s6, s3, 1
  v_lshrrev_b32 v253, 5, v255
  v_mfma_f32_32x32x16_bf16 v[48:63], a[132:135], v[4:7], v[48:63]
  v_exp_f32 v33, v33
  v_cmp_eq_u32 vcc, s6, v253
  v_and_b32 v252, 1, v252
  v_lshlrev_b32 v252, 12, v252
  v_lshl_add_u32 v252, v251, 4, v252
  v_mfma_f32_32x32x16_bf16 v[48:63], a[136:139], v[8:11], v[48:63]
  v_exp_f32 v34, v34
  s_lshl_b32 s6, s5, 8
  v_add_u32 v252, s6, v252
  v_lshlrev_b32 v253, 4, v255
  v_add_u32 v253, 8192, v253
  v_mfma_f32_32x32x16_bf16 v[48:63], a[140:143], v[12:15], v[48:63]
  v_exp_f32 v35, v35
  v_cndmask_b32 v252, v253, v252, vcc
  v_add_u32 v242, 131072, v252
  v_mov_b32 v253, 268435456
  v_mfma_f32_32x32x16_bf16 v[48:63], a[144:147], v[16:19], v[48:63]
  v_exp_f32 v36, v36
  s_cmp_eq_u32 s66, 0
  s_cselect_b64 s[100:101], vcc, 0
  s_nop 0
  v_cndmask_b32 v238, v238, v253, s[100:101]
  v_mfma_f32_32x32x16_bf16 v[48:63], a[148:151], v[20:23], v[48:63]
  v_add_f32 v92, v92, v32
  s_cmp_eq_u32 s66, 1
  s_cselect_b64 s[100:101], vcc, 0
  s_nop 0
  v_cndmask_b32 v239, v239, v253, s[100:101]
  v_mfma_f32_32x32x16_bf16 v[48:63], a[152:155], v[24:27], v[48:63]
  v_exp_f32 v37, v37
  s_cmp_eq_u32 s66, 2
  s_cselect_b64 s[100:101], vcc, 0
  s_nop 0
  v_cndmask_b32 v240, v240, v253, s[100:101]
  v_mfma_f32_32x32x16_bf16 v[48:63], a[156:159], v[28:31], v[48:63]
  v_add_f32 v93, v93, v33
  v_cvt_pk_bf16_f32 v64, v32, v33
  s_cmp_eq_u32 s66, 3
  s_cselect_b64 s[100:101], vcc, 0
  s_nop 0
  v_cndmask_b32 v241, v241, v253, s[100:101]
  v_mfma_f32_32x32x16_bf16 a[64:79], a[160:163], v[72:75], a[64:79]
  v_exp_f32 v38, v38
  v_add_f32 v92, v92, v34
  v_exp_f32 v39, v39
  v_add_f32 v93, v93, v35
  v_mfma_f32_32x32x16_bf16 a[80:95], a[168:171], v[72:75], a[80:95]
  v_cvt_pk_bf16_f32 v65, v34, v35
  v_exp_f32 v40, v40
  v_add_f32 v92, v92, v36
  v_exp_f32 v41, v41
  v_mfma_f32_32x32x16_bf16 a[96:111], a[176:179], v[72:75], a[96:111]
  v_add_f32 v93, v93, v37
  v_cvt_pk_bf16_f32 v66, v36, v37
  ds_read_b64_tr_b16 a[160:161], v88 offset:32768
  ds_read_b64_tr_b16 a[162:163], v88 offset:34816
  v_mfma_f32_32x32x16_bf16 a[112:127], a[184:187], v[72:75], a[112:127]
  v_exp_f32 v42, v42
  ds_read_b64_tr_b16 a[168:169], v89 offset:32768
  ds_read_b64_tr_b16 a[170:171], v89 offset:34816
  v_mfma_f32_32x32x16_bf16 a[64:79], a[164:167], v[76:79], a[64:79]
  v_add_f32 v92, v92, v38
  ds_read_b64_tr_b16 a[176:177], v90 offset:32768
  ds_read_b64_tr_b16 a[178:179], v90 offset:34816
  v_mfma_f32_32x32x16_bf16 a[80:95], a[172:175], v[76:79], a[80:95]
  v_exp_f32 v43, v43
  ds_read_b64_tr_b16 a[184:185], v91 offset:32768
  ds_read_b64_tr_b16 a[186:187], v91 offset:34816
  v_mfma_f32_32x32x16_bf16 a[96:111], a[180:183], v[76:79], a[96:111]
  v_add_f32 v93, v93, v39
  v_cvt_pk_bf16_f32 v67, v38, v39
  ds_read_b64_tr_b16 a[164:165], v88 offset:36864
  ds_read_b64_tr_b16 a[166:167], v88 offset:38912
  v_mfma_f32_32x32x16_bf16 a[112:127], a[188:191], v[76:79], a[112:127]
  v_exp_f32 v44, v44
  v_add_f32 v92, v92, v40
  v_exp_f32 v45, v45
  v_add_f32 v93, v93, v41
  v_cvt_pk_bf16_f32 v68, v40, v41
  v_exp_f32 v46, v46
  v_add_f32 v92, v92, v42
  v_exp_f32 v47, v47
  v_add_f32 v93, v93, v43
  v_cvt_pk_bf16_f32 v69, v42, v43
  v_add_f32 v92, v92, v44
  v_add_f32 v93, v93, v45
  v_cvt_pk_bf16_f32 v70, v44, v45
  v_add_f32 v92, v92, v46
  v_add_f32 v93, v93, v47
  v_cvt_pk_bf16_f32 v71, v46, v47
  ds_read_b64_tr_b16 a[172:173], v89 offset:36864
  ds_read_b64_tr_b16 a[174:175], v89 offset:38912
  s_nop 7
  s_nop 3
  ds_read_b64_tr_b16 a[180:181], v90 offset:36864
  ds_read_b64_tr_b16 a[182:183], v90 offset:38912
  ds_read_b64_tr_b16 a[188:189], v91 offset:36864
  ds_read_b64_tr_b16 a[190:191], v91 offset:38912
  s_waitcnt lgkmcnt(0)
  v_mfma_f32_32x32x16_bf16 a[0:15], a[160:163], v[64:67], a[0:15]
  v_exp_f32 v48, v48
  v_exp_f32 v49, v49
  v_exp_f32 v50, v50
  v_mfma_f32_32x32x16_bf16 a[16:31], a[168:171], v[64:67], a[16:31]
  v_exp_f32 v51, v51
  v_exp_f32 v52, v52
  v_add_f32 v94, v94, v48
  v_exp_f32 v53, v53
  v_add_f32 v95, v95, v49
  v_mfma_f32_32x32x16_bf16 a[32:47], a[176:179], v[64:67], a[32:47]
  v_cvt_pk_bf16_f32 v72, v48, v49
  v_exp_f32 v54, v54
  v_add_f32 v94, v94, v50
  v_exp_f32 v55, v55
  v_add_f32 v95, v95, v51
  v_mfma_f32_32x32x16_bf16 a[48:63], a[184:187], v[64:67], a[48:63]
  v_cvt_pk_bf16_f32 v73, v50, v51
  v_exp_f32 v56, v56
  v_add_f32 v94, v94, v52
  v_exp_f32 v57, v57
  v_add_f32 v95, v95, v53
  v_mfma_f32_32x32x16_bf16 a[0:15], a[164:167], v[68:71], a[0:15]
  v_cvt_pk_bf16_f32 v74, v52, v53
  v_exp_f32 v58, v58
  v_add_f32 v94, v94, v54
  v_exp_f32 v59, v59
  v_add_f32 v95, v95, v55
  v_mfma_f32_32x32x16_bf16 a[16:31], a[172:175], v[68:71], a[16:31]
  v_cvt_pk_bf16_f32 v75, v54, v55
  v_exp_f32 v60, v60
  v_add_f32 v94, v94, v56
  v_exp_f32 v61, v61
  v_add_f32 v95, v95, v57
  v_mfma_f32_32x32x16_bf16 a[32:47], a[180:183], v[68:71], a[32:47]
  v_cvt_pk_bf16_f32 v76, v56, v57
  v_exp_f32 v62, v62
  v_add_f32 v94, v94, v58
  v_exp_f32 v63, v63
  v_add_f32 v95, v95, v59
  v_mfma_f32_32x32x16_bf16 a[48:63], a[188:191], v[68:71], a[48:63]
  v_cvt_pk_bf16_f32 v77, v58, v59
  v_add_f32 v94, v94, v60
  v_add_f32 v95, v95, v61
  v_cvt_pk_bf16_f32 v78, v60, v61
  v_add_f32 v94, v94, v62
  v_add_f32 v95, v95, v63
  v_cvt_pk_bf16_f32 v79, v62, v63
  v_add_f32 v92, v92, v93
  s_nop 0
  v_mov_b32 v93, v92
  s_nop 1
  v_permlane32_swap_b32 v92, v93
  s_nop 0
  v_add_f32 v92, v92, v93
  v_add_f32 v94, v94, v95
  s_nop 0
  v_mov_b32 v95, v94
  s_nop 1
  v_permlane32_swap_b32 v94, v95
  s_nop 0
  v_add_f32 v94, v94, v95
  s_mov_b32 s6, 0x30800000
  s_mov_b32 s7, 0x4e800000
  v_cmp_nle_f32 vcc, s6, v92
  v_cmp_nle_f32 s[100:101], s6, v94
  v_rcp_f32 v98, v92
  s_or_b64 vcc, vcc, s[100:101]
  v_cmp_nge_f32 s[100:101], s7, v92
  v_rcp_f32 v100, v94
  s_or_b64 vcc, vcc, s[100:101]
  v_cmp_nge_f32 s[100:101], s7, v94
  s_nop 0
  s_or_b64 vcc, vcc, s[100:101]
  s_nop 4
  s_cbranch_vccnz L1_fallback
  v_mov_b32 v99, v98
  v_mov_b32 v101, v100
  v_bfe_u32 v250, v255, 4, 1
  v_lshrrev_b32 v251, 5, v255
  v_and_b32 v252, 15, v255
  v_lshlrev_b32 v250, 10, v250
  v_lshl_add_u32 v250, v251, 8, v250
  v_lshl_add_u32 v250, v252, 4, v250
  s_lshr_b32 s6, s5, 1
  s_lshl_b32 s6, s6, 16
  s_and_b32 s7, s5, 1
  s_lshl_b32 s7, s7, 14
  s_add_u32 s6, s6, s7
  v_add_u32 v96, s6, v250
  v_mfma_f32_32x32x16_bf16 a[64:79], a[160:163], v[72:75], a[64:79]
  buffer_load_dwordx4 v[128:131], v236, s[16:19], s60 offen offset:0
  buffer_load_dwordx4 v[132:135], v236, s[16:19], s60 offen offset:1024
  buffer_load_dwordx4 v[136:139], v236, s[16:19], s60 offen offset:2048
  v_mfma_f32_32x32x16_bf16 a[80:95], a[168:171], v[72:75], a[80:95]
  buffer_load_dwordx4 v[140:143], v236, s[16:19], s60 offen offset:3072
  buffer_load_dwordx4 v[144:147], v237, s[16:19], s60 offen offset:0
  buffer_load_dwordx4 v[148:151], v237, s[16:19], s60 offen offset:1024
  v_mfma_f32_32x32x16_bf16 a[96:111], a[176:179], v[72:75], a[96:111]
  buffer_load_dwordx4 v[152:155], v237, s[16:19], s60 offen offset:2048
  buffer_load_dwordx4 v[156:159], v237, s[16:19], s60 offen offset:3072
  s_add_u32 s60, s60, 32768
  v_accvgpr_read_b32 v104, a0
  v_accvgpr_read_b32 v105, a1
  v_accvgpr_read_b32 v106, a2
  v_accvgpr_read_b32 v107, a3
  v_accvgpr_read_b32 v108, a4
  v_accvgpr_read_b32 v109, a5
  v_mfma_f32_32x32x16_bf16 a[112:127], a[184:187], v[72:75], a[112:127]
  v_accvgpr_read_b32 v110, a6
  v_accvgpr_read_b32 v111, a7
  v_pk_mul_f32 v[104:105], v[104:105], v[98:99]
  v_pk_mul_f32 v[106:107], v[106:107], v[98:99]
  v_pk_mul_f32 v[108:109], v[108:109], v[98:99]
  v_pk_mul_f32 v[110:111], v[110:111], v[98:99]
  v_mfma_f32_32x32x16_bf16 a[64:79], a[164:167], v[76:79], a[64:79]
  v_cvt_pk_bf16_f32 v104, v104, v105
  v_cvt_pk_bf16_f32 v105, v106, v107
  v_cvt_pk_bf16_f32 v106, v108, v109
  v_cvt_pk_bf16_f32 v107, v110, v111
  v_accvgpr_read_b32 v112, a8
  v_accvgpr_read_b32 v113, a9
  v_mfma_f32_32x32x16_bf16 a[80:95], a[172:175], v[76:79], a[80:95]
  v_accvgpr_read_b32 v114, a10
  v_accvgpr_read_b32 v115, a11
  ds_write_b128 v96, v[104:107] offset:0
  v_accvgpr_read_b32 v116, a12
  v_accvgpr_read_b32 v117, a13
  v_accvgpr_read_b32 v118, a14
  v_mfma_f32_32x32x16_bf16 a[96:111], a[180:183], v[76:79], a[96:111]
  v_accvgpr_read_b32 v119, a15
  v_pk_mul_f32 v[112:113], v[112:113], v[98:99]
  v_pk_mul_f32 v[114:115], v[114:115], v[98:99]
  v_pk_mul_f32 v[116:117], v[116:117], v[98:99]
  v_pk_mul_f32 v[118:119], v[118:119], v[98:99]
  v_cvt_pk_bf16_f32 v112, v112, v113
  v_mfma_f32_32x32x16_bf16 a[112:127], a[188:191], v[76:79], a[112:127]
  v_cvt_pk_bf16_f32 v113, v114, v115
  v_cvt_pk_bf16_f32 v114, v116, v117
  v_cvt_pk_bf16_f32 v115, v118, v119
  v_accvgpr_read_b32 v104, a16
  v_accvgpr_read_b32 v105, a17
  v_accvgpr_read_b32 v106, a18
  v_accvgpr_read_b32 v107, a19
  ds_write_b128 v96, v[112:115] offset:512
  v_accvgpr_read_b32 v108, a20
  v_accvgpr_read_b32 v109, a21
  v_accvgpr_read_b32 v110, a22
  v_accvgpr_read_b32 v111, a23
  v_pk_mul_f32 v[104:105], v[104:105], v[98:99]
  v_pk_mul_f32 v[106:107], v[106:107], v[98:99]
  v_pk_mul_f32 v[108:109], v[108:109], v[98:99]
  v_pk_mul_f32 v[110:111], v[110:111], v[98:99]
  v_cvt_pk_bf16_f32 v104, v104, v105
  v_cvt_pk_bf16_f32 v105, v106, v107
  v_cvt_pk_bf16_f32 v106, v108, v109
  v_cvt_pk_bf16_f32 v107, v110, v111
  v_accvgpr_read_b32 v112, a24
  v_accvgpr_read_b32 v113, a25
  v_accvgpr_read_b32 v114, a26
  v_accvgpr_read_b32 v115, a27
  ds_write_b128 v96, v[104:107] offset:4096
  v_accvgpr_read_b32 v116, a28
  v_accvgpr_read_b32 v117, a29
  v_accvgpr_read_b32 v118, a30
  v_accvgpr_read_b32 v119, a31
  v_pk_mul_f32 v[112:113], v[112:113], v[98:99]
  v_pk_mul_f32 v[114:115], v[114:115], v[98:99]
  v_pk_mul_f32 v[116:117], v[116:117], v[98:99]
  v_pk_mul_f32 v[118:119], v[118:119], v[98:99]
  v_cvt_pk_bf16_f32 v112, v112, v113
  v_cvt_pk_bf16_f32 v113, v114, v115
  v_cvt_pk_bf16_f32 v114, v116, v117
  v_cvt_pk_bf16_f32 v115, v118, v119
  v_accvgpr_read_b32 v104, a32
  v_accvgpr_read_b32 v105, a33
  v_accvgpr_read_b32 v106, a34
  v_accvgpr_read_b32 v107, a35
  ds_write_b128 v96, v[112:115] offset:4608
  v_accvgpr_read_b32 v108, a36
  v_accvgpr_read_b32 v109, a37
  v_accvgpr_read_b32 v110, a38
  v_accvgpr_read_b32 v111, a39
  v_pk_mul_f32 v[104:105], v[104:105], v[98:99]
  v_pk_mul_f32 v[106:107], v[106:107], v[98:99]
  v_pk_mul_f32 v[108:109], v[108:109], v[98:99]
  v_pk_mul_f32 v[110:111], v[110:111], v[98:99]
  v_cvt_pk_bf16_f32 v104, v104, v105
  v_cvt_pk_bf16_f32 v105, v106, v107
  v_cvt_pk_bf16_f32 v106, v108, v109
  v_cvt_pk_bf16_f32 v107, v110, v111
  v_accvgpr_read_b32 v112, a40
  v_accvgpr_read_b32 v113, a41
  v_accvgpr_read_b32 v114, a42
  v_accvgpr_read_b32 v115, a43
  ds_write_b128 v96, v[104:107] offset:8192
  v_accvgpr_read_b32 v116, a44
  v_accvgpr_read_b32 v117, a45
  v_accvgpr_read_b32 v118, a46
  v_accvgpr_read_b32 v119, a47
  v_pk_mul_f32 v[112:113], v[112:113], v[98:99]
  v_pk_mul_f32 v[114:115], v[114:115], v[98:99]
  v_pk_mul_f32 v[116:117], v[116:117], v[98:99]
  v_pk_mul_f32 v[118:119], v[118:119], v[98:99]
  v_cvt_pk_bf16_f32 v112, v112, v113
  v_cvt_pk_bf16_f32 v113, v114, v115
  v_cvt_pk_bf16_f32 v114, v116, v117
  v_cvt_pk_bf16_f32 v115, v118, v119
  v_accvgpr_read_b32 v104, a48
  v_accvgpr_read_b32 v105, a49
  v_accvgpr_read_b32 v106, a50
  v_accvgpr_read_b32 v107, a51
  ds_write_b128 v96, v[112:115] offset:8704
  v_accvgpr_read_b32 v108, a52
  v_accvgpr_read_b32 v109, a53
  v_accvgpr_read_b32 v110, a54
  v_accvgpr_read_b32 v111, a55
  v_pk_mul_f32 v[104:105], v[104:105], v[98:99]
  v_pk_mul_f32 v[106:107], v[106:107], v[98:99]
  v_pk_mul_f32 v[108:109], v[108:109], v[98:99]
  v_pk_mul_f32 v[110:111], v[110:111], v[98:99]
  v_cvt_pk_bf16_f32 v104, v104, v105
  v_cvt_pk_bf16_f32 v105, v106, v107
  v_cvt_pk_bf16_f32 v106, v108, v109
  v_cvt_pk_bf16_f32 v107, v110, v111
  v_accvgpr_read_b32 v112, a56
  v_accvgpr_read_b32 v113, a57
  v_accvgpr_read_b32 v114, a58
  v_accvgpr_read_b32 v115, a59
  ds_write_b128 v96, v[104:107] offset:12288
  v_accvgpr_read_b32 v116, a60
  v_accvgpr_read_b32 v117, a61
  v_accvgpr_read_b32 v118, a62
  v_accvgpr_read_b32 v119, a63
  v_pk_mul_f32 v[112:113], v[112:113], v[98:99]
  v_pk_mul_f32 v[114:115], v[114:115], v[98:99]
  v_pk_mul_f32 v[116:117], v[116:117], v[98:99]
  v_pk_mul_f32 v[118:119], v[118:119], v[98:99]
  v_cvt_pk_bf16_f32 v112, v112, v113
  v_cvt_pk_bf16_f32 v113, v114, v115
  v_cvt_pk_bf16_f32 v114, v116, v117
  v_cvt_pk_bf16_f32 v115, v118, v119
  ds_write_b128 v96, v[112:115] offset:12800
  s_nop 3
  v_accvgpr_read_b32 v104, a64
  v_accvgpr_read_b32 v105, a65
  v_accvgpr_read_b32 v106, a66
  v_accvgpr_read_b32 v107, a67
  v_accvgpr_read_b32 v108, a68
  v_accvgpr_read_b32 v109, a69
  v_accvgpr_read_b32 v110, a70
  v_accvgpr_read_b32 v111, a71
  v_pk_mul_f32 v[104:105], v[104:105], v[100:101]
  v_pk_mul_f32 v[106:107], v[106:107], v[100:101]
  v_pk_mul_f32 v[108:109], v[108:109], v[100:101]
  v_pk_mul_f32 v[110:111], v[110:111], v[100:101]
  v_cvt_pk_bf16_f32 v104, v104, v105
  v_cvt_pk_bf16_f32 v105, v106, v107
  v_cvt_pk_bf16_f32 v106, v108, v109
  v_cvt_pk_bf16_f32 v107, v110, v111
  v_accvgpr_read_b32 v112, a72
  v_accvgpr_read_b32 v113, a73
  v_accvgpr_read_b32 v114, a74
  v_accvgpr_read_b32 v115, a75
  ds_write_b128 v96, v[104:107] offset:2048
  v_accvgpr_read_b32 v116, a76
  v_accvgpr_read_b32 v117, a77
  v_accvgpr_read_b32 v118, a78
  v_accvgpr_read_b32 v119, a79
  v_pk_mul_f32 v[112:113], v[112:113], v[100:101]
  v_pk_mul_f32 v[114:115], v[114:115], v[100:101]
  v_pk_mul_f32 v[116:117], v[116:117], v[100:101]
  v_pk_mul_f32 v[118:119], v[118:119], v[100:101]
  v_cvt_pk_bf16_f32 v112, v112, v113
  v_cvt_pk_bf16_f32 v113, v114, v115
  v_cvt_pk_bf16_f32 v114, v116, v117
  v_cvt_pk_bf16_f32 v115, v118, v119
  v_accvgpr_read_b32 v104, a80
  v_accvgpr_read_b32 v105, a81
  v_accvgpr_read_b32 v106, a82
  v_accvgpr_read_b32 v107, a83
  ds_write_b128 v96, v[112:115] offset:2560
  v_accvgpr_read_b32 v108, a84
  v_accvgpr_read_b32 v109, a85
  v_accvgpr_read_b32 v110, a86
  v_accvgpr_read_b32 v111, a87
  v_pk_mul_f32 v[104:105], v[104:105], v[100:101]
  v_pk_mul_f32 v[106:107], v[106:107], v[100:101]
  v_pk_mul_f32 v[108:109], v[108:109], v[100:101]
  v_pk_mul_f32 v[110:111], v[110:111], v[100:101]
  v_cvt_pk_bf16_f32 v104, v104, v105
  v_cvt_pk_bf16_f32 v105, v106, v107
  v_cvt_pk_bf16_f32 v106, v108, v109
  v_cvt_pk_bf16_f32 v107, v110, v111
  v_accvgpr_read_b32 v112, a88
  v_accvgpr_read_b32 v113, a89
  v_accvgpr_read_b32 v114, a90
  v_accvgpr_read_b32 v115, a91
  ds_write_b128 v96, v[104:107] offset:6144
  v_accvgpr_read_b32 v116, a92
  v_accvgpr_read_b32 v117, a93
  v_accvgpr_read_b32 v118, a94
  v_accvgpr_read_b32 v119, a95
  v_pk_mul_f32 v[112:113], v[112:113], v[100:101]
  v_pk_mul_f32 v[114:115], v[114:115], v[100:101]
  v_pk_mul_f32 v[116:117], v[116:117], v[100:101]
  v_pk_mul_f32 v[118:119], v[118:119], v[100:101]
  v_cvt_pk_bf16_f32 v112, v112, v113
  v_cvt_pk_bf16_f32 v113, v114, v115
  v_cvt_pk_bf16_f32 v114, v116, v117
  v_cvt_pk_bf16_f32 v115, v118, v119
  v_accvgpr_read_b32 v104, a96
  v_accvgpr_read_b32 v105, a97
  v_accvgpr_read_b32 v106, a98
  v_accvgpr_read_b32 v107, a99
  ds_write_b128 v96, v[112:115] offset:6656
  v_accvgpr_read_b32 v108, a100
  v_accvgpr_read_b32 v109, a101
  v_accvgpr_read_b32 v110, a102
  v_accvgpr_read_b32 v111, a103
  v_pk_mul_f32 v[104:105], v[104:105], v[100:101]
  v_pk_mul_f32 v[106:107], v[106:107], v[100:101]
  v_pk_mul_f32 v[108:109], v[108:109], v[100:101]
  v_pk_mul_f32 v[110:111], v[110:111], v[100:101]
  v_cvt_pk_bf16_f32 v104, v104, v105
  v_cvt_pk_bf16_f32 v105, v106, v107
  v_cvt_pk_bf16_f32 v106, v108, v109
  v_cvt_pk_bf16_f32 v107, v110, v111
  v_accvgpr_read_b32 v112, a104
  v_accvgpr_read_b32 v113, a105
  v_accvgpr_read_b32 v114, a106
  v_accvgpr_read_b32 v115, a107
  ds_write_b128 v96, v[104:107] offset:10240
  v_accvgpr_read_b32 v116, a108
  v_accvgpr_read_b32 v117, a109
  v_accvgpr_read_b32 v118, a110
  v_accvgpr_read_b32 v119, a111
  v_pk_mul_f32 v[112:113], v[112:113], v[100:101]
  v_pk_mul_f32 v[114:115], v[114:115], v[100:101]
  v_pk_mul_f32 v[116:117], v[116:117], v[100:101]
  v_pk_mul_f32 v[118:119], v[118:119], v[100:101]
  v_cvt_pk_bf16_f32 v112, v112, v113
  v_cvt_pk_bf16_f32 v113, v114, v115
  v_cvt_pk_bf16_f32 v114, v116, v117
  v_cvt_pk_bf16_f32 v115, v118, v119
  v_accvgpr_read_b32 v104, a112
  v_accvgpr_read_b32 v105, a113
  v_accvgpr_read_b32 v106, a114
  v_accvgpr_read_b32 v107, a115
  ds_write_b128 v96, v[112:115] offset:10752
  v_accvgpr_read_b32 v108, a116
  v_accvgpr_read_b32 v109, a117
  v_accvgpr_read_b32 v110, a118
  v_accvgpr_read_b32 v111, a119
  v_pk_mul_f32 v[104:105], v[104:105], v[100:101]
  v_pk_mul_f32 v[106:107], v[106:107], v[100:101]
  v_pk_mul_f32 v[108:109], v[108:109], v[100:101]
  v_pk_mul_f32 v[110:111], v[110:111], v[100:101]
  v_cvt_pk_bf16_f32 v104, v104, v105
  v_cvt_pk_bf16_f32 v105, v106, v107
  v_cvt_pk_bf16_f32 v106, v108, v109
  v_cvt_pk_bf16_f32 v107, v110, v111
  v_accvgpr_read_b32 v112, a120
  v_accvgpr_read_b32 v113, a121
  v_accvgpr_read_b32 v114, a122
  v_accvgpr_read_b32 v115, a123
  ds_write_b128 v96, v[104:107] offset:14336
  v_accvgpr_read_b32 v116, a124
  v_accvgpr_read_b32 v117, a125
  v_accvgpr_read_b32 v118, a126
  v_accvgpr_read_b32 v119, a127
  v_pk_mul_f32 v[112:113], v[112:113], v[100:101]
  v_pk_mul_f32 v[114:115], v[114:115], v[100:101]
  v_pk_mul_f32 v[116:117], v[116:117], v[100:101]
  v_pk_mul_f32 v[118:119], v[118:119], v[100:101]
  v_cvt_pk_bf16_f32 v112, v112, v113
  v_cvt_pk_bf16_f32 v113, v114, v115
  v_cvt_pk_bf16_f32 v114, v116, v117
  v_cvt_pk_bf16_f32 v115, v118, v119
  ds_write_b128 v96, v[112:115] offset:14848
L1_join:
  v_lshlrev_b32 v244, 4, v255
  v_add_u32 v245, 0x10000, v244
  s_waitcnt vmcnt(13)
  s_waitcnt lgkmcnt(0)
  s_barrier
  s_lshl_b32 s6, s4, 8
  s_add_u32 s6, s6, 16810116
  s_cmp_eq_u32 s5, 0
  s_cselect_b32 s6, s6, 268435456
  v_cmp_eq_u32 vcc, 0, v255
  v_mov_b32 v251, 1
  v_mov_b32 v250, 268435456
  v_cndmask_b32 v250, v250, 0, vcc
  buffer_atomic_add v251, v250, s[28:31], s6 offen sc1
  ds_read_b128 a[192:195], v244 offset:0
  ds_read_b128 a[196:199], v244 offset:1024
  ds_read_b128 a[200:203], v244 offset:2048
  ds_read_b128 a[204:207], v244 offset:3072
  s_waitcnt vmcnt(19)
  v_perm_b32 v224, v164, v160, s58
  v_perm_b32 v225, v172, v168, s58
  v_perm_b32 v226, v180, v176, s58
  v_perm_b32 v227, v188, v184, s58
  s_waitcnt lgkmcnt(0)
  s_nop 0
  v_mfma_f32_16x16x32_bf16 v[0:3], a[192:195], v[224:227], 0
  v_perm_b32 v228, v164, v160, s59
  v_perm_b32 v229, v172, v168, s59
  v_mfma_f32_16x16x32_bf16 v[32:35], a[196:199], v[224:227], 0
  v_perm_b32 v230, v180, v176, s59
  ds_read_b128 a[208:211], v244 offset:4096
  v_mfma_f32_16x16x32_bf16 v[64:67], a[200:203], v[224:227], 0
  v_perm_b32 v231, v188, v184, s59
  v_mfma_f32_16x16x32_bf16 v[96:99], a[204:207], v[224:227], 0
  s_nop 0
  v_mfma_f32_16x16x32_bf16 v[4:7], a[192:195], v[228:231], 0
  v_perm_b32 v224, v165, v161, s58
  v_perm_b32 v225, v173, v169, s58
  v_mfma_f32_16x16x32_bf16 v[36:39], a[196:199], v[228:231], 0
  v_perm_b32 v226, v181, v177, s58
  ds_read_b128 a[212:215], v244 offset:5120
  v_mfma_f32_16x16x32_bf16 v[68:71], a[200:203], v[228:231], 0
  v_perm_b32 v227, v189, v185, s58
  v_mfma_f32_16x16x32_bf16 v[100:103], a[204:207], v[228:231], 0
  s_nop 0
  v_mfma_f32_16x16x32_bf16 v[8:11], a[192:195], v[224:227], 0
  v_perm_b32 v228, v165, v161, s59
  v_perm_b32 v229, v173, v169, s59
  v_mfma_f32_16x16x32_bf16 v[40:43], a[196:199], v[224:227], 0
  v_perm_b32 v230, v181, v177, s59
  ds_read_b128 a[216:219], v244 offset:6144
  v_mfma_f32_16x16x32_bf16 v[72:75], a[200:203], v[224:227], 0
  v_perm_b32 v231, v189, v185, s59
  v_mfma_f32_16x16x32_bf16 v[104:107], a[204:207], v[224:227], 0
  s_nop 0
  v_mfma_f32_16x16x32_bf16 v[12:15], a[192:195], v[228:231], 0
  v_perm_b32 v224, v166, v162, s58
  v_perm_b32 v225, v174, v170, s58
  v_mfma_f32_16x16x32_bf16 v[44:47], a[196:199], v[228:231], 0
  v_perm_b32 v226, v182, v178, s58
  ds_read_b128 a[220:223], v244 offset:7168
  v_mfma_f32_16x16x32_bf16 v[76:79], a[200:203], v[228:231], 0
  v_perm_b32 v227, v190, v186, s58
  v_mfma_f32_16x16x32_bf16 v[108:111], a[204:207], v[228:231], 0
  s_nop 0
  v_mfma_f32_16x16x32_bf16 v[16:19], a[192:195], v[224:227], 0
  v_perm_b32 v228, v166, v162, s59
  v_perm_b32 v229, v174, v170, s59
  v_mfma_f32_16x16x32_bf16 v[48:51], a[196:199], v[224:227], 0
  v_perm_b32 v230, v182, v178, s59
  v_mfma_f32_16x16x32_bf16 v[80:83], a[200:203], v[224:227], 0
  v_perm_b32 v231, v190, v186, s59
  v_mfma_f32_16x16x32_bf16 v[112:115], a[204:207], v[224:227], 0
  s_nop 0
  v_mfma_f32_16x16x32_bf16 v[20:23], a[192:195], v[228:231], 0
  v_perm_b32 v224, v167, v163, s58
  v_perm_b32 v225, v175, v171, s58
  v_mfma_f32_16x16x32_bf16 v[52:55], a[196:199], v[228:231], 0
  v_perm_b32 v226, v183, v179, s58
  v_mfma_f32_16x16x32_bf16 v[84:87], a[200:203], v[228:231], 0
  v_perm_b32 v227, v191, v187, s58
  v_mfma_f32_16x16x32_bf16 v[116:119], a[204:207], v[228:231], 0
  s_nop 0
  v_mfma_f32_16x16x32_bf16 v[24:27], a[192:195], v[224:227], 0
  v_perm_b32 v228, v167, v163, s59
  v_perm_b32 v229, v175, v171, s59
  v_mfma_f32_16x16x32_bf16 v[56:59], a[196:199], v[224:227], 0
  v_perm_b32 v230, v183, v179, s59
  v_mfma_f32_16x16x32_bf16 v[88:91], a[200:203], v[224:227], 0
  v_perm_b32 v231, v191, v187, s59
  v_mfma_f32_16x16x32_bf16 v[120:123], a[204:207], v[224:227], 0
  s_nop 0
  v_mfma_f32_16x16x32_bf16 v[28:31], a[192:195], v[228:231], 0
  s_waitcnt vmcnt(13)
  v_perm_b32 v224, v196, v192, s58
  v_perm_b32 v225, v204, v200, s58
  v_mfma_f32_16x16x32_bf16 v[60:63], a[196:199], v[228:231], 0
  s_waitcnt vmcnt(9)
  v_perm_b32 v226, v212, v208, s58
  v_mfma_f32_16x16x32_bf16 v[92:95], a[200:203], v[228:231], 0
  v_perm_b32 v227, v220, v216, s58
  v_mfma_f32_16x16x32_bf16 v[124:127], a[204:207], v[228:231], 0
  buffer_load_dwordx4 v[160:163], v236, s[16:19], s60 offen offset:0
  s_waitcnt lgkmcnt(0)
  v_mfma_f32_16x16x32_bf16 v[0:3], a[208:211], v[224:227], v[0:3]
  v_perm_b32 v228, v196, v192, s59
  v_perm_b32 v229, v204, v200, s59
  v_mfma_f32_16x16x32_bf16 v[32:35], a[212:215], v[224:227], v[32:35]
  v_perm_b32 v230, v212, v208, s59
  ds_read_b128 a[192:195], v244 offset:8192
  v_mfma_f32_16x16x32_bf16 v[64:67], a[216:219], v[224:227], v[64:67]
  v_perm_b32 v231, v220, v216, s59
  v_mfma_f32_16x16x32_bf16 v[96:99], a[220:223], v[224:227], v[96:99]
  buffer_load_dwordx4 v[164:167], v236, s[16:19], s60 offen offset:1024
  v_mfma_f32_16x16x32_bf16 v[4:7], a[208:211], v[228:231], v[4:7]
  v_perm_b32 v224, v197, v193, s58
  v_perm_b32 v225, v205, v201, s58
  v_mfma_f32_16x16x32_bf16 v[36:39], a[212:215], v[228:231], v[36:39]
  v_perm_b32 v226, v213, v209, s58
  ds_read_b128 a[196:199], v244 offset:9216
  v_mfma_f32_16x16x32_bf16 v[68:71], a[216:219], v[228:231], v[68:71]
  v_perm_b32 v227, v221, v217, s58
  v_mfma_f32_16x16x32_bf16 v[100:103], a[220:223], v[228:231], v[100:103]
  buffer_load_dwordx4 v[168:171], v236, s[16:19], s60 offen offset:2048
  v_mfma_f32_16x16x32_bf16 v[8:11], a[208:211], v[224:227], v[8:11]
  v_perm_b32 v228, v197, v193, s59
  v_perm_b32 v229, v205, v201, s59
  v_mfma_f32_16x16x32_bf16 v[40:43], a[212:215], v[224:227], v[40:43]
  v_perm_b32 v230, v213, v209, s59
  ds_read_b128 a[200:203], v244 offset:10240
  v_mfma_f32_16x16x32_bf16 v[72:75], a[216:219], v[224:227], v[72:75]
  v_perm_b32 v231, v221, v217, s59
  v_mfma_f32_16x16x32_bf16 v[104:107], a[220:223], v[224:227], v[104:107]
  buffer_load_dwordx4 v[172:175], v236, s[16:19], s60 offen offset:3072
  v_mfma_f32_16x16x32_bf16 v[12:15], a[208:211], v[228:231], v[12:15]
  v_perm_b32 v224, v198, v194, s58
  v_perm_b32 v225, v206, v202, s58
  v_mfma_f32_16x16x32_bf16 v[44:47], a[212:215], v[228:231], v[44:47]
  v_perm_b32 v226, v214, v210, s58
  ds_read_b128 a[204:207], v244 offset:11264
  v_mfma_f32_16x16x32_bf16 v[76:79], a[216:219], v[228:231], v[76:79]
  v_perm_b32 v227, v222, v218, s58
  v_mfma_f32_16x16x32_bf16 v[108:111], a[220:223], v[228:231], v[108:111]
  buffer_load_dwordx4 v[176:179], v237, s[16:19], s60 offen offset:0
  v_mfma_f32_16x16x32_bf16 v[16:19], a[208:211], v[224:227], v[16:19]
  v_perm_b32 v228, v198, v194, s59
  v_perm_b32 v229, v206, v202, s59
  v_mfma_f32_16x16x32_bf16 v[48:51], a[212:215], v[224:227], v[48:51]
  v_perm_b32 v230, v214, v210, s59
  v_mfma_f32_16x16x32_bf16 v[80:83], a[216:219], v[224:227], v[80:83]
  v_perm_b32 v231, v222, v218, s59
  v_mfma_f32_16x16x32_bf16 v[112:115], a[220:223], v[224:227], v[112:115]
  buffer_load_dwordx4 v[180:183], v237, s[16:19], s60 offen offset:1024
  v_mfma_f32_16x16x32_bf16 v[20:23], a[208:211], v[228:231], v[20:23]
  v_perm_b32 v224, v199, v195, s58
  v_perm_b32 v225, v207, v203, s58
  v_mfma_f32_16x16x32_bf16 v[52:55], a[212:215], v[228:231], v[52:55]
  v_perm_b32 v226, v215, v211, s58
  v_mfma_f32_16x16x32_bf16 v[84:87], a[216:219], v[228:231], v[84:87]
  v_perm_b32 v227, v223, v219, s58
  v_mfma_f32_16x16x32_bf16 v[116:119], a[220:223], v[228:231], v[116:119]
  buffer_load_dwordx4 v[184:187], v237, s[16:19], s60 offen offset:2048
  v_mfma_f32_16x16x32_bf16 v[24:27], a[208:211], v[224:227], v[24:27]
  v_perm_b32 v228, v199, v195, s59
  v_perm_b32 v229, v207, v203, s59
  v_mfma_f32_16x16x32_bf16 v[56:59], a[212:215], v[224:227], v[56:59]
  v_perm_b32 v230, v215, v211, s59
  v_mfma_f32_16x16x32_bf16 v[88:91], a[216:219], v[224:227], v[88:91]
  v_perm_b32 v231, v223, v219, s59
  v_mfma_f32_16x16x32_bf16 v[120:123], a[220:223], v[224:227], v[120:123]
  buffer_load_dwordx4 v[188:191], v237, s[16:19], s60 offen offset:3072
  s_add_u32 s60, s60, 32768
  v_mfma_f32_16x16x32_bf16 v[28:31], a[208:211], v[228:231], v[28:31]
  s_waitcnt vmcnt(13)
  v_perm_b32 v224, v132, v128, s58
  v_perm_b32 v225, v140, v136, s58
  v_mfma_f32_16x16x32_bf16 v[60:63], a[212:215], v[228:231], v[60:63]
  s_waitcnt vmcnt(9)
  v_perm_b32 v226, v148, v144, s58
  v_mfma_f32_16x16x32_bf16 v[92:95], a[216:219], v[228:231], v[92:95]
  v_perm_b32 v227, v156, v152, s58
  v_mfma_f32_16x16x32_bf16 v[124:127], a[220:223], v[228:231], v[124:127]
  buffer_load_dwordx4 v[192:195], v236, s[16:19], s60 offen offset:0
  s_waitcnt lgkmcnt(0)
  v_mfma_f32_16x16x32_bf16 v[0:3], a[192:195], v[224:227], v[0:3]
  v_perm_b32 v228, v132, v128, s59
  v_perm_b32 v229, v140, v136, s59
  v_mfma_f32_16x16x32_bf16 v[32:35], a[196:199], v[224:227], v[32:35]
  v_perm_b32 v230, v148, v144, s59
  ds_read_b128 a[208:211], v244 offset:12288
  v_mfma_f32_16x16x32_bf16 v[64:67], a[200:203], v[224:227], v[64:67]
  v_perm_b32 v231, v156, v152, s59
  v_mfma_f32_16x16x32_bf16 v[96:99], a[204:207], v[224:227], v[96:99]
  buffer_load_dwordx4 v[196:199], v236, s[16:19], s60 offen offset:1024
  v_mfma_f32_16x16x32_bf16 v[4:7], a[192:195], v[228:231], v[4:7]
  v_perm_b32 v224, v133, v129, s58
  v_perm_b32 v225, v141, v137, s58
  v_mfma_f32_16x16x32_bf16 v[36:39], a[196:199], v[228:231], v[36:39]
  v_perm_b32 v226, v149, v145, s58
  ds_read_b128 a[212:215], v244 offset:13312
  v_mfma_f32_16x16x32_bf16 v[68:71], a[200:203], v[228:231], v[68:71]
  v_perm_b32 v227, v157, v153, s58
  v_mfma_f32_16x16x32_bf16 v[100:103], a[204:207], v[228:231], v[100:103]
  buffer_load_dwordx4 v[200:203], v236, s[16:19], s60 offen offset:2048
  v_mfma_f32_16x16x32_bf16 v[8:11], a[192:195], v[224:227], v[8:11]
  v_perm_b32 v228, v133, v129, s59
  v_perm_b32 v229, v141, v137, s59
  v_mfma_f32_16x16x32_bf16 v[40:43], a[196:199], v[224:227], v[40:43]
  v_perm_b32 v230, v149, v145, s59
  ds_read_b128 a[216:219], v244 offset:14336
  v_mfma_f32_16x16x32_bf16 v[72:75], a[200:203], v[224:227], v[72:75]
  v_perm_b32 v231, v157, v153, s59
  v_mfma_f32_16x16x32_bf16 v[104:107], a[204:207], v[224:227], v[104:107]
  buffer_load_dwordx4 v[204:207], v236, s[16:19], s60 offen offset:3072
  v_mfma_f32_16x16x32_bf16 v[12:15], a[192:195], v[228:231], v[12:15]
  v_perm_b32 v224, v134, v130, s58
  v_perm_b32 v225, v142, v138, s58
  v_mfma_f32_16x16x32_bf16 v[44:47], a[196:199], v[228:231], v[44:47]
  v_perm_b32 v226, v150, v146, s58
  ds_read_b128 a[220:223], v244 offset:15360
  v_mfma_f32_16x16x32_bf16 v[76:79], a[200:203], v[228:231], v[76:79]
  v_perm_b32 v227, v158, v154, s58
  v_mfma_f32_16x16x32_bf16 v[108:111], a[204:207], v[228:231], v[108:111]
  buffer_load_dwordx4 v[208:211], v237, s[16:19], s60 offen offset:0
  v_mfma_f32_16x16x32_bf16 v[16:19], a[192:195], v[224:227], v[16:19]
  v_perm_b32 v228, v134, v130, s59
  v_perm_b32 v229, v142, v138, s59
  v_mfma_f32_16x16x32_bf16 v[48:51], a[196:199], v[224:227], v[48:51]
  v_perm_b32 v230, v150, v146, s59
  v_mfma_f32_16x16x32_bf16 v[80:83], a[200:203], v[224:227], v[80:83]
  v_perm_b32 v231, v158, v154, s59
  v_mfma_f32_16x16x32_bf16 v[112:115], a[204:207], v[224:227], v[112:115]
  buffer_load_dwordx4 v[212:215], v237, s[16:19], s60 offen offset:1024
  v_mfma_f32_16x16x32_bf16 v[20:23], a[192:195], v[228:231], v[20:23]
  v_perm_b32 v224, v135, v131, s58
  v_perm_b32 v225, v143, v139, s58
  v_mfma_f32_16x16x32_bf16 v[52:55], a[196:199], v[228:231], v[52:55]
  v_perm_b32 v226, v151, v147, s58
  v_mfma_f32_16x16x32_bf16 v[84:87], a[200:203], v[228:231], v[84:87]
  v_perm_b32 v227, v159, v155, s58
  v_mfma_f32_16x16x32_bf16 v[116:119], a[204:207], v[228:231], v[116:119]
  buffer_load_dwordx4 v[216:219], v237, s[16:19], s60 offen offset:2048
  v_mfma_f32_16x16x32_bf16 v[24:27], a[192:195], v[224:227], v[24:27]
  v_perm_b32 v228, v135, v131, s59
  v_perm_b32 v229, v143, v139, s59
  v_mfma_f32_16x16x32_bf16 v[56:59], a[196:199], v[224:227], v[56:59]
  v_perm_b32 v230, v151, v147, s59
  v_mfma_f32_16x16x32_bf16 v[88:91], a[200:203], v[224:227], v[88:91]
  v_perm_b32 v231, v159, v155, s59
  v_mfma_f32_16x16x32_bf16 v[120:123], a[204:207], v[224:227], v[120:123]
  buffer_load_dwordx4 v[220:223], v237, s[16:19], s60 offen offset:3072
  s_add_u32 s60, s60, 32768
  v_mfma_f32_16x16x32_bf16 v[28:31], a[192:195], v[228:231], v[28:31]
  s_waitcnt vmcnt(12)
  v_perm_b32 v224, v164, v160, s58
  v_perm_b32 v225, v172, v168, s58
  v_mfma_f32_16x16x32_bf16 v[60:63], a[196:199], v[228:231], v[60:63]
  s_waitcnt vmcnt(8)
  v_perm_b32 v226, v180, v176, s58
  v_mfma_f32_16x16x32_bf16 v[92:95], a[200:203], v[228:231], v[92:95]
  v_perm_b32 v227, v188, v184, s58
  v_mfma_f32_16x16x32_bf16 v[124:127], a[204:207], v[228:231], v[124:127]
  buffer_load_dwordx4 v[128:131], v236, s[16:19], s60 offen offset:0
  s_waitcnt lgkmcnt(0)
  v_mfma_f32_16x16x32_bf16 v[0:3], a[208:211], v[224:227], v[0:3]
  v_perm_b32 v228, v164, v160, s59
  v_perm_b32 v229, v172, v168, s59
  v_mfma_f32_16x16x32_bf16 v[32:35], a[212:215], v[224:227], v[32:35]
  v_perm_b32 v230, v180, v176, s59
  ds_read_b128 a[192:195], v244 offset:16384
  v_mfma_f32_16x16x32_bf16 v[64:67], a[216:219], v[224:227], v[64:67]
  v_perm_b32 v231, v188, v184, s59
  v_mfma_f32_16x16x32_bf16 v[96:99], a[220:223], v[224:227], v[96:99]
  buffer_load_dwordx4 v[132:135], v236, s[16:19], s60 offen offset:1024
  v_mfma_f32_16x16x32_bf16 v[4:7], a[208:211], v[228:231], v[4:7]
  v_perm_b32 v224, v165, v161, s58
  v_perm_b32 v225, v173, v169, s58
  v_mfma_f32_16x16x32_bf16 v[36:39], a[212:215], v[228:231], v[36:39]
  v_perm_b32 v226, v181, v177, s58
  ds_read_b128 a[196:199], v244 offset:17408
  v_mfma_f32_16x16x32_bf16 v[68:71], a[216:219], v[228:231], v[68:71]
  v_perm_b32 v227, v189, v185, s58
  v_mfma_f32_16x16x32_bf16 v[100:103], a[220:223], v[228:231], v[100:103]
  buffer_load_dwordx4 v[136:139], v236, s[16:19], s60 offen offset:2048
  v_mfma_f32_16x16x32_bf16 v[8:11], a[208:211], v[224:227], v[8:11]
  v_perm_b32 v228, v165, v161, s59
  v_perm_b32 v229, v173, v169, s59
  v_mfma_f32_16x16x32_bf16 v[40:43], a[212:215], v[224:227], v[40:43]
  v_perm_b32 v230, v181, v177, s59
  ds_read_b128 a[200:203], v244 offset:18432
  v_mfma_f32_16x16x32_bf16 v[72:75], a[216:219], v[224:227], v[72:75]
  v_perm_b32 v231, v189, v185, s59
  v_mfma_f32_16x16x32_bf16 v[104:107], a[220:223], v[224:227], v[104:107]
  buffer_load_dwordx4 v[140:143], v236, s[16:19], s60 offen offset:3072
  v_mfma_f32_16x16x32_bf16 v[12:15], a[208:211], v[228:231], v[12:15]
  v_perm_b32 v224, v166, v162, s58
  v_perm_b32 v225, v174, v170, s58
  v_mfma_f32_16x16x32_bf16 v[44:47], a[212:215], v[228:231], v[44:47]
  v_perm_b32 v226, v182, v178, s58
  ds_read_b128 a[204:207], v244 offset:19456
  v_mfma_f32_16x16x32_bf16 v[76:79], a[216:219], v[228:231], v[76:79]
  v_perm_b32 v227, v190, v186, s58
  v_mfma_f32_16x16x32_bf16 v[108:111], a[220:223], v[228:231], v[108:111]
  buffer_load_dwordx4 v[144:147], v237, s[16:19], s60 offen offset:0
  v_mfma_f32_16x16x32_bf16 v[16:19], a[208:211], v[224:227], v[16:19]
  v_perm_b32 v228, v166, v162, s59
  v_perm_b32 v229, v174, v170, s59
  v_mfma_f32_16x16x32_bf16 v[48:51], a[212:215], v[224:227], v[48:51]
  v_perm_b32 v230, v182, v178, s59
  v_mfma_f32_16x16x32_bf16 v[80:83], a[216:219], v[224:227], v[80:83]
  v_perm_b32 v231, v190, v186, s59
  v_mfma_f32_16x16x32_bf16 v[112:115], a[220:223], v[224:227], v[112:115]
  buffer_load_dwordx4 v[148:151], v237, s[16:19], s60 offen offset:1024
  v_mfma_f32_16x16x32_bf16 v[20:23], a[208:211], v[228:231], v[20:23]
  v_perm_b32 v224, v167, v163, s58
  v_perm_b32 v225, v175, v171, s58
  v_mfma_f32_16x16x32_bf16 v[52:55], a[212:215], v[228:231], v[52:55]
  v_perm_b32 v226, v183, v179, s58
  v_mfma_f32_16x16x32_bf16 v[84:87], a[216:219], v[228:231], v[84:87]
  v_perm_b32 v227, v191, v187, s58
  v_mfma_f32_16x16x32_bf16 v[116:119], a[220:223], v[228:231], v[116:119]
  buffer_load_dwordx4 v[152:155], v237, s[16:19], s60 offen offset:2048
  v_mfma_f32_16x16x32_bf16 v[24:27], a[208:211], v[224:227], v[24:27]
  v_perm_b32 v228, v167, v163, s59
  v_perm_b32 v229, v175, v171, s59
  v_mfma_f32_16x16x32_bf16 v[56:59], a[212:215], v[224:227], v[56:59]
  v_perm_b32 v230, v183, v179, s59
  v_mfma_f32_16x16x32_bf16 v[88:91], a[216:219], v[224:227], v[88:91]
  v_perm_b32 v231, v191, v187, s59
  v_mfma_f32_16x16x32_bf16 v[120:123], a[220:223], v[224:227], v[120:123]
  buffer_load_dwordx4 v[156:159], v237, s[16:19], s60 offen offset:3072
  s_add_u32 s60, s60, 32768
  v_mfma_f32_16x16x32_bf16 v[28:31], a[208:211], v[228:231], v[28:31]
  s_waitcnt vmcnt(12)
  v_perm_b32 v224, v196, v192, s58
  v_perm_b32 v225, v204, v200, s58
  v_mfma_f32_16x16x32_bf16 v[60:63], a[212:215], v[228:231], v[60:63]
  s_waitcnt vmcnt(8)
  v_perm_b32 v226, v212, v208, s58
  v_mfma_f32_16x16x32_bf16 v[92:95], a[216:219], v[228:231], v[92:95]
  v_perm_b32 v227, v220, v216, s58
  v_mfma_f32_16x16x32_bf16 v[124:127], a[220:223], v[228:231], v[124:127]
  buffer_load_dwordx4 v[160:163], v236, s[16:19], s60 offen offset:0
  s_waitcnt lgkmcnt(0)
  v_mfma_f32_16x16x32_bf16 v[0:3], a[192:195], v[224:227], v[0:3]
  v_perm_b32 v228, v196, v192, s59
  v_perm_b32 v229, v204, v200, s59
  v_mfma_f32_16x16x32_bf16 v[32:35], a[196:199], v[224:227], v[32:35]
  v_perm_b32 v230, v212, v208, s59
  ds_read_b128 a[208:211], v244 offset:20480
  v_mfma_f32_16x16x32_bf16 v[64:67], a[200:203], v[224:227], v[64:67]
  v_perm_b32 v231, v220, v216, s59
  v_mfma_f32_16x16x32_bf16 v[96:99], a[204:207], v[224:227], v[96:99]
  buffer_load_dwordx4 v[164:167], v236, s[16:19], s60 offen offset:1024
  v_mfma_f32_16x16x32_bf16 v[4:7], a[192:195], v[228:231], v[4:7]
  v_perm_b32 v224, v197, v193, s58
  v_perm_b32 v225, v205, v201, s58
  v_mfma_f32_16x16x32_bf16 v[36:39], a[196:199], v[228:231], v[36:39]
  v_perm_b32 v226, v213, v209, s58
  ds_read_b128 a[212:215], v244 offset:21504
  v_mfma_f32_16x16x32_bf16 v[68:71], a[200:203], v[228:231], v[68:71]
  v_perm_b32 v227, v221, v217, s58
  v_mfma_f32_16x16x32_bf16 v[100:103], a[204:207], v[228:231], v[100:103]
  buffer_load_dwordx4 v[168:171], v236, s[16:19], s60 offen offset:2048
  v_mfma_f32_16x16x32_bf16 v[8:11], a[192:195], v[224:227], v[8:11]
  v_perm_b32 v228, v197, v193, s59
  v_perm_b32 v229, v205, v201, s59
  v_mfma_f32_16x16x32_bf16 v[40:43], a[196:199], v[224:227], v[40:43]
  v_perm_b32 v230, v213, v209, s59
  ds_read_b128 a[216:219], v244 offset:22528
  v_mfma_f32_16x16x32_bf16 v[72:75], a[200:203], v[224:227], v[72:75]
  v_perm_b32 v231, v221, v217, s59
  v_mfma_f32_16x16x32_bf16 v[104:107], a[204:207], v[224:227], v[104:107]
  buffer_load_dwordx4 v[172:175], v236, s[16:19], s60 offen offset:3072
  v_mfma_f32_16x16x32_bf16 v[12:15], a[192:195], v[228:231], v[12:15]
  v_perm_b32 v224, v198, v194, s58
  v_perm_b32 v225, v206, v202, s58
  v_mfma_f32_16x16x32_bf16 v[44:47], a[196:199], v[228:231], v[44:47]
  v_perm_b32 v226, v214, v210, s58
  ds_read_b128 a[220:223], v244 offset:23552
  v_mfma_f32_16x16x32_bf16 v[76:79], a[200:203], v[228:231], v[76:79]
  v_perm_b32 v227, v222, v218, s58
  v_mfma_f32_16x16x32_bf16 v[108:111], a[204:207], v[228:231], v[108:111]
  buffer_load_dwordx4 v[176:179], v237, s[16:19], s60 offen offset:0
  v_mfma_f32_16x16x32_bf16 v[16:19], a[192:195], v[224:227], v[16:19]
  v_perm_b32 v228, v198, v194, s59
  v_perm_b32 v229, v206, v202, s59
  v_mfma_f32_16x16x32_bf16 v[48:51], a[196:199], v[224:227], v[48:51]
  v_perm_b32 v230, v214, v210, s59
  v_mfma_f32_16x16x32_bf16 v[80:83], a[200:203], v[224:227], v[80:83]
  v_perm_b32 v231, v222, v218, s59
  v_mfma_f32_16x16x32_bf16 v[112:115], a[204:207], v[224:227], v[112:115]
  buffer_load_dwordx4 v[180:183], v237, s[16:19], s60 offen offset:1024
  v_mfma_f32_16x16x32_bf16 v[20:23], a[192:195], v[228:231], v[20:23]
  v_perm_b32 v224, v199, v195, s58
  v_perm_b32 v225, v207, v203, s58
  v_mfma_f32_16x16x32_bf16 v[52:55], a[196:199], v[228:231], v[52:55]
  v_perm_b32 v226, v215, v211, s58
  v_mfma_f32_16x16x32_bf16 v[84:87], a[200:203], v[228:231], v[84:87]
  v_perm_b32 v227, v223, v219, s58
  v_mfma_f32_16x16x32_bf16 v[116:119], a[204:207], v[228:231], v[116:119]
  buffer_load_dwordx4 v[184:187], v237, s[16:19], s60 offen offset:2048
  v_mfma_f32_16x16x32_bf16 v[24:27], a[192:195], v[224:227], v[24:27]
  v_perm_b32 v228, v199, v195, s59
  v_perm_b32 v229, v207, v203, s59
  v_mfma_f32_16x16x32_bf16 v[56:59], a[196:199], v[224:227], v[56:59]
  v_perm_b32 v230, v215, v211, s59
  v_mfma_f32_16x16x32_bf16 v[88:91], a[200:203], v[224:227], v[88:91]
  v_perm_b32 v231, v223, v219, s59
  v_mfma_f32_16x16x32_bf16 v[120:123], a[204:207], v[224:227], v[120:123]
  buffer_load_dwordx4 v[188:191], v237, s[16:19], s60 offen offset:3072
  s_add_u32 s60, s60, 32768
  v_mfma_f32_16x16x32_bf16 v[28:31], a[192:195], v[228:231], v[28:31]
  s_waitcnt vmcnt(12)
  v_perm_b32 v224, v132, v128, s58
  v_perm_b32 v225, v140, v136, s58
  v_mfma_f32_16x16x32_bf16 v[60:63], a[196:199], v[228:231], v[60:63]
  s_waitcnt vmcnt(8)
  v_perm_b32 v226, v148, v144, s58
  v_mfma_f32_16x16x32_bf16 v[92:95], a[200:203], v[228:231], v[92:95]
  v_perm_b32 v227, v156, v152, s58
  v_mfma_f32_16x16x32_bf16 v[124:127], a[204:207], v[228:231], v[124:127]
  buffer_load_dwordx4 v[192:195], v236, s[16:19], s60 offen offset:0
  s_waitcnt lgkmcnt(0)
  v_mfma_f32_16x16x32_bf16 v[0:3], a[208:211], v[224:227], v[0:3]
  v_perm_b32 v228, v132, v128, s59
  v_perm_b32 v229, v140, v136, s59
  v_mfma_f32_16x16x32_bf16 v[32:35], a[212:215], v[224:227], v[32:35]
  v_perm_b32 v230, v148, v144, s59
  ds_read_b128 a[192:195], v244 offset:24576
  v_mfma_f32_16x16x32_bf16 v[64:67], a[216:219], v[224:227], v[64:67]
  v_perm_b32 v231, v156, v152, s59
  v_mfma_f32_16x16x32_bf16 v[96:99], a[220:223], v[224:227], v[96:99]
  buffer_load_dwordx4 v[196:199], v236, s[16:19], s60 offen offset:1024
  v_mfma_f32_16x16x32_bf16 v[4:7], a[208:211], v[228:231], v[4:7]
  v_perm_b32 v224, v133, v129, s58
  v_perm_b32 v225, v141, v137, s58
  v_mfma_f32_16x16x32_bf16 v[36:39], a[212:215], v[228:231], v[36:39]
  v_perm_b32 v226, v149, v145, s58
  ds_read_b128 a[196:199], v244 offset:25600
  v_mfma_f32_16x16x32_bf16 v[68:71], a[216:219], v[228:231], v[68:71]
  v_perm_b32 v227, v157, v153, s58
  v_mfma_f32_16x16x32_bf16 v[100:103], a[220:223], v[228:231], v[100:103]
  buffer_load_dwordx4 v[200:203], v236, s[16:19], s60 offen offset:2048
  v_mfma_f32_16x16x32_bf16 v[8:11], a[208:211], v[224:227], v[8:11]
  v_perm_b32 v228, v133, v129, s59
  v_perm_b32 v229, v141, v137, s59
  v_mfma_f32_16x16x32_bf16 v[40:43], a[212:215], v[224:227], v[40:43]
  v_perm_b32 v230, v149, v145, s59
  ds_read_b128 a[200:203], v244 offset:26624
  v_mfma_f32_16x16x32_bf16 v[72:75], a[216:219], v[224:227], v[72:75]
  v_perm_b32 v231, v157, v153, s59
  v_mfma_f32_16x16x32_bf16 v[104:107], a[220:223], v[224:227], v[104:107]
  buffer_load_dwordx4 v[204:207], v236, s[16:19], s60 offen offset:3072
  v_mfma_f32_16x16x32_bf16 v[12:15], a[208:211], v[228:231], v[12:15]
  v_perm_b32 v224, v134, v130, s58
  v_perm_b32 v225, v142, v138, s58
  v_mfma_f32_16x16x32_bf16 v[44:47], a[212:215], v[228:231], v[44:47]
  v_perm_b32 v226, v150, v146, s58
  ds_read_b128 a[204:207], v244 offset:27648
  v_mfma_f32_16x16x32_bf16 v[76:79], a[216:219], v[228:231], v[76:79]
  v_perm_b32 v227, v158, v154, s58
  v_mfma_f32_16x16x32_bf16 v[108:111], a[220:223], v[228:231], v[108:111]
  buffer_load_dwordx4 v[208:211], v237, s[16:19], s60 offen offset:0
  v_mfma_f32_16x16x32_bf16 v[16:19], a[208:211], v[224:227], v[16:19]
  v_perm_b32 v228, v134, v130, s59
  v_perm_b32 v229, v142, v138, s59
  v_mfma_f32_16x16x32_bf16 v[48:51], a[212:215], v[224:227], v[48:51]
  v_perm_b32 v230, v150, v146, s59
  v_mfma_f32_16x16x32_bf16 v[80:83], a[216:219], v[224:227], v[80:83]
  v_perm_b32 v231, v158, v154, s59
  v_mfma_f32_16x16x32_bf16 v[112:115], a[220:223], v[224:227], v[112:115]
  buffer_load_dwordx4 v[212:215], v237, s[16:19], s60 offen offset:1024
  v_mfma_f32_16x16x32_bf16 v[20:23], a[208:211], v[228:231], v[20:23]
  v_perm_b32 v224, v135, v131, s58
  v_perm_b32 v225, v143, v139, s58
  v_mfma_f32_16x16x32_bf16 v[52:55], a[212:215], v[228:231], v[52:55]
  v_perm_b32 v226, v151, v147, s58
  v_mfma_f32_16x16x32_bf16 v[84:87], a[216:219], v[228:231], v[84:87]
  v_perm_b32 v227, v159, v155, s58
  v_mfma_f32_16x16x32_bf16 v[116:119], a[220:223], v[228:231], v[116:119]
  buffer_load_dwordx4 v[216:219], v237, s[16:19], s60 offen offset:2048
  v_mfma_f32_16x16x32_bf16 v[24:27], a[208:211], v[224:227], v[24:27]
  v_perm_b32 v228, v135, v131, s59
  v_perm_b32 v229, v143, v139, s59
  v_mfma_f32_16x16x32_bf16 v[56:59], a[212:215], v[224:227], v[56:59]
  v_perm_b32 v230, v151, v147, s59
  v_mfma_f32_16x16x32_bf16 v[88:91], a[216:219], v[224:227], v[88:91]
  v_perm_b32 v231, v159, v155, s59
  v_mfma_f32_16x16x32_bf16 v[120:123], a[220:223], v[224:227], v[120:123]
  buffer_load_dwordx4 v[220:223], v237, s[16:19], s60 offen offset:3072
  s_add_u32 s60, s60, 32768
  v_mfma_f32_16x16x32_bf16 v[28:31], a[208:211], v[228:231], v[28:31]
  s_waitcnt vmcnt(12)
  v_perm_b32 v224, v164, v160, s58
  v_perm_b32 v225, v172, v168, s58
  v_mfma_f32_16x16x32_bf16 v[60:63], a[212:215], v[228:231], v[60:63]
  s_waitcnt vmcnt(8)
  v_perm_b32 v226, v180, v176, s58
  v_mfma_f32_16x16x32_bf16 v[92:95], a[216:219], v[228:231], v[92:95]
  v_perm_b32 v227, v188, v184, s58
  v_mfma_f32_16x16x32_bf16 v[124:127], a[220:223], v[228:231], v[124:127]
  buffer_load_dwordx4 v[128:131], v236, s[16:19], s60 offen offset:0
  s_waitcnt lgkmcnt(0)
  v_mfma_f32_16x16x32_bf16 v[0:3], a[192:195], v[224:227], v[0:3]
  v_perm_b32 v228, v164, v160, s59
  v_perm_b32 v229, v172, v168, s59
  v_mfma_f32_16x16x32_bf16 v[32:35], a[196:199], v[224:227], v[32:35]
  v_perm_b32 v230, v180, v176, s59
  ds_read_b128 a[208:211], v244 offset:28672
  v_mfma_f32_16x16x32_bf16 v[64:67], a[200:203], v[224:227], v[64:67]
  v_perm_b32 v231, v188, v184, s59
  v_mfma_f32_16x16x32_bf16 v[96:99], a[204:207], v[224:227], v[96:99]
  buffer_load_dwordx4 v[132:135], v236, s[16:19], s60 offen offset:1024
  v_mfma_f32_16x16x32_bf16 v[4:7], a[192:195], v[228:231], v[4:7]
  v_perm_b32 v224, v165, v161, s58
  v_perm_b32 v225, v173, v169, s58
  v_mfma_f32_16x16x32_bf16 v[36:39], a[196:199], v[228:231], v[36:39]
  v_perm_b32 v226, v181, v177, s58
  ds_read_b128 a[212:215], v244 offset:29696
  v_mfma_f32_16x16x32_bf16 v[68:71], a[200:203], v[228:231], v[68:71]
  v_perm_b32 v227, v189, v185, s58
  v_mfma_f32_16x16x32_bf16 v[100:103], a[204:207], v[228:231], v[100:103]
  buffer_load_dwordx4 v[136:139], v236, s[16:19], s60 offen offset:2048
  v_mfma_f32_16x16x32_bf16 v[8:11], a[192:195], v[224:227], v[8:11]
  v_perm_b32 v228, v165, v161, s59
  v_perm_b32 v229, v173, v169, s59
  v_mfma_f32_16x16x32_bf16 v[40:43], a[196:199], v[224:227], v[40:43]
  v_perm_b32 v230, v181, v177, s59
  ds_read_b128 a[216:219], v244 offset:30720
  v_mfma_f32_16x16x32_bf16 v[72:75], a[200:203], v[224:227], v[72:75]
  v_perm_b32 v231, v189, v185, s59
  v_mfma_f32_16x16x32_bf16 v[104:107], a[204:207], v[224:227], v[104:107]
  buffer_load_dwordx4 v[140:143], v236, s[16:19], s60 offen offset:3072
  v_mfma_f32_16x16x32_bf16 v[12:15], a[192:195], v[228:231], v[12:15]
  v_perm_b32 v224, v166, v162, s58
  v_perm_b32 v225, v174, v170, s58
  v_mfma_f32_16x16x32_bf16 v[44:47], a[196:199], v[228:231], v[44:47]
  v_perm_b32 v226, v182, v178, s58
  ds_read_b128 a[220:223], v244 offset:31744
  v_mfma_f32_16x16x32_bf16 v[76:79], a[200:203], v[228:231], v[76:79]
  v_perm_b32 v227, v190, v186, s58
  v_mfma_f32_16x16x32_bf16 v[108:111], a[204:207], v[228:231], v[108:111]
  buffer_load_dwordx4 v[144:147], v237, s[16:19], s60 offen offset:0
  v_mfma_f32_16x16x32_bf16 v[16:19], a[192:195], v[224:227], v[16:19]
  v_perm_b32 v228, v166, v162, s59
  v_perm_b32 v229, v174, v170, s59
  v_mfma_f32_16x16x32_bf16 v[48:51], a[196:199], v[224:227], v[48:51]
  v_perm_b32 v230, v182, v178, s59
  v_mfma_f32_16x16x32_bf16 v[80:83], a[200:203], v[224:227], v[80:83]
  v_perm_b32 v231, v190, v186, s59
  v_mfma_f32_16x16x32_bf16 v[112:115], a[204:207], v[224:227], v[112:115]
  buffer_load_dwordx4 v[148:151], v237, s[16:19], s60 offen offset:1024
  v_mfma_f32_16x16x32_bf16 v[20:23], a[192:195], v[228:231], v[20:23]
  v_perm_b32 v224, v167, v163, s58
  v_perm_b32 v225, v175, v171, s58
  v_mfma_f32_16x16x32_bf16 v[52:55], a[196:199], v[228:231], v[52:55]
  v_perm_b32 v226, v183, v179, s58
  v_mfma_f32_16x16x32_bf16 v[84:87], a[200:203], v[228:231], v[84:87]
  v_perm_b32 v227, v191, v187, s58
  v_mfma_f32_16x16x32_bf16 v[116:119], a[204:207], v[228:231], v[116:119]
  buffer_load_dwordx4 v[152:155], v237, s[16:19], s60 offen offset:2048
  v_mfma_f32_16x16x32_bf16 v[24:27], a[192:195], v[224:227], v[24:27]
  v_perm_b32 v228, v167, v163, s59
  v_perm_b32 v229, v175, v171, s59
  v_mfma_f32_16x16x32_bf16 v[56:59], a[196:199], v[224:227], v[56:59]
  v_perm_b32 v230, v183, v179, s59
  v_mfma_f32_16x16x32_bf16 v[88:91], a[200:203], v[224:227], v[88:91]
  v_perm_b32 v231, v191, v187, s59
  v_mfma_f32_16x16x32_bf16 v[120:123], a[204:207], v[224:227], v[120:123]
  buffer_load_dwordx4 v[156:159], v237, s[16:19], s60 offen offset:3072
  s_add_u32 s60, s60, 32768
  v_mfma_f32_16x16x32_bf16 v[28:31], a[192:195], v[228:231], v[28:31]
  s_waitcnt vmcnt(12)
  v_perm_b32 v224, v196, v192, s58
  v_perm_b32 v225, v204, v200, s58
  v_mfma_f32_16x16x32_bf16 v[60:63], a[196:199], v[228:231], v[60:63]
  s_waitcnt vmcnt(8)
  v_perm_b32 v226, v212, v208, s58
  v_mfma_f32_16x16x32_bf16 v[92:95], a[200:203], v[228:231], v[92:95]
  v_perm_b32 v227, v220, v216, s58
  v_mfma_f32_16x16x32_bf16 v[124:127], a[204:207], v[228:231], v[124:127]
  buffer_load_dwordx4 v[160:163], v236, s[16:19], s60 offen offset:0
  s_waitcnt lgkmcnt(0)
  v_mfma_f32_16x16x32_bf16 v[0:3], a[208:211], v[224:227], v[0:3]
  v_perm_b32 v228, v196, v192, s59
  v_perm_b32 v229, v204, v200, s59
  v_mfma_f32_16x16x32_bf16 v[32:35], a[212:215], v[224:227], v[32:35]
  v_perm_b32 v230, v212, v208, s59
  ds_read_b128 a[192:195], v245 offset:0
  v_mfma_f32_16x16x32_bf16 v[64:67], a[216:219], v[224:227], v[64:67]
  v_perm_b32 v231, v220, v216, s59
  v_mfma_f32_16x16x32_bf16 v[96:99], a[220:223], v[224:227], v[96:99]
  buffer_load_dwordx4 v[164:167], v236, s[16:19], s60 offen offset:1024
  v_mfma_f32_16x16x32_bf16 v[4:7], a[208:211], v[228:231], v[4:7]
  v_perm_b32 v224, v197, v193, s58
  v_perm_b32 v225, v205, v201, s58
  v_mfma_f32_16x16x32_bf16 v[36:39], a[212:215], v[228:231], v[36:39]
  v_perm_b32 v226, v213, v209, s58
  ds_read_b128 a[196:199], v245 offset:1024
  v_mfma_f32_16x16x32_bf16 v[68:71], a[216:219], v[228:231], v[68:71]
  v_perm_b32 v227, v221, v217, s58
  v_mfma_f32_16x16x32_bf16 v[100:103], a[220:223], v[228:231], v[100:103]
  buffer_load_dwordx4 v[168:171], v236, s[16:19], s60 offen offset:2048
  v_mfma_f32_16x16x32_bf16 v[8:11], a[208:211], v[224:227], v[8:11]
  v_perm_b32 v228, v197, v193, s59
  v_perm_b32 v229, v205, v201, s59
  v_mfma_f32_16x16x32_bf16 v[40:43], a[212:215], v[224:227], v[40:43]
  v_perm_b32 v230, v213, v209, s59
  ds_read_b128 a[200:203], v245 offset:2048
  v_mfma_f32_16x16x32_bf16 v[72:75], a[216:219], v[224:227], v[72:75]
  v_perm_b32 v231, v221, v217, s59
  v_mfma_f32_16x16x32_bf16 v[104:107], a[220:223], v[224:227], v[104:107]
  buffer_load_dwordx4 v[172:175], v236, s[16:19], s60 offen offset:3072
  v_mfma_f32_16x16x32_bf16 v[12:15], a[208:211], v[228:231], v[12:15]
  v_perm_b32 v224, v198, v194, s58
  v_perm_b32 v225, v206, v202, s58
  v_mfma_f32_16x16x32_bf16 v[44:47], a[212:215], v[228:231], v[44:47]
  v_perm_b32 v226, v214, v210, s58
  ds_read_b128 a[204:207], v245 offset:3072
  v_mfma_f32_16x16x32_bf16 v[76:79], a[216:219], v[228:231], v[76:79]
  v_perm_b32 v227, v222, v218, s58
  v_mfma_f32_16x16x32_bf16 v[108:111], a[220:223], v[228:231], v[108:111]
  buffer_load_dwordx4 v[176:179], v237, s[16:19], s60 offen offset:0
  v_mfma_f32_16x16x32_bf16 v[16:19], a[208:211], v[224:227], v[16:19]
  v_perm_b32 v228, v198, v194, s59
  v_perm_b32 v229, v206, v202, s59
  v_mfma_f32_16x16x32_bf16 v[48:51], a[212:215], v[224:227], v[48:51]
  v_perm_b32 v230, v214, v210, s59
  v_mfma_f32_16x16x32_bf16 v[80:83], a[216:219], v[224:227], v[80:83]
  v_perm_b32 v231, v222, v218, s59
  v_mfma_f32_16x16x32_bf16 v[112:115], a[220:223], v[224:227], v[112:115]
  buffer_load_dwordx4 v[180:183], v237, s[16:19], s60 offen offset:1024
  v_mfma_f32_16x16x32_bf16 v[20:23], a[208:211], v[228:231], v[20:23]
  v_perm_b32 v224, v199, v195, s58
  v_perm_b32 v225, v207, v203, s58
  v_mfma_f32_16x16x32_bf16 v[52:55], a[212:215], v[228:231], v[52:55]
  v_perm_b32 v226, v215, v211, s58
  v_mfma_f32_16x16x32_bf16 v[84:87], a[216:219], v[228:231], v[84:87]
  v_perm_b32 v227, v223, v219, s58
  v_mfma_f32_16x16x32_bf16 v[116:119], a[220:223], v[228:231], v[116:119]
  buffer_load_dwordx4 v[184:187], v237, s[16:19], s60 offen offset:2048
  v_mfma_f32_16x16x32_bf16 v[24:27], a[208:211], v[224:227], v[24:27]
  v_perm_b32 v228, v199, v195, s59
  v_perm_b32 v229, v207, v203, s59
  v_mfma_f32_16x16x32_bf16 v[56:59], a[212:215], v[224:227], v[56:59]
  v_perm_b32 v230, v215, v211, s59
  v_mfma_f32_16x16x32_bf16 v[88:91], a[216:219], v[224:227], v[88:91]
  v_perm_b32 v231, v223, v219, s59
  v_mfma_f32_16x16x32_bf16 v[120:123], a[220:223], v[224:227], v[120:123]
  buffer_load_dwordx4 v[188:191], v237, s[16:19], s60 offen offset:3072
  s_add_u32 s60, s60, 32768
  v_mfma_f32_16x16x32_bf16 v[28:31], a[208:211], v[228:231], v[28:31]
  s_waitcnt vmcnt(12)
  v_perm_b32 v224, v132, v128, s58
  v_perm_b32 v225, v140, v136, s58
  v_mfma_f32_16x16x32_bf16 v[60:63], a[212:215], v[228:231], v[60:63]
  s_waitcnt vmcnt(8)
  v_perm_b32 v226, v148, v144, s58
  v_mfma_f32_16x16x32_bf16 v[92:95], a[216:219], v[228:231], v[92:95]
  v_perm_b32 v227, v156, v152, s58
  v_mfma_f32_16x16x32_bf16 v[124:127], a[220:223], v[228:231], v[124:127]
  buffer_load_dwordx4 v[192:195], v236, s[16:19], s60 offen offset:0
  s_waitcnt lgkmcnt(0)
  v_mfma_f32_16x16x32_bf16 v[0:3], a[192:195], v[224:227], v[0:3]
  v_perm_b32 v228, v132, v128, s59
  v_perm_b32 v229, v140, v136, s59
  v_mfma_f32_16x16x32_bf16 v[32:35], a[196:199], v[224:227], v[32:35]
  v_perm_b32 v230, v148, v144, s59
  ds_read_b128 a[208:211], v245 offset:4096
  v_mfma_f32_16x16x32_bf16 v[64:67], a[200:203], v[224:227], v[64:67]
  v_perm_b32 v231, v156, v152, s59
  v_mfma_f32_16x16x32_bf16 v[96:99], a[204:207], v[224:227], v[96:99]
  buffer_load_dwordx4 v[196:199], v236, s[16:19], s60 offen offset:1024
  v_mfma_f32_16x16x32_bf16 v[4:7], a[192:195], v[228:231], v[4:7]
  v_perm_b32 v224, v133, v129, s58
  v_perm_b32 v225, v141, v137, s58
  v_mfma_f32_16x16x32_bf16 v[36:39], a[196:199], v[228:231], v[36:39]
  v_perm_b32 v226, v149, v145, s58
  ds_read_b128 a[212:215], v245 offset:5120
  v_mfma_f32_16x16x32_bf16 v[68:71], a[200:203], v[228:231], v[68:71]
  v_perm_b32 v227, v157, v153, s58
  v_mfma_f32_16x16x32_bf16 v[100:103], a[204:207], v[228:231], v[100:103]
  buffer_load_dwordx4 v[200:203], v236, s[16:19], s60 offen offset:2048
  v_mfma_f32_16x16x32_bf16 v[8:11], a[192:195], v[224:227], v[8:11]
  v_perm_b32 v228, v133, v129, s59
  v_perm_b32 v229, v141, v137, s59
  v_mfma_f32_16x16x32_bf16 v[40:43], a[196:199], v[224:227], v[40:43]
  v_perm_b32 v230, v149, v145, s59
  ds_read_b128 a[216:219], v245 offset:6144
  v_mfma_f32_16x16x32_bf16 v[72:75], a[200:203], v[224:227], v[72:75]
  v_perm_b32 v231, v157, v153, s59
  v_mfma_f32_16x16x32_bf16 v[104:107], a[204:207], v[224:227], v[104:107]
  buffer_load_dwordx4 v[204:207], v236, s[16:19], s60 offen offset:3072
  v_mfma_f32_16x16x32_bf16 v[12:15], a[192:195], v[228:231], v[12:15]
  v_perm_b32 v224, v134, v130, s58
  v_perm_b32 v225, v142, v138, s58
  v_mfma_f32_16x16x32_bf16 v[44:47], a[196:199], v[228:231], v[44:47]
  v_perm_b32 v226, v150, v146, s58
  ds_read_b128 a[220:223], v245 offset:7168
  v_mfma_f32_16x16x32_bf16 v[76:79], a[200:203], v[228:231], v[76:79]
  v_perm_b32 v227, v158, v154, s58
  v_mfma_f32_16x16x32_bf16 v[108:111], a[204:207], v[228:231], v[108:111]
  buffer_load_dwordx4 v[208:211], v237, s[16:19], s60 offen offset:0
  v_mfma_f32_16x16x32_bf16 v[16:19], a[192:195], v[224:227], v[16:19]
  v_perm_b32 v228, v134, v130, s59
  v_perm_b32 v229, v142, v138, s59
  v_mfma_f32_16x16x32_bf16 v[48:51], a[196:199], v[224:227], v[48:51]
  v_perm_b32 v230, v150, v146, s59
  v_mfma_f32_16x16x32_bf16 v[80:83], a[200:203], v[224:227], v[80:83]
  v_perm_b32 v231, v158, v154, s59
  v_mfma_f32_16x16x32_bf16 v[112:115], a[204:207], v[224:227], v[112:115]
  buffer_load_dwordx4 v[212:215], v237, s[16:19], s60 offen offset:1024
  v_mfma_f32_16x16x32_bf16 v[20:23], a[192:195], v[228:231], v[20:23]
  v_perm_b32 v224, v135, v131, s58
  v_perm_b32 v225, v143, v139, s58
  v_mfma_f32_16x16x32_bf16 v[52:55], a[196:199], v[228:231], v[52:55]
  v_perm_b32 v226, v151, v147, s58
  v_mfma_f32_16x16x32_bf16 v[84:87], a[200:203], v[228:231], v[84:87]
  v_perm_b32 v227, v159, v155, s58
  v_mfma_f32_16x16x32_bf16 v[116:119], a[204:207], v[228:231], v[116:119]
  buffer_load_dwordx4 v[216:219], v237, s[16:19], s60 offen offset:2048
  v_mfma_f32_16x16x32_bf16 v[24:27], a[192:195], v[224:227], v[24:27]
  v_perm_b32 v228, v135, v131, s59
  v_perm_b32 v229, v143, v139, s59
  v_mfma_f32_16x16x32_bf16 v[56:59], a[196:199], v[224:227], v[56:59]
  v_perm_b32 v230, v151, v147, s59
  v_mfma_f32_16x16x32_bf16 v[88:91], a[200:203], v[224:227], v[88:91]
  v_perm_b32 v231, v159, v155, s59
  v_mfma_f32_16x16x32_bf16 v[120:123], a[204:207], v[224:227], v[120:123]
  buffer_load_dwordx4 v[220:223], v237, s[16:19], s60 offen offset:3072
  s_add_u32 s60, s60, 32768
  v_mfma_f32_16x16x32_bf16 v[28:31], a[192:195], v[228:231], v[28:31]
  s_waitcnt vmcnt(12)
  v_perm_b32 v224, v164, v160, s58
  v_perm_b32 v225, v172, v168, s58
  v_mfma_f32_16x16x32_bf16 v[60:63], a[196:199], v[228:231], v[60:63]
  s_waitcnt vmcnt(8)
  v_perm_b32 v226, v180, v176, s58
  v_mfma_f32_16x16x32_bf16 v[92:95], a[200:203], v[228:231], v[92:95]
  v_perm_b32 v227, v188, v184, s58
  v_mfma_f32_16x16x32_bf16 v[124:127], a[204:207], v[228:231], v[124:127]
  buffer_load_dwordx4 v[128:131], v236, s[16:19], s60 offen offset:0
  s_waitcnt lgkmcnt(0)
  v_mfma_f32_16x16x32_bf16 v[0:3], a[208:211], v[224:227], v[0:3]
  v_perm_b32 v228, v164, v160, s59
  v_perm_b32 v229, v172, v168, s59
  v_mfma_f32_16x16x32_bf16 v[32:35], a[212:215], v[224:227], v[32:35]
  v_perm_b32 v230, v180, v176, s59
  ds_read_b128 a[192:195], v245 offset:8192
  v_mfma_f32_16x16x32_bf16 v[64:67], a[216:219], v[224:227], v[64:67]
  v_perm_b32 v231, v188, v184, s59
  v_mfma_f32_16x16x32_bf16 v[96:99], a[220:223], v[224:227], v[96:99]
  buffer_load_dwordx4 v[132:135], v236, s[16:19], s60 offen offset:1024
  v_mfma_f32_16x16x32_bf16 v[4:7], a[208:211], v[228:231], v[4:7]
  v_perm_b32 v224, v165, v161, s58
  v_perm_b32 v225, v173, v169, s58
  v_mfma_f32_16x16x32_bf16 v[36:39], a[212:215], v[228:231], v[36:39]
  v_perm_b32 v226, v181, v177, s58
  ds_read_b128 a[196:199], v245 offset:9216
  v_mfma_f32_16x16x32_bf16 v[68:71], a[216:219], v[228:231], v[68:71]
  v_perm_b32 v227, v189, v185, s58
  v_mfma_f32_16x16x32_bf16 v[100:103], a[220:223], v[228:231], v[100:103]
  buffer_load_dwordx4 v[136:139], v236, s[16:19], s60 offen offset:2048
  v_mfma_f32_16x16x32_bf16 v[8:11], a[208:211], v[224:227], v[8:11]
  v_perm_b32 v228, v165, v161, s59
  v_perm_b32 v229, v173, v169, s59
  v_mfma_f32_16x16x32_bf16 v[40:43], a[212:215], v[224:227], v[40:43]
  v_perm_b32 v230, v181, v177, s59
  ds_read_b128 a[200:203], v245 offset:10240
  v_mfma_f32_16x16x32_bf16 v[72:75], a[216:219], v[224:227], v[72:75]
  v_perm_b32 v231, v189, v185, s59
  v_mfma_f32_16x16x32_bf16 v[104:107], a[220:223], v[224:227], v[104:107]
  buffer_load_dwordx4 v[140:143], v236, s[16:19], s60 offen offset:3072
  v_mfma_f32_16x16x32_bf16 v[12:15], a[208:211], v[228:231], v[12:15]
  v_perm_b32 v224, v166, v162, s58
  v_perm_b32 v225, v174, v170, s58
  v_mfma_f32_16x16x32_bf16 v[44:47], a[212:215], v[228:231], v[44:47]
  v_perm_b32 v226, v182, v178, s58
  ds_read_b128 a[204:207], v245 offset:11264
  v_mfma_f32_16x16x32_bf16 v[76:79], a[216:219], v[228:231], v[76:79]
  v_perm_b32 v227, v190, v186, s58
  v_mfma_f32_16x16x32_bf16 v[108:111], a[220:223], v[228:231], v[108:111]
  buffer_load_dwordx4 v[144:147], v237, s[16:19], s60 offen offset:0
  v_mfma_f32_16x16x32_bf16 v[16:19], a[208:211], v[224:227], v[16:19]
  v_perm_b32 v228, v166, v162, s59
  v_perm_b32 v229, v174, v170, s59
  v_mfma_f32_16x16x32_bf16 v[48:51], a[212:215], v[224:227], v[48:51]
  v_perm_b32 v230, v182, v178, s59
  v_mfma_f32_16x16x32_bf16 v[80:83], a[216:219], v[224:227], v[80:83]
  v_perm_b32 v231, v190, v186, s59
  v_mfma_f32_16x16x32_bf16 v[112:115], a[220:223], v[224:227], v[112:115]
  buffer_load_dwordx4 v[148:151], v237, s[16:19], s60 offen offset:1024
  v_mfma_f32_16x16x32_bf16 v[20:23], a[208:211], v[228:231], v[20:23]
  v_perm_b32 v224, v167, v163, s58
  v_perm_b32 v225, v175, v171, s58
  v_mfma_f32_16x16x32_bf16 v[52:55], a[212:215], v[228:231], v[52:55]
  v_perm_b32 v226, v183, v179, s58
  v_mfma_f32_16x16x32_bf16 v[84:87], a[216:219], v[228:231], v[84:87]
  v_perm_b32 v227, v191, v187, s58
  v_mfma_f32_16x16x32_bf16 v[116:119], a[220:223], v[228:231], v[116:119]
  buffer_load_dwordx4 v[152:155], v237, s[16:19], s60 offen offset:2048
  v_mfma_f32_16x16x32_bf16 v[24:27], a[208:211], v[224:227], v[24:27]
  v_perm_b32 v228, v167, v163, s59
  v_perm_b32 v229, v175, v171, s59
  v_mfma_f32_16x16x32_bf16 v[56:59], a[212:215], v[224:227], v[56:59]
  v_perm_b32 v230, v183, v179, s59
  v_mfma_f32_16x16x32_bf16 v[88:91], a[216:219], v[224:227], v[88:91]
  v_perm_b32 v231, v191, v187, s59
  v_mfma_f32_16x16x32_bf16 v[120:123], a[220:223], v[224:227], v[120:123]
  buffer_load_dwordx4 v[156:159], v237, s[16:19], s60 offen offset:3072
  s_add_u32 s60, s60, 32768
  v_mfma_f32_16x16x32_bf16 v[28:31], a[208:211], v[228:231], v[28:31]
  s_waitcnt vmcnt(12)
  v_perm_b32 v224, v196, v192, s58
  v_perm_b32 v225, v204, v200, s58
  v_mfma_f32_16x16x32_bf16 v[60:63], a[212:215], v[228:231], v[60:63]
  s_waitcnt vmcnt(8)
  v_perm_b32 v226, v212, v208, s58
  v_mfma_f32_16x16x32_bf16 v[92:95], a[216:219], v[228:231], v[92:95]
  v_perm_b32 v227, v220, v216, s58
  v_mfma_f32_16x16x32_bf16 v[124:127], a[220:223], v[228:231], v[124:127]
  buffer_load_dwordx4 v[160:163], v236, s[16:19], s60 offen offset:0
  s_waitcnt lgkmcnt(0)
  v_mfma_f32_16x16x32_bf16 v[0:3], a[192:195], v[224:227], v[0:3]
  v_perm_b32 v228, v196, v192, s59
  v_perm_b32 v229, v204, v200, s59
  v_mfma_f32_16x16x32_bf16 v[32:35], a[196:199], v[224:227], v[32:35]
  v_perm_b32 v230, v212, v208, s59
  ds_read_b128 a[208:211], v245 offset:12288
  v_mfma_f32_16x16x32_bf16 v[64:67], a[200:203], v[224:227], v[64:67]
  v_perm_b32 v231, v220, v216, s59
  v_mfma_f32_16x16x32_bf16 v[96:99], a[204:207], v[224:227], v[96:99]
  buffer_load_dwordx4 v[164:167], v236, s[16:19], s60 offen offset:1024
  v_mfma_f32_16x16x32_bf16 v[4:7], a[192:195], v[228:231], v[4:7]
  v_perm_b32 v224, v197, v193, s58
  v_perm_b32 v225, v205, v201, s58
  v_mfma_f32_16x16x32_bf16 v[36:39], a[196:199], v[228:231], v[36:39]
  v_perm_b32 v226, v213, v209, s58
  ds_read_b128 a[212:215], v245 offset:13312
  v_mfma_f32_16x16x32_bf16 v[68:71], a[200:203], v[228:231], v[68:71]
  v_perm_b32 v227, v221, v217, s58
  v_mfma_f32_16x16x32_bf16 v[100:103], a[204:207], v[228:231], v[100:103]
  buffer_load_dwordx4 v[168:171], v236, s[16:19], s60 offen offset:2048
  v_mfma_f32_16x16x32_bf16 v[8:11], a[192:195], v[224:227], v[8:11]
  v_perm_b32 v228, v197, v193, s59
  v_perm_b32 v229, v205, v201, s59
  v_mfma_f32_16x16x32_bf16 v[40:43], a[196:199], v[224:227], v[40:43]
  v_perm_b32 v230, v213, v209, s59
  ds_read_b128 a[216:219], v245 offset:14336
  v_mfma_f32_16x16x32_bf16 v[72:75], a[200:203], v[224:227], v[72:75]
  v_perm_b32 v231, v221, v217, s59
  v_mfma_f32_16x16x32_bf16 v[104:107], a[204:207], v[224:227], v[104:107]
  buffer_load_dwordx4 v[172:175], v236, s[16:19], s60 offen offset:3072
  v_mfma_f32_16x16x32_bf16 v[12:15], a[192:195], v[228:231], v[12:15]
  v_perm_b32 v224, v198, v194, s58
  v_perm_b32 v225, v206, v202, s58
  v_mfma_f32_16x16x32_bf16 v[44:47], a[196:199], v[228:231], v[44:47]
  v_perm_b32 v226, v214, v210, s58
  ds_read_b128 a[220:223], v245 offset:15360
  v_mfma_f32_16x16x32_bf16 v[76:79], a[200:203], v[228:231], v[76:79]
  v_perm_b32 v227, v222, v218, s58
  v_mfma_f32_16x16x32_bf16 v[108:111], a[204:207], v[228:231], v[108:111]
  buffer_load_dwordx4 v[176:179], v237, s[16:19], s60 offen offset:0
  v_mfma_f32_16x16x32_bf16 v[16:19], a[192:195], v[224:227], v[16:19]
  v_perm_b32 v228, v198, v194, s59
  v_perm_b32 v229, v206, v202, s59
  v_mfma_f32_16x16x32_bf16 v[48:51], a[196:199], v[224:227], v[48:51]
  v_perm_b32 v230, v214, v210, s59
  v_mfma_f32_16x16x32_bf16 v[80:83], a[200:203], v[224:227], v[80:83]
  v_perm_b32 v231, v222, v218, s59
  v_mfma_f32_16x16x32_bf16 v[112:115], a[204:207], v[224:227], v[112:115]
  buffer_load_dwordx4 v[180:183], v237, s[16:19], s60 offen offset:1024
  v_mfma_f32_16x16x32_bf16 v[20:23], a[192:195], v[228:231], v[20:23]
  v_perm_b32 v224, v199, v195, s58
  v_perm_b32 v225, v207, v203, s58
  v_mfma_f32_16x16x32_bf16 v[52:55], a[196:199], v[228:231], v[52:55]
  v_perm_b32 v226, v215, v211, s58
  v_mfma_f32_16x16x32_bf16 v[84:87], a[200:203], v[228:231], v[84:87]
  v_perm_b32 v227, v223, v219, s58
  v_mfma_f32_16x16x32_bf16 v[116:119], a[204:207], v[228:231], v[116:119]
  buffer_load_dwordx4 v[184:187], v237, s[16:19], s60 offen offset:2048
  v_mfma_f32_16x16x32_bf16 v[24:27], a[192:195], v[224:227], v[24:27]
  v_perm_b32 v228, v199, v195, s59
  v_perm_b32 v229, v207, v203, s59
  v_mfma_f32_16x16x32_bf16 v[56:59], a[196:199], v[224:227], v[56:59]
  v_perm_b32 v230, v215, v211, s59
  v_mfma_f32_16x16x32_bf16 v[88:91], a[200:203], v[224:227], v[88:91]
  v_perm_b32 v231, v223, v219, s59
  v_mfma_f32_16x16x32_bf16 v[120:123], a[204:207], v[224:227], v[120:123]
  buffer_load_dwordx4 v[188:191], v237, s[16:19], s60 offen offset:3072
  s_add_u32 s60, s60, 32768
  v_mfma_f32_16x16x32_bf16 v[28:31], a[192:195], v[228:231], v[28:31]
  s_waitcnt vmcnt(12)
  v_perm_b32 v224, v132, v128, s58
  v_perm_b32 v225, v140, v136, s58
  v_mfma_f32_16x16x32_bf16 v[60:63], a[196:199], v[228:231], v[60:63]
  s_waitcnt vmcnt(8)
  v_perm_b32 v226, v148, v144, s58
  v_mfma_f32_16x16x32_bf16 v[92:95], a[200:203], v[228:231], v[92:95]
  v_perm_b32 v227, v156, v152, s58
  v_mfma_f32_16x16x32_bf16 v[124:127], a[204:207], v[228:231], v[124:127]
  buffer_load_dwordx4 v[192:195], v236, s[16:19], s60 offen offset:0
  s_waitcnt lgkmcnt(0)
  v_mfma_f32_16x16x32_bf16 v[0:3], a[208:211], v[224:227], v[0:3]
  v_perm_b32 v228, v132, v128, s59
  v_perm_b32 v229, v140, v136, s59
  v_mfma_f32_16x16x32_bf16 v[32:35], a[212:215], v[224:227], v[32:35]
  v_perm_b32 v230, v148, v144, s59
  ds_read_b128 a[192:195], v245 offset:16384
  v_mfma_f32_16x16x32_bf16 v[64:67], a[216:219], v[224:227], v[64:67]
  v_perm_b32 v231, v156, v152, s59
  v_mfma_f32_16x16x32_bf16 v[96:99], a[220:223], v[224:227], v[96:99]
  buffer_load_dwordx4 v[196:199], v236, s[16:19], s60 offen offset:1024
  v_mfma_f32_16x16x32_bf16 v[4:7], a[208:211], v[228:231], v[4:7]
  v_perm_b32 v224, v133, v129, s58
  v_perm_b32 v225, v141, v137, s58
  v_mfma_f32_16x16x32_bf16 v[36:39], a[212:215], v[228:231], v[36:39]
  v_perm_b32 v226, v149, v145, s58
  ds_read_b128 a[196:199], v245 offset:17408
  v_mfma_f32_16x16x32_bf16 v[68:71], a[216:219], v[228:231], v[68:71]
  v_perm_b32 v227, v157, v153, s58
  v_mfma_f32_16x16x32_bf16 v[100:103], a[220:223], v[228:231], v[100:103]
  buffer_load_dwordx4 v[200:203], v236, s[16:19], s60 offen offset:2048
  v_mfma_f32_16x16x32_bf16 v[8:11], a[208:211], v[224:227], v[8:11]
  v_perm_b32 v228, v133, v129, s59
  v_perm_b32 v229, v141, v137, s59
  v_mfma_f32_16x16x32_bf16 v[40:43], a[212:215], v[224:227], v[40:43]
  v_perm_b32 v230, v149, v145, s59
  ds_read_b128 a[200:203], v245 offset:18432
  v_mfma_f32_16x16x32_bf16 v[72:75], a[216:219], v[224:227], v[72:75]
  v_perm_b32 v231, v157, v153, s59
  v_mfma_f32_16x16x32_bf16 v[104:107], a[220:223], v[224:227], v[104:107]
  buffer_load_dwordx4 v[204:207], v236, s[16:19], s60 offen offset:3072
  v_mfma_f32_16x16x32_bf16 v[12:15], a[208:211], v[228:231], v[12:15]
  v_perm_b32 v224, v134, v130, s58
  v_perm_b32 v225, v142, v138, s58
  v_mfma_f32_16x16x32_bf16 v[44:47], a[212:215], v[228:231], v[44:47]
  v_perm_b32 v226, v150, v146, s58
  ds_read_b128 a[204:207], v245 offset:19456
  v_mfma_f32_16x16x32_bf16 v[76:79], a[216:219], v[228:231], v[76:79]
  v_perm_b32 v227, v158, v154, s58
  v_mfma_f32_16x16x32_bf16 v[108:111], a[220:223], v[228:231], v[108:111]
  buffer_load_dwordx4 v[208:211], v237, s[16:19], s60 offen offset:0
  v_mfma_f32_16x16x32_bf16 v[16:19], a[208:211], v[224:227], v[16:19]
  v_perm_b32 v228, v134, v130, s59
  v_perm_b32 v229, v142, v138, s59
  v_mfma_f32_16x16x32_bf16 v[48:51], a[212:215], v[224:227], v[48:51]
  v_perm_b32 v230, v150, v146, s59
  v_mfma_f32_16x16x32_bf16 v[80:83], a[216:219], v[224:227], v[80:83]
  v_perm_b32 v231, v158, v154, s59
  v_mfma_f32_16x16x32_bf16 v[112:115], a[220:223], v[224:227], v[112:115]
  buffer_load_dwordx4 v[212:215], v237, s[16:19], s60 offen offset:1024
  v_mfma_f32_16x16x32_bf16 v[20:23], a[208:211], v[228:231], v[20:23]
  v_perm_b32 v224, v135, v131, s58
  v_perm_b32 v225, v143, v139, s58
  v_mfma_f32_16x16x32_bf16 v[52:55], a[212:215], v[228:231], v[52:55]
  v_perm_b32 v226, v151, v147, s58
  v_mfma_f32_16x16x32_bf16 v[84:87], a[216:219], v[228:231], v[84:87]
  v_perm_b32 v227, v159, v155, s58
  v_mfma_f32_16x16x32_bf16 v[116:119], a[220:223], v[228:231], v[116:119]
  buffer_load_dwordx4 v[216:219], v237, s[16:19], s60 offen offset:2048
  v_mfma_f32_16x16x32_bf16 v[24:27], a[208:211], v[224:227], v[24:27]
  v_perm_b32 v228, v135, v131, s59
  v_perm_b32 v229, v143, v139, s59
  v_mfma_f32_16x16x32_bf16 v[56:59], a[212:215], v[224:227], v[56:59]
  v_perm_b32 v230, v151, v147, s59
  v_mfma_f32_16x16x32_bf16 v[88:91], a[216:219], v[224:227], v[88:91]
  v_perm_b32 v231, v159, v155, s59
  v_mfma_f32_16x16x32_bf16 v[120:123], a[220:223], v[224:227], v[120:123]
  buffer_load_dwordx4 v[220:223], v237, s[16:19], s60 offen offset:3072
  s_add_u32 s60, s60, 32768
  v_mfma_f32_16x16x32_bf16 v[28:31], a[208:211], v[228:231], v[28:31]
  s_waitcnt vmcnt(12)
  v_perm_b32 v224, v164, v160, s58
  v_perm_b32 v225, v172, v168, s58
  v_mfma_f32_16x16x32_bf16 v[60:63], a[212:215], v[228:231], v[60:63]
  s_waitcnt vmcnt(8)
  v_perm_b32 v226, v180, v176, s58
  v_mfma_f32_16x16x32_bf16 v[92:95], a[216:219], v[228:231], v[92:95]
  v_perm_b32 v227, v188, v184, s58
  v_mfma_f32_16x16x32_bf16 v[124:127], a[220:223], v[228:231], v[124:127]
  buffer_load_dwordx4 v[128:131], v236, s[16:19], s60 offen offset:0
  s_waitcnt lgkmcnt(0)
  v_mfma_f32_16x16x32_bf16 v[0:3], a[192:195], v[224:227], v[0:3]
  v_perm_b32 v228, v164, v160, s59
  v_perm_b32 v229, v172, v168, s59
  v_mfma_f32_16x16x32_bf16 v[32:35], a[196:199], v[224:227], v[32:35]
  v_perm_b32 v230, v180, v176, s59
  ds_read_b128 a[128:131], v245 offset:20480
  v_mfma_f32_16x16x32_bf16 v[64:67], a[200:203], v[224:227], v[64:67]
  v_perm_b32 v231, v188, v184, s59
  ds_read_b128 a[132:135], v245 offset:21504
  v_mfma_f32_16x16x32_bf16 v[96:99], a[204:207], v[224:227], v[96:99]
  buffer_load_dwordx4 v[132:135], v236, s[16:19], s60 offen offset:1024
  v_mfma_f32_16x16x32_bf16 v[4:7], a[192:195], v[228:231], v[4:7]
  v_perm_b32 v224, v165, v161, s58
  v_perm_b32 v225, v173, v169, s58
  v_mfma_f32_16x16x32_bf16 v[36:39], a[196:199], v[228:231], v[36:39]
  v_perm_b32 v226, v181, v177, s58
  ds_read_b128 a[136:139], v245 offset:22528
  v_mfma_f32_16x16x32_bf16 v[68:71], a[200:203], v[228:231], v[68:71]
  v_perm_b32 v227, v189, v185, s58
  ds_read_b128 a[140:143], v245 offset:23552
  v_mfma_f32_16x16x32_bf16 v[100:103], a[204:207], v[228:231], v[100:103]
  buffer_load_dwordx4 v[136:139], v236, s[16:19], s60 offen offset:2048
  v_mfma_f32_16x16x32_bf16 v[8:11], a[192:195], v[224:227], v[8:11]
  v_perm_b32 v228, v165, v161, s59
  v_perm_b32 v229, v173, v169, s59
  v_mfma_f32_16x16x32_bf16 v[40:43], a[196:199], v[224:227], v[40:43]
  v_perm_b32 v230, v181, v177, s59
  ds_read_b128 a[144:147], v245 offset:24576
  v_mfma_f32_16x16x32_bf16 v[72:75], a[200:203], v[224:227], v[72:75]
  v_perm_b32 v231, v189, v185, s59
  ds_read_b128 a[148:151], v245 offset:25600
  v_mfma_f32_16x16x32_bf16 v[104:107], a[204:207], v[224:227], v[104:107]
  buffer_load_dwordx4 v[140:143], v236, s[16:19], s60 offen offset:3072
  v_mfma_f32_16x16x32_bf16 v[12:15], a[192:195], v[228:231], v[12:15]
  v_perm_b32 v224, v166, v162, s58
  v_perm_b32 v225, v174, v170, s58
  v_mfma_f32_16x16x32_bf16 v[44:47], a[196:199], v[228:231], v[44:47]
  v_perm_b32 v226, v182, v178, s58
  ds_read_b128 a[152:155], v245 offset:26624
  v_mfma_f32_16x16x32_bf16 v[76:79], a[200:203], v[228:231], v[76:79]
  v_perm_b32 v227, v190, v186, s58
  ds_read_b128 a[156:159], v245 offset:27648
  v_mfma_f32_16x16x32_bf16 v[108:111], a[204:207], v[228:231], v[108:111]
  buffer_load_dwordx4 v[144:147], v237, s[16:19], s60 offen offset:0
  v_mfma_f32_16x16x32_bf16 v[16:19], a[192:195], v[224:227], v[16:19]
  v_perm_b32 v228, v166, v162, s59
  v_perm_b32 v229, v174, v170, s59
  v_mfma_f32_16x16x32_bf16 v[48:51], a[196:199], v[224:227], v[48:51]
  v_perm_b32 v230, v182, v178, s59
  ds_read_b128 a[160:163], v245 offset:28672
  v_mfma_f32_16x16x32_bf16 v[80:83], a[200:203], v[224:227], v[80:83]
  v_perm_b32 v231, v190, v186, s59
  ds_read_b128 a[164:167], v245 offset:29696
  v_mfma_f32_16x16x32_bf16 v[112:115], a[204:207], v[224:227], v[112:115]
  buffer_load_dwordx4 v[148:151], v237, s[16:19], s60 offen offset:1024
  v_mfma_f32_16x16x32_bf16 v[20:23], a[192:195], v[228:231], v[20:23]
  v_perm_b32 v224, v167, v163, s58
  v_perm_b32 v225, v175, v171, s58
  v_mfma_f32_16x16x32_bf16 v[52:55], a[196:199], v[228:231], v[52:55]
  v_perm_b32 v226, v183, v179, s58
  ds_read_b128 a[168:171], v245 offset:30720
  v_mfma_f32_16x16x32_bf16 v[84:87], a[200:203], v[228:231], v[84:87]
  v_perm_b32 v227, v191, v187, s58
  ds_read_b128 a[172:175], v245 offset:31744
  v_mfma_f32_16x16x32_bf16 v[116:119], a[204:207], v[228:231], v[116:119]
  buffer_load_dwordx4 v[152:155], v237, s[16:19], s60 offen offset:2048
  v_mfma_f32_16x16x32_bf16 v[24:27], a[192:195], v[224:227], v[24:27]
  v_perm_b32 v228, v167, v163, s59
  v_perm_b32 v229, v175, v171, s59
  v_mfma_f32_16x16x32_bf16 v[56:59], a[196:199], v[224:227], v[56:59]
  v_perm_b32 v230, v183, v179, s59
  v_mfma_f32_16x16x32_bf16 v[88:91], a[200:203], v[224:227], v[88:91]
  v_perm_b32 v231, v191, v187, s59
  v_mfma_f32_16x16x32_bf16 v[120:123], a[204:207], v[224:227], v[120:123]
  buffer_load_dwordx4 v[156:159], v237, s[16:19], s60 offen offset:3072
  s_add_u32 s60, s60, 32768
  v_mfma_f32_16x16x32_bf16 v[28:31], a[192:195], v[228:231], v[28:31]
  s_waitcnt vmcnt(12)
  v_perm_b32 v224, v196, v192, s58
  v_perm_b32 v225, v204, v200, s58
  v_mfma_f32_16x16x32_bf16 v[60:63], a[196:199], v[228:231], v[60:63]
  s_waitcnt vmcnt(8)
  v_perm_b32 v226, v212, v208, s58
  v_mfma_f32_16x16x32_bf16 v[92:95], a[200:203], v[228:231], v[92:95]
  v_perm_b32 v227, v220, v216, s58
  v_perm_b32 v232, v196, v192, s59
  v_perm_b32 v233, v204, v200, s59
  v_mfma_f32_16x16x32_bf16 v[124:127], a[204:207], v[228:231], v[124:127]
  v_perm_b32 v234, v212, v208, s59
  v_perm_b32 v235, v220, v216, s59
  buffer_load_dwordx4 v[160:163], v236, s[16:19], s60 offen offset:0
  s_waitcnt lgkmcnt(0)
  v_mfma_f32_16x16x32_bf16 v[0:3], a[128:131], v[224:227], v[0:3]
  v_perm_b32 v228, v197, v193, s58
  v_perm_b32 v229, v205, v201, s58
  v_mfma_f32_16x16x32_bf16 v[32:35], a[132:135], v[224:227], v[32:35]
  v_perm_b32 v230, v213, v209, s58
  v_perm_b32 v231, v221, v217, s58
  buffer_load_dwordx4 v[164:167], v236, s[16:19], s60 offen offset:1024
  v_mfma_f32_16x16x32_bf16 v[4:7], a[128:131], v[232:235], v[4:7]
  v_perm_b32 v224, v197, v193, s59
  v_perm_b32 v225, v205, v201, s59
  v_mfma_f32_16x16x32_bf16 v[36:39], a[132:135], v[232:235], v[36:39]
  v_perm_b32 v226, v213, v209, s59
  v_perm_b32 v227, v221, v217, s59
  buffer_load_dwordx4 v[168:171], v236, s[16:19], s60 offen offset:2048
  v_mfma_f32_16x16x32_bf16 v[8:11], a[128:131], v[228:231], v[8:11]
  v_perm_b32 v232, v198, v194, s58
  v_perm_b32 v233, v206, v202, s58
  v_mfma_f32_16x16x32_bf16 v[40:43], a[132:135], v[228:231], v[40:43]
  v_perm_b32 v234, v214, v210, s58
  v_perm_b32 v235, v222, v218, s58
  buffer_load_dwordx4 v[172:175], v236, s[16:19], s60 offen offset:3072
  v_mfma_f32_16x16x32_bf16 v[12:15], a[128:131], v[224:227], v[12:15]
  v_perm_b32 v228, v198, v194, s59
  v_perm_b32 v229, v206, v202, s59
  v_mfma_f32_16x16x32_bf16 v[44:47], a[132:135], v[224:227], v[44:47]
  v_perm_b32 v230, v214, v210, s59
  v_perm_b32 v231, v222, v218, s59
  buffer_load_dwordx4 v[176:179], v237, s[16:19], s60 offen offset:0
  v_mfma_f32_16x16x32_bf16 v[16:19], a[128:131], v[232:235], v[16:19]
  v_perm_b32 v224, v199, v195, s58
  v_perm_b32 v225, v207, v203, s58
  v_mfma_f32_16x16x32_bf16 v[48:51], a[132:135], v[232:235], v[48:51]
  v_perm_b32 v226, v215, v211, s58
  v_perm_b32 v227, v223, v219, s58
  buffer_load_dwordx4 v[180:183], v237, s[16:19], s60 offen offset:1024
  v_mfma_f32_16x16x32_bf16 v[20:23], a[128:131], v[228:231], v[20:23]
  v_perm_b32 v232, v199, v195, s59
  v_perm_b32 v233, v207, v203, s59
  v_mfma_f32_16x16x32_bf16 v[52:55], a[132:135], v[228:231], v[52:55]
  v_perm_b32 v234, v215, v211, s59
  v_perm_b32 v235, v223, v219, s59
  buffer_load_dwordx4 v[184:187], v237, s[16:19], s60 offen offset:2048
  v_mfma_f32_16x16x32_bf16 v[24:27], a[128:131], v[224:227], v[24:27]
  s_waitcnt vmcnt(7)
  v_perm_b32 v228, v132, v128, s58
  v_perm_b32 v229, v140, v136, s58
  v_mfma_f32_16x16x32_bf16 v[56:59], a[132:135], v[224:227], v[56:59]
  v_perm_b32 v230, v148, v144, s58
  v_perm_b32 v231, v156, v152, s58
  buffer_load_dwordx4 v[188:191], v237, s[16:19], s60 offen offset:3072
  v_mfma_f32_16x16x32_bf16 v[28:31], a[128:131], v[232:235], v[28:31]
  v_perm_b32 v224, v132, v128, s59
  v_perm_b32 v225, v140, v136, s59
  v_mfma_f32_16x16x32_bf16 v[60:63], a[132:135], v[232:235], v[60:63]
  v_perm_b32 v226, v148, v144, s59
  v_perm_b32 v227, v156, v152, s59
  s_lshl_b32 s6, s4, 6
  s_lshl_b32 s7, s3, 3
  s_add_u32 s6, s6, s7
  v_mfma_f32_16x16x32_bf16 v[0:3], a[144:147], v[228:231], v[0:3]
  v_perm_b32 v232, v133, v129, s58
  v_perm_b32 v233, v141, v137, s58
  v_mfma_f32_16x16x32_bf16 v[32:35], a[148:151], v[228:231], v[32:35]
  v_perm_b32 v234, v149, v145, s58
  v_perm_b32 v235, v157, v153, s58
  v_mfma_f32_16x16x32_bf16 v[4:7], a[144:147], v[224:227], v[4:7]
  v_perm_b32 v228, v133, v129, s59
  v_perm_b32 v229, v141, v137, s59
  v_mfma_f32_16x16x32_bf16 v[36:39], a[148:151], v[224:227], v[36:39]
  v_perm_b32 v230, v149, v145, s59
  v_perm_b32 v231, v157, v153, s59
  s_lshl_b32 s7, s5, 1
  s_add_u32 s64, s6, s7
  v_mfma_f32_16x16x32_bf16 v[8:11], a[144:147], v[232:235], v[8:11]
  v_perm_b32 v224, v134, v130, s58
  v_perm_b32 v225, v142, v138, s58
  v_mfma_f32_16x16x32_bf16 v[40:43], a[148:151], v[232:235], v[40:43]
  v_perm_b32 v226, v150, v146, s58
  v_perm_b32 v227, v158, v154, s58
  v_mfma_f32_16x16x32_bf16 v[12:15], a[144:147], v[228:231], v[12:15]
  v_perm_b32 v232, v134, v130, s59
  v_perm_b32 v233, v142, v138, s59
  v_mfma_f32_16x16x32_bf16 v[44:47], a[148:151], v[228:231], v[44:47]
  v_perm_b32 v234, v150, v146, s59
  v_perm_b32 v235, v158, v154, s59
  s_lshl_b32 s61, s64, 10
  v_lshlrev_b32 v254, 4, v255
  v_mfma_f32_16x16x32_bf16 v[16:19], a[144:147], v[224:227], v[16:19]
  v_perm_b32 v228, v135, v131, s58
  v_perm_b32 v229, v143, v139, s58
  v_mfma_f32_16x16x32_bf16 v[48:51], a[148:151], v[224:227], v[48:51]
  v_perm_b32 v230, v151, v147, s58
  v_perm_b32 v231, v159, v155, s58
  v_mfma_f32_16x16x32_bf16 v[20:23], a[144:147], v[232:235], v[20:23]
  v_perm_b32 v224, v135, v131, s59
  v_perm_b32 v225, v143, v139, s59
  v_mfma_f32_16x16x32_bf16 v[52:55], a[148:151], v[232:235], v[52:55]
  v_perm_b32 v226, v151, v147, s59
  v_perm_b32 v227, v159, v155, s59
  buffer_load_dwordx4 a[0:3], v254, s[8:11], s61 offen
  v_mfma_f32_16x16x32_bf16 v[24:27], a[144:147], v[228:231], v[24:27]
  s_waitcnt vmcnt(1)
  v_perm_b32 v232, v164, v160, s58
  v_perm_b32 v233, v172, v168, s58
  v_mfma_f32_16x16x32_bf16 v[56:59], a[148:151], v[228:231], v[56:59]
  v_perm_b32 v234, v180, v176, s58
  v_perm_b32 v235, v188, v184, s58
  v_mfma_f32_16x16x32_bf16 v[28:31], a[144:147], v[224:227], v[28:31]
  v_perm_b32 v228, v164, v160, s59
  v_perm_b32 v229, v172, v168, s59
  v_mfma_f32_16x16x32_bf16 v[60:63], a[148:151], v[224:227], v[60:63]
  v_perm_b32 v230, v180, v176, s59
  v_perm_b32 v231, v188, v184, s59
  buffer_load_dwordx4 a[4:7], v254, s[8:11], s61 offen offset:1024
  v_mfma_f32_16x16x32_bf16 v[0:3], a[160:163], v[232:235], v[0:3]
  v_perm_b32 v224, v165, v161, s58
  v_perm_b32 v225, v173, v169, s58
  v_mfma_f32_16x16x32_bf16 v[32:35], a[164:167], v[232:235], v[32:35]
  v_perm_b32 v226, v181, v177, s58
  v_perm_b32 v227, v189, v185, s58
  v_mfma_f32_16x16x32_bf16 v[4:7], a[160:163], v[228:231], v[4:7]
  v_perm_b32 v232, v165, v161, s59
  v_perm_b32 v233, v173, v169, s59
  v_mfma_f32_16x16x32_bf16 v[36:39], a[164:167], v[228:231], v[36:39]
  v_perm_b32 v234, v181, v177, s59
  v_perm_b32 v235, v189, v185, s59
  s_lshl_b32 s6, s64, 3
  s_add_u32 s6, s6, 16777216
  v_mov_b32 v254, 0
  v_mfma_f32_16x16x32_bf16 v[8:11], a[160:163], v[224:227], v[8:11]
  v_perm_b32 v228, v166, v162, s58
  v_perm_b32 v229, v174, v170, s58
  v_mfma_f32_16x16x32_bf16 v[40:43], a[164:167], v[224:227], v[40:43]
  v_perm_b32 v230, v182, v178, s58
  v_perm_b32 v231, v190, v186, s58
  v_mfma_f32_16x16x32_bf16 v[12:15], a[160:163], v[232:235], v[12:15]
  v_perm_b32 v224, v166, v162, s59
  v_perm_b32 v225, v174, v170, s59
  v_mfma_f32_16x16x32_bf16 v[44:47], a[164:167], v[232:235], v[44:47]
  v_perm_b32 v226, v182, v178, s59
  v_perm_b32 v227, v190, v186, s59
  buffer_load_dwordx4 a[8:11], v254, s[28:31], s6 offen sc1
  v_mfma_f32_16x16x32_bf16 v[16:19], a[160:163], v[228:231], v[16:19]
  v_perm_b32 v232, v167, v163, s58
  v_perm_b32 v233, v175, v171, s58
  v_mfma_f32_16x16x32_bf16 v[48:51], a[164:167], v[228:231], v[48:51]
  v_perm_b32 v234, v183, v179, s58
  v_perm_b32 v235, v191, v187, s58
  v_mfma_f32_16x16x32_bf16 v[20:23], a[160:163], v[224:227], v[20:23]
  v_perm_b32 v228, v167, v163, s59
  v_perm_b32 v229, v175, v171, s59
  v_mfma_f32_16x16x32_bf16 v[52:55], a[164:167], v[224:227], v[52:55]
  v_perm_b32 v230, v183, v179, s59
  v_perm_b32 v231, v191, v187, s59
  v_mfma_f32_16x16x32_bf16 v[24:27], a[160:163], v[232:235], v[24:27]
  v_perm_b32 v224, v196, v192, s58
  v_perm_b32 v225, v204, v200, s58
  v_mfma_f32_16x16x32_bf16 v[56:59], a[164:167], v[232:235], v[56:59]
  v_perm_b32 v226, v212, v208, s58
  v_perm_b32 v227, v220, v216, s58
  v_mfma_f32_16x16x32_bf16 v[28:31], a[160:163], v[228:231], v[28:31]
  v_perm_b32 v232, v196, v192, s59
  v_perm_b32 v233, v204, v200, s59
  v_mfma_f32_16x16x32_bf16 v[60:63], a[164:167], v[228:231], v[60:63]
  v_perm_b32 v234, v212, v208, s59
  v_perm_b32 v235, v220, v216, s59
  v_mfma_f32_16x16x32_bf16 v[64:67], a[136:139], v[224:227], v[64:67]
  v_perm_b32 v228, v197, v193, s58
  v_perm_b32 v229, v205, v201, s58
  v_mfma_f32_16x16x32_bf16 v[96:99], a[140:143], v[224:227], v[96:99]
  v_perm_b32 v230, v213, v209, s58
  v_perm_b32 v231, v221, v217, s58
  v_mfma_f32_16x16x32_bf16 v[68:71], a[136:139], v[232:235], v[68:71]
  v_perm_b32 v224, v197, v193, s59
  v_perm_b32 v225, v205, v201, s59
  v_mfma_f32_16x16x32_bf16 v[100:103], a[140:143], v[232:235], v[100:103]
  v_perm_b32 v226, v213, v209, s59
  v_perm_b32 v227, v221, v217, s59
  v_mfma_f32_16x16x32_bf16 v[72:75], a[136:139], v[228:231], v[72:75]
  v_perm_b32 v232, v198, v194, s58
  v_perm_b32 v233, v206, v202, s58
  v_cvt_pk_bf16_f32 v246, v0, v4
  v_cvt_pk_bf16_f32 v247, v8, v12
  v_mfma_f32_16x16x32_bf16 v[104:107], a[140:143], v[228:231], v[104:107]
  v_perm_b32 v234, v214, v210, s58
  v_perm_b32 v235, v222, v218, s58
  v_cvt_pk_bf16_f32 v248, v16, v20
  v_cvt_pk_bf16_f32 v249, v24, v28
  s_cmp_eq_u32 s66, 0
  s_cbranch_scc0 L_nw00
  ds_write_b128 v242, v[246:249] offset:0
  L_nw00:
  buffer_store_dwordx4 v[246:249], v238, s[28:31], s69 offen offset:0 sc1
  v_mfma_f32_16x16x32_bf16 v[76:79], a[136:139], v[224:227], v[76:79]
  v_perm_b32 v228, v198, v194, s59
  v_perm_b32 v229, v206, v202, s59
  v_mfma_f32_16x16x32_bf16 v[108:111], a[140:143], v[224:227], v[108:111]
  v_perm_b32 v230, v214, v210, s59
  v_perm_b32 v231, v222, v218, s59
  v_mfma_f32_16x16x32_bf16 v[80:83], a[136:139], v[232:235], v[80:83]
  v_perm_b32 v224, v199, v195, s58
  v_perm_b32 v225, v207, v203, s58
  v_mfma_f32_16x16x32_bf16 v[112:115], a[140:143], v[232:235], v[112:115]
  v_perm_b32 v226, v215, v211, s58
  v_perm_b32 v227, v223, v219, s58
  v_mfma_f32_16x16x32_bf16 v[84:87], a[136:139], v[228:231], v[84:87]
  v_perm_b32 v232, v199, v195, s59
  v_perm_b32 v233, v207, v203, s59
  v_cvt_pk_bf16_f32 v250, v1, v5
  v_cvt_pk_bf16_f32 v251, v9, v13
  v_mfma_f32_16x16x32_bf16 v[116:119], a[140:143], v[228:231], v[116:119]
  v_perm_b32 v234, v215, v211, s59
  v_perm_b32 v235, v223, v219, s59
  v_cvt_pk_bf16_f32 v252, v17, v21
  v_cvt_pk_bf16_f32 v253, v25, v29
  s_cmp_eq_u32 s66, 0
  s_cbranch_scc0 L_nw01
  ds_write_b128 v242, v[250:253] offset:1024
  L_nw01:
  buffer_store_dwordx4 v[250:253], v238, s[28:31], s69 offen offset:1024 sc1
  v_mfma_f32_16x16x32_bf16 v[88:91], a[136:139], v[224:227], v[88:91]
  v_perm_b32 v228, v132, v128, s58
  v_perm_b32 v229, v140, v136, s58
  v_mfma_f32_16x16x32_bf16 v[120:123], a[140:143], v[224:227], v[120:123]
  v_perm_b32 v230, v148, v144, s58
  v_perm_b32 v231, v156, v152, s58
  v_mfma_f32_16x16x32_bf16 v[92:95], a[136:139], v[232:235], v[92:95]
  v_perm_b32 v224, v132, v128, s59
  v_perm_b32 v225, v140, v136, s59
  v_mfma_f32_16x16x32_bf16 v[124:127], a[140:143], v[232:235], v[124:127]
  v_perm_b32 v226, v148, v144, s59
  v_perm_b32 v227, v156, v152, s59
  v_mfma_f32_16x16x32_bf16 v[64:67], a[152:155], v[228:231], v[64:67]
  v_perm_b32 v232, v133, v129, s58
  v_perm_b32 v233, v141, v137, s58
  v_cvt_pk_bf16_f32 v246, v2, v6
  v_cvt_pk_bf16_f32 v247, v10, v14
  v_mfma_f32_16x16x32_bf16 v[96:99], a[156:159], v[228:231], v[96:99]
  v_perm_b32 v234, v149, v145, s58
  v_perm_b32 v235, v157, v153, s58
  v_cvt_pk_bf16_f32 v248, v18, v22
  v_cvt_pk_bf16_f32 v249, v26, v30
  s_cmp_eq_u32 s66, 0
  s_cbranch_scc0 L_nw02
  ds_write_b128 v242, v[246:249] offset:2048
  L_nw02:
  buffer_store_dwordx4 v[246:249], v238, s[28:31], s69 offen offset:2048 sc1
  v_mfma_f32_16x16x32_bf16 v[68:71], a[152:155], v[224:227], v[68:71]
  v_perm_b32 v228, v133, v129, s59
  v_perm_b32 v229, v141, v137, s59
  v_mfma_f32_16x16x32_bf16 v[100:103], a[156:159], v[224:227], v[100:103]
  v_perm_b32 v230, v149, v145, s59
  v_perm_b32 v231, v157, v153, s59
  v_mfma_f32_16x16x32_bf16 v[72:75], a[152:155], v[232:235], v[72:75]
  v_perm_b32 v224, v134, v130, s58
  v_perm_b32 v225, v142, v138, s58
  v_mfma_f32_16x16x32_bf16 v[104:107], a[156:159], v[232:235], v[104:107]
  v_perm_b32 v226, v150, v146, s58
  v_perm_b32 v227, v158, v154, s58
  v_mfma_f32_16x16x32_bf16 v[76:79], a[152:155], v[228:231], v[76:79]
  v_perm_b32 v232, v134, v130, s59
  v_perm_b32 v233, v142, v138, s59
  v_cvt_pk_bf16_f32 v250, v3, v7
  v_cvt_pk_bf16_f32 v251, v11, v15
  v_mfma_f32_16x16x32_bf16 v[108:111], a[156:159], v[228:231], v[108:111]
  v_perm_b32 v234, v150, v146, s59
  v_perm_b32 v235, v158, v154, s59
  v_cvt_pk_bf16_f32 v252, v19, v23
  v_cvt_pk_bf16_f32 v253, v27, v31
  s_cmp_eq_u32 s66, 0
  s_cbranch_scc0 L_nw03
  ds_write_b128 v242, v[250:253] offset:3072
  L_nw03:
  buffer_store_dwordx4 v[250:253], v238, s[28:31], s69 offen offset:3072 sc1
  v_mfma_f32_16x16x32_bf16 v[80:83], a[152:155], v[224:227], v[80:83]
  v_perm_b32 v228, v135, v131, s58
  v_perm_b32 v229, v143, v139, s58
  v_mfma_f32_16x16x32_bf16 v[112:115], a[156:159], v[224:227], v[112:115]
  v_perm_b32 v230, v151, v147, s58
  v_perm_b32 v231, v159, v155, s58
  v_mfma_f32_16x16x32_bf16 v[84:87], a[152:155], v[232:235], v[84:87]
  v_perm_b32 v224, v135, v131, s59
  v_perm_b32 v225, v143, v139, s59
  v_mfma_f32_16x16x32_bf16 v[116:119], a[156:159], v[232:235], v[116:119]
  v_perm_b32 v226, v151, v147, s59
  v_perm_b32 v227, v159, v155, s59
  v_mfma_f32_16x16x32_bf16 v[88:91], a[152:155], v[228:231], v[88:91]
  v_perm_b32 v232, v164, v160, s58
  v_perm_b32 v233, v172, v168, s58
  v_cvt_pk_bf16_f32 v246, v32, v36
  v_cvt_pk_bf16_f32 v247, v40, v44
  v_mfma_f32_16x16x32_bf16 v[120:123], a[156:159], v[228:231], v[120:123]
  v_perm_b32 v234, v180, v176, s58
  v_perm_b32 v235, v188, v184, s58
  v_cvt_pk_bf16_f32 v248, v48, v52
  v_cvt_pk_bf16_f32 v249, v56, v60
  s_cmp_eq_u32 s66, 1
  s_cbranch_scc0 L_nw10
  ds_write_b128 v242, v[246:249] offset:0
  L_nw10:
  buffer_store_dwordx4 v[246:249], v239, s[28:31], s69 offen offset:0 sc1
  v_mfma_f32_16x16x32_bf16 v[92:95], a[152:155], v[224:227], v[92:95]
  v_perm_b32 v228, v164, v160, s59
  v_perm_b32 v229, v172, v168, s59
  v_mfma_f32_16x16x32_bf16 v[124:127], a[156:159], v[224:227], v[124:127]
  v_perm_b32 v230, v180, v176, s59
  v_perm_b32 v231, v188, v184, s59
  v_mfma_f32_16x16x32_bf16 v[64:67], a[168:171], v[232:235], v[64:67]
  v_perm_b32 v224, v165, v161, s58
  v_perm_b32 v225, v173, v169, s58
  v_mfma_f32_16x16x32_bf16 v[96:99], a[172:175], v[232:235], v[96:99]
  v_perm_b32 v226, v181, v177, s58
  v_perm_b32 v227, v189, v185, s58
  v_mfma_f32_16x16x32_bf16 v[68:71], a[168:171], v[228:231], v[68:71]
  v_perm_b32 v232, v165, v161, s59
  v_perm_b32 v233, v173, v169, s59
  v_cvt_pk_bf16_f32 v250, v33, v37
  v_cvt_pk_bf16_f32 v251, v41, v45
  v_mfma_f32_16x16x32_bf16 v[100:103], a[172:175], v[228:231], v[100:103]
  v_perm_b32 v234, v181, v177, s59
  v_perm_b32 v235, v189, v185, s59
  v_cvt_pk_bf16_f32 v252, v49, v53
  v_cvt_pk_bf16_f32 v253, v57, v61
  s_cmp_eq_u32 s66, 1
  s_cbranch_scc0 L_nw11
  ds_write_b128 v242, v[250:253] offset:1024
  L_nw11:
  buffer_store_dwordx4 v[250:253], v239, s[28:31], s69 offen offset:1024 sc1
  v_mfma_f32_16x16x32_bf16 v[72:75], a[168:171], v[224:227], v[72:75]
  v_perm_b32 v228, v166, v162, s58
  v_perm_b32 v229, v174, v170, s58
  v_mfma_f32_16x16x32_bf16 v[104:107], a[172:175], v[224:227], v[104:107]
  v_perm_b32 v230, v182, v178, s58
  v_perm_b32 v231, v190, v186, s58
  v_mfma_f32_16x16x32_bf16 v[76:79], a[168:171], v[232:235], v[76:79]
  v_perm_b32 v224, v166, v162, s59
  v_perm_b32 v225, v174, v170, s59
  v_mfma_f32_16x16x32_bf16 v[108:111], a[172:175], v[232:235], v[108:111]
  v_perm_b32 v226, v182, v178, s59
  v_perm_b32 v227, v190, v186, s59
  v_mfma_f32_16x16x32_bf16 v[80:83], a[168:171], v[228:231], v[80:83]
  v_perm_b32 v232, v167, v163, s58
  v_perm_b32 v233, v175, v171, s58
  v_cvt_pk_bf16_f32 v246, v34, v38
  v_cvt_pk_bf16_f32 v247, v42, v46
  v_mfma_f32_16x16x32_bf16 v[112:115], a[172:175], v[228:231], v[112:115]
  v_perm_b32 v234, v183, v179, s58
  v_perm_b32 v235, v191, v187, s58
  v_cvt_pk_bf16_f32 v248, v50, v54
  v_cvt_pk_bf16_f32 v249, v58, v62
  s_cmp_eq_u32 s66, 1
  s_cbranch_scc0 L_nw12
  ds_write_b128 v242, v[246:249] offset:2048
  L_nw12:
  buffer_store_dwordx4 v[246:249], v239, s[28:31], s69 offen offset:2048 sc1
  v_mfma_f32_16x16x32_bf16 v[84:87], a[168:171], v[224:227], v[84:87]
  v_perm_b32 v228, v167, v163, s59
  v_perm_b32 v229, v175, v171, s59
  v_mfma_f32_16x16x32_bf16 v[116:119], a[172:175], v[224:227], v[116:119]
  v_perm_b32 v230, v183, v179, s59
  v_perm_b32 v231, v191, v187, s59
  v_mfma_f32_16x16x32_bf16 v[88:91], a[168:171], v[232:235], v[88:91]
  v_mfma_f32_16x16x32_bf16 v[120:123], a[172:175], v[232:235], v[120:123]
  v_mfma_f32_16x16x32_bf16 v[92:95], a[168:171], v[228:231], v[92:95]
  v_cvt_pk_bf16_f32 v250, v35, v39
  v_cvt_pk_bf16_f32 v251, v43, v47
  v_mfma_f32_16x16x32_bf16 v[124:127], a[172:175], v[228:231], v[124:127]
  v_cvt_pk_bf16_f32 v252, v51, v55
  v_cvt_pk_bf16_f32 v253, v59, v63
  s_cmp_eq_u32 s66, 1
  s_cbranch_scc0 L_nw13
  ds_write_b128 v242, v[250:253] offset:3072
  L_nw13:
  buffer_store_dwordx4 v[250:253], v239, s[28:31], s69 offen offset:3072 sc1
  s_nop 3
  v_cvt_pk_bf16_f32 v128, v64, v68
  v_cvt_pk_bf16_f32 v129, v72, v76
  v_cvt_pk_bf16_f32 v130, v80, v84
  v_cvt_pk_bf16_f32 v131, v88, v92
  s_cmp_eq_u32 s66, 2
  s_cbranch_scc0 L_nw20
  ds_write_b128 v242, v[128:131] offset:0
  L_nw20:
  buffer_store_dwordx4 v[128:131], v240, s[28:31], s69 offen offset:0 sc1
  v_cvt_pk_bf16_f32 v132, v65, v69
  v_cvt_pk_bf16_f32 v133, v73, v77
  v_cvt_pk_bf16_f32 v134, v81, v85
  v_cvt_pk_bf16_f32 v135, v89, v93
  s_cmp_eq_u32 s66, 2
  s_cbranch_scc0 L_nw21
  ds_write_b128 v242, v[132:135] offset:1024
  L_nw21:
  buffer_store_dwordx4 v[132:135], v240, s[28:31], s69 offen offset:1024 sc1
  v_cvt_pk_bf16_f32 v136, v66, v70
  v_cvt_pk_bf16_f32 v137, v74, v78
  v_cvt_pk_bf16_f32 v138, v82, v86
  v_cvt_pk_bf16_f32 v139, v90, v94
  s_cmp_eq_u32 s66, 2
  s_cbranch_scc0 L_nw22
  ds_write_b128 v242, v[136:139] offset:2048
  L_nw22:
  buffer_store_dwordx4 v[136:139], v240, s[28:31], s69 offen offset:2048 sc1
  v_cvt_pk_bf16_f32 v140, v67, v71
  v_cvt_pk_bf16_f32 v141, v75, v79
  v_cvt_pk_bf16_f32 v142, v83, v87
  v_cvt_pk_bf16_f32 v143, v91, v95
  s_cmp_eq_u32 s66, 2
  s_cbranch_scc0 L_nw23
  ds_write_b128 v242, v[140:143] offset:3072
  L_nw23:
  buffer_store_dwordx4 v[140:143], v240, s[28:31], s69 offen offset:3072 sc1
  v_cvt_pk_bf16_f32 v144, v96, v100
  v_cvt_pk_bf16_f32 v145, v104, v108
  v_cvt_pk_bf16_f32 v146, v112, v116
  v_cvt_pk_bf16_f32 v147, v120, v124
  s_cmp_eq_u32 s66, 3
  s_cbranch_scc0 L_nw30
  ds_write_b128 v242, v[144:147] offset:0
  L_nw30:
  buffer_store_dwordx4 v[144:147], v241, s[28:31], s69 offen offset:0 sc1
  v_cvt_pk_bf16_f32 v148, v97, v101
  v_cvt_pk_bf16_f32 v149, v105, v109
  v_cvt_pk_bf16_f32 v150, v113, v117
  v_cvt_pk_bf16_f32 v151, v121, v125
  s_cmp_eq_u32 s66, 3
  s_cbranch_scc0 L_nw31
  ds_write_b128 v242, v[148:151] offset:1024
  L_nw31:
  buffer_store_dwordx4 v[148:151], v241, s[28:31], s69 offen offset:1024 sc1
  v_cvt_pk_bf16_f32 v152, v98, v102
  v_cvt_pk_bf16_f32 v153, v106, v110
  v_cvt_pk_bf16_f32 v154, v114, v118
  v_cvt_pk_bf16_f32 v155, v122, v126
  s_cmp_eq_u32 s66, 3
  s_cbranch_scc0 L_nw32
  ds_write_b128 v242, v[152:155] offset:2048
  L_nw32:
  buffer_store_dwordx4 v[152:155], v241, s[28:31], s69 offen offset:2048 sc1
  v_cvt_pk_bf16_f32 v156, v99, v103
  v_cvt_pk_bf16_f32 v157, v107, v111
  v_cvt_pk_bf16_f32 v158, v115, v119
  v_cvt_pk_bf16_f32 v159, v123, v127
  s_cmp_eq_u32 s66, 3
  s_cbranch_scc0 L_nw33
  ds_write_b128 v242, v[156:159] offset:3072
  L_nw33:
  buffer_store_dwordx4 v[156:159], v241, s[28:31], s69 offen offset:3072 sc1
  s_waitcnt vmcnt(16)
  v_accvgpr_read_b32 v192, a0
  v_accvgpr_read_b32 v193, a1
  v_accvgpr_read_b32 v194, a2
  v_accvgpr_read_b32 v195, a3
  v_accvgpr_read_b32 v196, a4
  v_accvgpr_read_b32 v197, a5
  v_accvgpr_read_b32 v198, a6
  v_accvgpr_read_b32 v199, a7
  v_accvgpr_read_b32 v200, a8
  v_accvgpr_read_b32 v201, a9
  v_accvgpr_read_b32 v202, a10
  v_accvgpr_read_b32 v203, a11
  s_lshl_b32 s99, s4, 8
  s_add_u32 s99, s99, 16809984
  v_and_b32 v252, 31, v255
  v_lshlrev_b32 v252, 2, v252
  buffer_load_dword v254, v252, s[28:31], s99 offen sc1
  s_mov_b32 s40, s52
  s_and_b32 s41, s53, 0xffff
  s_mov_b32 s42, 2097152
  s_mov_b32 s43, 0x20000
  v_lshlrev_b32 v250, 4, v255
  v_cmp_eq_u32 vcc, 0, v255
  v_mov_b32 v239, 268435456
  s_lshl_b32 s7, s3, 2
  s_add_u32 s7, s7, s5
  s_lshl_b32 s7, s7, 2
  s_add_u32 s7, s7, s99
  v_cndmask_b32 v239, v239, 0, vcc
  v_mov_b32 v253, 1
  s_sub_u32 s67, s67, s64
  s_lshl_b32 s62, s3, 2
  s_lshl_b32 s62, 1, s62
  s_mov_b32 s69, s61
  s_mov_b32 s61, s62
  s_lshl_b32 s6, s5, 11
  s_add_u32 s6, s6, 131072
  v_add_u32 v240, s6, v250
  s_waitcnt lgkmcnt(0)
  s_barrier
  s_cmp_eq_u32 s3, 0
  s_cbranch_scc0 L_own0
  ds_read_b128 v[0:3], v240
  ds_read_b128 v[32:35], v240 offset:1024
  L_own0:
  s_cmp_eq_u32 s3, 1
  s_cbranch_scc0 L_own1
  ds_read_b128 v[4:7], v240
  ds_read_b128 v[36:39], v240 offset:1024
  L_own1:
  s_cmp_eq_u32 s3, 2
  s_cbranch_scc0 L_own2
  ds_read_b128 v[8:11], v240
  ds_read_b128 v[40:43], v240 offset:1024
  L_own2:
  s_cmp_eq_u32 s3, 3
  s_cbranch_scc0 L_own3
  ds_read_b128 v[12:15], v240
  ds_read_b128 v[44:47], v240 offset:1024
  L_own3:
  s_cmp_eq_u32 s3, 4
  s_cbranch_scc0 L_own4
  ds_read_b128 v[16:19], v240
  ds_read_b128 v[48:51], v240 offset:1024
  L_own4:
  s_cmp_eq_u32 s3, 5
  s_cbranch_scc0 L_own5
  ds_read_b128 v[20:23], v240
  ds_read_b128 v[52:55], v240 offset:1024
  L_own5:
  s_cmp_eq_u32 s3, 6
  s_cbranch_scc0 L_own6
  ds_read_b128 v[24:27], v240
  ds_read_b128 v[56:59], v240 offset:1024
  L_own6:
  s_cmp_eq_u32 s3, 7
  s_cbranch_scc0 L_own7
  ds_read_b128 v[28:31], v240
  ds_read_b128 v[60:63], v240 offset:1024
  L_own7:
  s_waitcnt vmcnt(0)
  v_mov_b32 v251, v254
  buffer_store_dword v253, v239, s[28:31], s7 offen sc1
  s_waitcnt lgkmcnt(0)
  s_cmp_lt_u32 s67, 2
  s_cbranch_scc1 L1_selrow
  v_cmp_ne_u32 vcc, 0, v251
  s_movk_i32 s62, 2
  s_nop 3
  s_lshr_b32 s6, vcc_lo, 1
  s_and_b32 s6, s6, vcc_lo
  s_lshr_b32 s7, s6, 2
  s_and_b32 s6, s6, s7
  s_and_b32 s6, s6, 0x11111111
  s_andn2_b32 s6, s6, s61
  s_or_b32 s7, s6, s61
  s_cmp_eq_u32 s7, 0x11111111
  s_cselect_b32 s62, 8, s62
  s_bitcmp1_b32 s6, 0
  s_cbranch_scc0 L_noga0
  s_sub_u32 s62, s62, 1
  s_cbranch_scc1 L_gdonea
  s_add_u32 s7, s69, 0
  s_bitset1_b32 s61, 0
  buffer_load_dwordx4 v[0:3], v250, s[28:31], s7 offen sc1
  buffer_load_dwordx4 v[32:35], v250, s[28:31], s7 offen offset:1024 sc1
  L_noga0:
  s_bitcmp1_b32 s6, 4
  s_cbranch_scc0 L_noga1
  s_sub_u32 s62, s62, 1
  s_cbranch_scc1 L_gdonea
  s_add_u32 s7, s69, 2097152
  s_bitset1_b32 s61, 4
  buffer_load_dwordx4 v[4:7], v250, s[28:31], s7 offen sc1
  buffer_load_dwordx4 v[36:39], v250, s[28:31], s7 offen offset:1024 sc1
  L_noga1:
  s_bitcmp1_b32 s6, 8
  s_cbranch_scc0 L_noga2
  s_sub_u32 s62, s62, 1
  s_cbranch_scc1 L_gdonea
  s_add_u32 s7, s69, 4194304
  s_bitset1_b32 s61, 8
  buffer_load_dwordx4 v[8:11], v250, s[28:31], s7 offen sc1
  buffer_load_dwordx4 v[40:43], v250, s[28:31], s7 offen offset:1024 sc1
  L_noga2:
  s_bitcmp1_b32 s6, 12
  s_cbranch_scc0 L_noga3
  s_sub_u32 s62, s62, 1
  s_cbranch_scc1 L_gdonea
  s_add_u32 s7, s69, 6291456
  s_bitset1_b32 s61, 12
  buffer_load_dwordx4 v[12:15], v250, s[28:31], s7 offen sc1
  buffer_load_dwordx4 v[44:47], v250, s[28:31], s7 offen offset:1024 sc1
  L_noga3:
  s_bitcmp1_b32 s6, 16
  s_cbranch_scc0 L_noga4
  s_sub_u32 s62, s62, 1
  s_cbranch_scc1 L_gdonea
  s_add_u32 s7, s69, 8388608
  s_bitset1_b32 s61, 16
  buffer_load_dwordx4 v[16:19], v250, s[28:31], s7 offen sc1
  buffer_load_dwordx4 v[48:51], v250, s[28:31], s7 offen offset:1024 sc1
  L_noga4:
  s_bitcmp1_b32 s6, 20
  s_cbranch_scc0 L_noga5
  s_sub_u32 s62, s62, 1
  s_cbranch_scc1 L_gdonea
  s_add_u32 s7, s69, 10485760
  s_bitset1_b32 s61, 20
  buffer_load_dwordx4 v[20:23], v250, s[28:31], s7 offen sc1
  buffer_load_dwordx4 v[52:55], v250, s[28:31], s7 offen offset:1024 sc1
  L_noga5:
  s_bitcmp1_b32 s6, 24
  s_cbranch_scc0 L_noga6
  s_sub_u32 s62, s62, 1
  s_cbranch_scc1 L_gdonea
  s_add_u32 s7, s69, 12582912
  s_bitset1_b32 s61, 24
  buffer_load_dwordx4 v[24:27], v250, s[28:31], s7 offen sc1
  buffer_load_dwordx4 v[56:59], v250, s[28:31], s7 offen offset:1024 sc1
  L_noga6:
  s_bitcmp1_b32 s6, 28
  s_cbranch_scc0 L_noga7
  s_sub_u32 s62, s62, 1
  s_cbranch_scc1 L_gdonea
  s_add_u32 s7, s69, 14680064
  s_bitset1_b32 s61, 28
  buffer_load_dwordx4 v[28:31], v250, s[28:31], s7 offen sc1
  buffer_load_dwordx4 v[60:63], v250, s[28:31], s7 offen offset:1024 sc1
  L_noga7:
L_gdonea:
  v_mov_b32 v112, 0xbfb8aa3b
  v_mov_b32 v113, 0xbfb8aa3b
  v_mov_b32 v114, 1.0
  v_mov_b32 v115, 1.0
  v_mov_b32 v104, v201
  v_mov_b32 v105, v201
  v_mul_f32 v106, v200, v201
  v_sub_f32 v106, 0, v106
  v_mov_b32 v107, v106
  v_mov_b32 v108, v203
  v_mov_b32 v109, v203
  v_mul_f32 v110, v202, v203
  v_sub_f32 v110, 0, v110
  v_mov_b32 v111, v110
  v_lshlrev_b32 v64, 16, v192
  v_lshlrev_b32 v66, 16, v193
  v_lshlrev_b32 v68, 16, v194
  v_lshlrev_b32 v70, 16, v195
  v_and_b32 v65, s65, v192
  v_and_b32 v67, s65, v193
  v_and_b32 v69, s65, v194
  v_and_b32 v71, s65, v195
  v_pk_fma_f32 v[80:81], v[64:65], v[104:105], v[106:107]
  v_pk_fma_f32 v[82:83], v[66:67], v[104:105], v[106:107]
  v_pk_fma_f32 v[84:85], v[68:69], v[104:105], v[106:107]
  v_pk_fma_f32 v[86:87], v[70:71], v[104:105], v[106:107]
  v_pk_mul_f32 v[116:117], v[80:81], v[112:113]
  v_pk_mul_f32 v[118:119], v[82:83], v[112:113]
  v_pk_mul_f32 v[120:121], v[84:85], v[112:113]
  v_pk_mul_f32 v[122:123], v[86:87], v[112:113]
  v_exp_f32 v116, v116
  v_exp_f32 v118, v118
  v_exp_f32 v120, v120
  v_exp_f32 v122, v122
  v_exp_f32 v117, v117
  v_exp_f32 v119, v119
  v_exp_f32 v121, v121
  v_exp_f32 v123, v123
  v_pk_add_f32 v[116:117], v[116:117], v[114:115]
  v_pk_add_f32 v[118:119], v[118:119], v[114:115]
  v_pk_add_f32 v[120:121], v[120:121], v[114:115]
  v_pk_add_f32 v[122:123], v[122:123], v[114:115]
  v_rcp_f32 v116, v116
  v_rcp_f32 v118, v118
  v_rcp_f32 v120, v120
  v_rcp_f32 v122, v122
  v_rcp_f32 v117, v117
  v_rcp_f32 v119, v119
  v_rcp_f32 v121, v121
  v_rcp_f32 v123, v123
  v_pk_mul_f32 v[80:81], v[80:81], v[116:117]
  v_pk_mul_f32 v[82:83], v[82:83], v[118:119]
  v_pk_mul_f32 v[84:85], v[84:85], v[120:121]
  v_pk_mul_f32 v[86:87], v[86:87], v[122:123]
  v_lshlrev_b32 v72, 16, v196
  v_lshlrev_b32 v74, 16, v197
  v_lshlrev_b32 v76, 16, v198
  v_lshlrev_b32 v78, 16, v199
  v_and_b32 v73, s65, v196
  v_and_b32 v75, s65, v197
  v_and_b32 v77, s65, v198
  v_and_b32 v79, s65, v199
  v_pk_fma_f32 v[88:89], v[72:73], v[108:109], v[110:111]
  v_pk_fma_f32 v[90:91], v[74:75], v[108:109], v[110:111]
  v_pk_fma_f32 v[92:93], v[76:77], v[108:109], v[110:111]
  v_pk_fma_f32 v[94:95], v[78:79], v[108:109], v[110:111]
  v_pk_mul_f32 v[116:117], v[88:89], v[112:113]
  v_pk_mul_f32 v[118:119], v[90:91], v[112:113]
  v_pk_mul_f32 v[120:121], v[92:93], v[112:113]
  v_pk_mul_f32 v[122:123], v[94:95], v[112:113]
  v_exp_f32 v116, v116
  v_exp_f32 v118, v118
  v_exp_f32 v120, v120
  v_exp_f32 v122, v122
  v_exp_f32 v117, v117
  v_exp_f32 v119, v119
  v_exp_f32 v121, v121
  v_exp_f32 v123, v123
  v_pk_add_f32 v[116:117], v[116:117], v[114:115]
  v_pk_add_f32 v[118:119], v[118:119], v[114:115]
  v_pk_add_f32 v[120:121], v[120:121], v[114:115]
  v_pk_add_f32 v[122:123], v[122:123], v[114:115]
  v_rcp_f32 v116, v116
  v_rcp_f32 v118, v118
  v_rcp_f32 v120, v120
  v_rcp_f32 v122, v122
  v_rcp_f32 v117, v117
  v_rcp_f32 v119, v119
  v_rcp_f32 v121, v121
  v_rcp_f32 v123, v123
  v_pk_mul_f32 v[88:89], v[88:89], v[116:117]
  v_pk_mul_f32 v[90:91], v[90:91], v[118:119]
  v_pk_mul_f32 v[92:93], v[92:93], v[120:121]
  v_pk_mul_f32 v[94:95], v[94:95], v[122:123]
  s_mov_b32 s98, 0
  L1_flagpoll:
  s_cmp_eq_u32 s61, 0x11111111
  s_cbranch_scc1 L1_flagok
  s_add_u32 s98, s98, 1
  s_cmp_lt_u32 s98, 0x4000
  s_cbranch_scc0 L1_flagok
  buffer_load_dword v251, v252, s[28:31], s99 offen sc1
  s_waitcnt vmcnt(0)
  v_cmp_ne_u32 vcc, 0, v251
  s_movk_i32 s62, 2
  s_nop 3
  s_lshr_b32 s6, vcc_lo, 1
  s_and_b32 s6, s6, vcc_lo
  s_lshr_b32 s7, s6, 2
  s_and_b32 s6, s6, s7
  s_and_b32 s6, s6, 0x11111111
  s_andn2_b32 s6, s6, s61
  s_or_b32 s7, s6, s61
  s_cmp_eq_u32 s7, 0x11111111
  s_cselect_b32 s62, 8, s62
  s_bitcmp1_b32 s6, 0
  s_cbranch_scc0 L_nogb0
  s_sub_u32 s62, s62, 1
  s_cbranch_scc1 L_gdoneb
  s_add_u32 s7, s69, 0
  s_bitset1_b32 s61, 0
  buffer_load_dwordx4 v[0:3], v250, s[28:31], s7 offen sc1
  buffer_load_dwordx4 v[32:35], v250, s[28:31], s7 offen offset:1024 sc1
  L_nogb0:
  s_bitcmp1_b32 s6, 4
  s_cbranch_scc0 L_nogb1
  s_sub_u32 s62, s62, 1
  s_cbranch_scc1 L_gdoneb
  s_add_u32 s7, s69, 2097152
  s_bitset1_b32 s61, 4
  buffer_load_dwordx4 v[4:7], v250, s[28:31], s7 offen sc1
  buffer_load_dwordx4 v[36:39], v250, s[28:31], s7 offen offset:1024 sc1
  L_nogb1:
  s_bitcmp1_b32 s6, 8
  s_cbranch_scc0 L_nogb2
  s_sub_u32 s62, s62, 1
  s_cbranch_scc1 L_gdoneb
  s_add_u32 s7, s69, 4194304
  s_bitset1_b32 s61, 8
  buffer_load_dwordx4 v[8:11], v250, s[28:31], s7 offen sc1
  buffer_load_dwordx4 v[40:43], v250, s[28:31], s7 offen offset:1024 sc1
  L_nogb2:
  s_bitcmp1_b32 s6, 12
  s_cbranch_scc0 L_nogb3
  s_sub_u32 s62, s62, 1
  s_cbranch_scc1 L_gdoneb
  s_add_u32 s7, s69, 6291456
  s_bitset1_b32 s61, 12
  buffer_load_dwordx4 v[12:15], v250, s[28:31], s7 offen sc1
  buffer_load_dwordx4 v[44:47], v250, s[28:31], s7 offen offset:1024 sc1
  L_nogb3:
  s_bitcmp1_b32 s6, 16
  s_cbranch_scc0 L_nogb4
  s_sub_u32 s62, s62, 1
  s_cbranch_scc1 L_gdoneb
  s_add_u32 s7, s69, 8388608
  s_bitset1_b32 s61, 16
  buffer_load_dwordx4 v[16:19], v250, s[28:31], s7 offen sc1
  buffer_load_dwordx4 v[48:51], v250, s[28:31], s7 offen offset:1024 sc1
  L_nogb4:
  s_bitcmp1_b32 s6, 20
  s_cbranch_scc0 L_nogb5
  s_sub_u32 s62, s62, 1
  s_cbranch_scc1 L_gdoneb
  s_add_u32 s7, s69, 10485760
  s_bitset1_b32 s61, 20
  buffer_load_dwordx4 v[20:23], v250, s[28:31], s7 offen sc1
  buffer_load_dwordx4 v[52:55], v250, s[28:31], s7 offen offset:1024 sc1
  L_nogb5:
  s_bitcmp1_b32 s6, 24
  s_cbranch_scc0 L_nogb6
  s_sub_u32 s62, s62, 1
  s_cbranch_scc1 L_gdoneb
  s_add_u32 s7, s69, 12582912
  s_bitset1_b32 s61, 24
  buffer_load_dwordx4 v[24:27], v250, s[28:31], s7 offen sc1
  buffer_load_dwordx4 v[56:59], v250, s[28:31], s7 offen offset:1024 sc1
  L_nogb6:
  s_bitcmp1_b32 s6, 28
  s_cbranch_scc0 L_nogb7
  s_sub_u32 s62, s62, 1
  s_cbranch_scc1 L_gdoneb
  s_add_u32 s7, s69, 14680064
  s_bitset1_b32 s61, 28
  buffer_load_dwordx4 v[28:31], v250, s[28:31], s7 offen sc1
  buffer_load_dwordx4 v[60:63], v250, s[28:31], s7 offen offset:1024 sc1
  L_nogb7:
L_gdoneb:
  s_branch L1_flagpoll
  L1_flagok:
  s_waitcnt vmcnt(0)
  s_mov_b32 s6, 0x00003f80
  s_mov_b32 s7, 0x3f800000
  v_dot2_f32_bf16 v104, v0, s6, 0
  v_dot2_f32_bf16 v106, v1, s6, 0
  v_dot2_f32_bf16 v105, v0, s7, 0
  v_dot2_f32_bf16 v107, v1, s7, 0
  v_dot2_f32_bf16 v104, v4, s6, v104
  v_dot2_f32_bf16 v106, v5, s6, v106
  v_dot2_f32_bf16 v105, v4, s7, v105
  v_dot2_f32_bf16 v107, v5, s7, v107
  v_dot2_f32_bf16 v104, v8, s6, v104
  v_dot2_f32_bf16 v106, v9, s6, v106
  v_dot2_f32_bf16 v105, v8, s7, v105
  v_dot2_f32_bf16 v107, v9, s7, v107
  v_dot2_f32_bf16 v104, v12, s6, v104
  v_dot2_f32_bf16 v106, v13, s6, v106
  v_dot2_f32_bf16 v105, v12, s7, v105
  v_dot2_f32_bf16 v107, v13, s7, v107
  v_dot2_f32_bf16 v104, v16, s6, v104
  v_dot2_f32_bf16 v106, v17, s6, v106
  v_dot2_f32_bf16 v105, v16, s7, v105
  v_dot2_f32_bf16 v107, v17, s7, v107
  v_dot2_f32_bf16 v104, v20, s6, v104
  v_dot2_f32_bf16 v106, v21, s6, v106
  v_dot2_f32_bf16 v105, v20, s7, v105
  v_dot2_f32_bf16 v107, v21, s7, v107
  v_dot2_f32_bf16 v104, v24, s6, v104
  v_dot2_f32_bf16 v106, v25, s6, v106
  v_dot2_f32_bf16 v105, v24, s7, v105
  v_dot2_f32_bf16 v107, v25, s7, v107
  v_dot2_f32_bf16 v104, v28, s6, v104
  v_dot2_f32_bf16 v106, v29, s6, v106
  v_dot2_f32_bf16 v105, v28, s7, v105
  v_dot2_f32_bf16 v107, v29, s7, v107
  s_nop 1
  v_pk_fma_f32 v[104:105], v[104:105], v[80:81], v[64:65]
  v_pk_fma_f32 v[106:107], v[106:107], v[82:83], v[66:67]
  v_cvt_pk_bf16_f32 v96, v104, v105
  v_cvt_pk_bf16_f32 v97, v106, v107
  v_dot2_f32_bf16 v104, v2, s6, 0
  v_dot2_f32_bf16 v106, v3, s6, 0
  v_dot2_f32_bf16 v105, v2, s7, 0
  v_dot2_f32_bf16 v107, v3, s7, 0
  v_dot2_f32_bf16 v104, v6, s6, v104
  v_dot2_f32_bf16 v106, v7, s6, v106
  v_dot2_f32_bf16 v105, v6, s7, v105
  v_dot2_f32_bf16 v107, v7, s7, v107
  v_dot2_f32_bf16 v104, v10, s6, v104
  v_dot2_f32_bf16 v106, v11, s6, v106
  v_dot2_f32_bf16 v105, v10, s7, v105
  v_dot2_f32_bf16 v107, v11, s7, v107
  v_dot2_f32_bf16 v104, v14, s6, v104
  v_dot2_f32_bf16 v106, v15, s6, v106
  v_dot2_f32_bf16 v105, v14, s7, v105
  v_dot2_f32_bf16 v107, v15, s7, v107
  v_dot2_f32_bf16 v104, v18, s6, v104
  v_dot2_f32_bf16 v106, v19, s6, v106
  v_dot2_f32_bf16 v105, v18, s7, v105
  v_dot2_f32_bf16 v107, v19, s7, v107
  v_dot2_f32_bf16 v104, v22, s6, v104
  v_dot2_f32_bf16 v106, v23, s6, v106
  v_dot2_f32_bf16 v105, v22, s7, v105
  v_dot2_f32_bf16 v107, v23, s7, v107
  v_dot2_f32_bf16 v104, v26, s6, v104
  v_dot2_f32_bf16 v106, v27, s6, v106
  v_dot2_f32_bf16 v105, v26, s7, v105
  v_dot2_f32_bf16 v107, v27, s7, v107
  v_dot2_f32_bf16 v104, v30, s6, v104
  v_dot2_f32_bf16 v106, v31, s6, v106
  v_dot2_f32_bf16 v105, v30, s7, v105
  v_dot2_f32_bf16 v107, v31, s7, v107
  s_nop 1
  v_pk_fma_f32 v[104:105], v[104:105], v[84:85], v[68:69]
  v_pk_fma_f32 v[106:107], v[106:107], v[86:87], v[70:71]
  v_cvt_pk_bf16_f32 v98, v104, v105
  v_cvt_pk_bf16_f32 v99, v106, v107
  v_dot2_f32_bf16 v108, v32, s6, 0
  v_dot2_f32_bf16 v110, v33, s6, 0
  v_dot2_f32_bf16 v109, v32, s7, 0
  v_dot2_f32_bf16 v111, v33, s7, 0
  v_dot2_f32_bf16 v108, v36, s6, v108
  v_dot2_f32_bf16 v110, v37, s6, v110
  v_dot2_f32_bf16 v109, v36, s7, v109
  v_dot2_f32_bf16 v111, v37, s7, v111
  v_dot2_f32_bf16 v108, v40, s6, v108
  v_dot2_f32_bf16 v110, v41, s6, v110
  v_dot2_f32_bf16 v109, v40, s7, v109
  v_dot2_f32_bf16 v111, v41, s7, v111
  v_dot2_f32_bf16 v108, v44, s6, v108
  v_dot2_f32_bf16 v110, v45, s6, v110
  v_dot2_f32_bf16 v109, v44, s7, v109
  v_dot2_f32_bf16 v111, v45, s7, v111
  v_dot2_f32_bf16 v108, v48, s6, v108
  v_dot2_f32_bf16 v110, v49, s6, v110
  v_dot2_f32_bf16 v109, v48, s7, v109
  v_dot2_f32_bf16 v111, v49, s7, v111
  v_dot2_f32_bf16 v108, v52, s6, v108
  v_dot2_f32_bf16 v110, v53, s6, v110
  v_dot2_f32_bf16 v109, v52, s7, v109
  v_dot2_f32_bf16 v111, v53, s7, v111
  v_dot2_f32_bf16 v108, v56, s6, v108
  v_dot2_f32_bf16 v110, v57, s6, v110
  v_dot2_f32_bf16 v109, v56, s7, v109
  v_dot2_f32_bf16 v111, v57, s7, v111
  v_dot2_f32_bf16 v108, v60, s6, v108
  v_dot2_f32_bf16 v110, v61, s6, v110
  v_dot2_f32_bf16 v109, v60, s7, v109
  v_dot2_f32_bf16 v111, v61, s7, v111
  s_nop 1
  v_pk_fma_f32 v[108:109], v[108:109], v[88:89], v[72:73]
  v_pk_fma_f32 v[110:111], v[110:111], v[90:91], v[74:75]
  v_cvt_pk_bf16_f32 v100, v108, v109
  v_cvt_pk_bf16_f32 v101, v110, v111
  v_dot2_f32_bf16 v108, v34, s6, 0
  v_dot2_f32_bf16 v110, v35, s6, 0
  v_dot2_f32_bf16 v109, v34, s7, 0
  v_dot2_f32_bf16 v111, v35, s7, 0
  v_dot2_f32_bf16 v108, v38, s6, v108
  v_dot2_f32_bf16 v110, v39, s6, v110
  v_dot2_f32_bf16 v109, v38, s7, v109
  v_dot2_f32_bf16 v111, v39, s7, v111
  v_dot2_f32_bf16 v108, v42, s6, v108
  v_dot2_f32_bf16 v110, v43, s6, v110
  v_dot2_f32_bf16 v109, v42, s7, v109
  v_dot2_f32_bf16 v111, v43, s7, v111
  v_dot2_f32_bf16 v108, v46, s6, v108
  v_dot2_f32_bf16 v110, v47, s6, v110
  v_dot2_f32_bf16 v109, v46, s7, v109
  v_dot2_f32_bf16 v111, v47, s7, v111
  v_dot2_f32_bf16 v108, v50, s6, v108
  v_dot2_f32_bf16 v110, v51, s6, v110
  v_dot2_f32_bf16 v109, v50, s7, v109
  v_dot2_f32_bf16 v111, v51, s7, v111
  v_dot2_f32_bf16 v108, v54, s6, v108
  v_dot2_f32_bf16 v110, v55, s6, v110
  v_dot2_f32_bf16 v109, v54, s7, v109
  v_dot2_f32_bf16 v111, v55, s7, v111
  v_dot2_f32_bf16 v108, v58, s6, v108
  v_dot2_f32_bf16 v110, v59, s6, v110
  v_dot2_f32_bf16 v109, v58, s7, v109
  v_dot2_f32_bf16 v111, v59, s7, v111
  v_dot2_f32_bf16 v108, v62, s6, v108
  v_dot2_f32_bf16 v110, v63, s6, v110
  v_dot2_f32_bf16 v109, v62, s7, v109
  v_dot2_f32_bf16 v111, v63, s7, v111
  s_nop 1
  v_pk_fma_f32 v[108:109], v[108:109], v[92:93], v[76:77]
  v_pk_fma_f32 v[110:111], v[110:111], v[94:95], v[78:79]
  v_cvt_pk_bf16_f32 v102, v108, v109
  v_cvt_pk_bf16_f32 v103, v110, v111
  buffer_store_dwordx4 v[96:99], v250, s[40:43], s69 offen sc1
  buffer_store_dwordx4 v[100:103], v250, s[40:43], s69 offen offset:1024 sc1
L1_done:
  s_endpgm
L1_selrow:
  v_and_b32 v240, 31, v255
  v_lshlrev_b32 v240, 8, v240
  s_mov_b32 s98, 0
  s_mov_b32 s7, 16810116
  s_waitcnt lgkmcnt(0)
  L1_ypoll:
  buffer_load_dword v251, v252, s[28:31], s99 offen sc1
  buffer_load_dword v241, v240, s[28:31], s7 offen sc1
  s_waitcnt vmcnt(0)
  v_cmp_eq_u32 vcc, 0, v251
  v_cmp_ne_u32 s[100:101], 8, v241
  s_nop 1
  s_or_b64 vcc, vcc, s[100:101]
  s_nop 4
  s_cbranch_vccz L1_yok
  s_add_u32 s98, s98, 1
  s_cmp_lt_u32 s98, 0x4000
  s_cbranch_scc1 L1_ypoll
  L1_yok:
  s_mov_b32 s7, 16818176
  buffer_load_dwordx4 v[128:131], v250, s[28:31], s7 offen sc1
  buffer_load_dwordx4 v[132:135], v250, s[28:31], s7 offen offset:1024 sc1
  s_add_u32 s7, s7, 2048
  buffer_load_dwordx4 v[136:139], v250, s[28:31], s7 offen sc1
  buffer_load_dwordx4 v[140:143], v250, s[28:31], s7 offen offset:1024 sc1
  s_add_u32 s7, s7, 2048
  buffer_load_dwordx4 v[144:147], v250, s[28:31], s7 offen sc1
  buffer_load_dwordx4 v[148:151], v250, s[28:31], s7 offen offset:1024 sc1
  s_add_u32 s7, s7, 2048
  buffer_load_dwordx4 v[152:155], v250, s[28:31], s7 offen sc1
  buffer_load_dwordx4 v[156:159], v250, s[28:31], s7 offen offset:1024 sc1
  s_add_u32 s7, s7, 2048
  buffer_load_dwordx4 v[160:163], v250, s[28:31], s7 offen sc1
  buffer_load_dwordx4 v[164:167], v250, s[28:31], s7 offen offset:1024 sc1
  s_add_u32 s7, s7, 2048
  buffer_load_dwordx4 v[168:171], v250, s[28:31], s7 offen sc1
  buffer_load_dwordx4 v[172:175], v250, s[28:31], s7 offen offset:1024 sc1
  s_add_u32 s7, s7, 2048
  buffer_load_dwordx4 v[176:179], v250, s[28:31], s7 offen sc1
  buffer_load_dwordx4 v[180:183], v250, s[28:31], s7 offen offset:1024 sc1
  s_add_u32 s7, s7, 2048
  buffer_load_dwordx4 v[184:187], v250, s[28:31], s7 offen sc1
  buffer_load_dwordx4 v[188:191], v250, s[28:31], s7 offen offset:1024 sc1
  s_add_u32 s7, s7, 2048
  s_add_u32 s7, s69, 0
  s_cmp_eq_u32 s3, 0
  s_cbranch_scc1 L_sown00
  buffer_load_dwordx4 v[0:3], v250, s[28:31], s7 offen offset:0 sc1
  L_sown00:
  s_add_u32 s7, s69, 2097152
  s_cmp_eq_u32 s3, 1
  s_cbranch_scc1 L_sown01
  buffer_load_dwordx4 v[4:7], v250, s[28:31], s7 offen offset:0 sc1
  L_sown01:
  s_add_u32 s7, s69, 4194304
  s_cmp_eq_u32 s3, 2
  s_cbranch_scc1 L_sown02
  buffer_load_dwordx4 v[8:11], v250, s[28:31], s7 offen offset:0 sc1
  L_sown02:
  s_add_u32 s7, s69, 6291456
  s_cmp_eq_u32 s3, 3
  s_cbranch_scc1 L_sown03
  buffer_load_dwordx4 v[12:15], v250, s[28:31], s7 offen offset:0 sc1
  L_sown03:
  s_add_u32 s7, s69, 8388608
  s_cmp_eq_u32 s3, 4
  s_cbranch_scc1 L_sown04
  buffer_load_dwordx4 v[16:19], v250, s[28:31], s7 offen offset:0 sc1
  L_sown04:
  s_add_u32 s7, s69, 10485760
  s_cmp_eq_u32 s3, 5
  s_cbranch_scc1 L_sown05
  buffer_load_dwordx4 v[20:23], v250, s[28:31], s7 offen offset:0 sc1
  L_sown05:
  s_add_u32 s7, s69, 12582912
  s_cmp_eq_u32 s3, 6
  s_cbranch_scc1 L_sown06
  buffer_load_dwordx4 v[24:27], v250, s[28:31], s7 offen offset:0 sc1
  L_sown06:
  s_add_u32 s7, s69, 14680064
  s_cmp_eq_u32 s3, 7
  s_cbranch_scc1 L_sown07
  buffer_load_dwordx4 v[28:31], v250, s[28:31], s7 offen offset:0 sc1
  L_sown07:
  s_add_u32 s7, s69, 0
  s_cmp_eq_u32 s3, 0
  s_cbranch_scc1 L_sown10
  buffer_load_dwordx4 v[32:35], v250, s[28:31], s7 offen offset:1024 sc1
  L_sown10:
  s_add_u32 s7, s69, 2097152
  s_cmp_eq_u32 s3, 1
  s_cbranch_scc1 L_sown11
  buffer_load_dwordx4 v[36:39], v250, s[28:31], s7 offen offset:1024 sc1
  L_sown11:
  s_add_u32 s7, s69, 4194304
  s_cmp_eq_u32 s3, 2
  s_cbranch_scc1 L_sown12
  buffer_load_dwordx4 v[40:43], v250, s[28:31], s7 offen offset:1024 sc1
  L_sown12:
  s_add_u32 s7, s69, 6291456
  s_cmp_eq_u32 s3, 3
  s_cbranch_scc1 L_sown13
  buffer_load_dwordx4 v[44:47], v250, s[28:31], s7 offen offset:1024 sc1
  L_sown13:
  s_add_u32 s7, s69, 8388608
  s_cmp_eq_u32 s3, 4
  s_cbranch_scc1 L_sown14
  buffer_load_dwordx4 v[48:51], v250, s[28:31], s7 offen offset:1024 sc1
  L_sown14:
  s_add_u32 s7, s69, 10485760
  s_cmp_eq_u32 s3, 5
  s_cbranch_scc1 L_sown15
  buffer_load_dwordx4 v[52:55], v250, s[28:31], s7 offen offset:1024 sc1
  L_sown15:
  s_add_u32 s7, s69, 12582912
  s_cmp_eq_u32 s3, 6
  s_cbranch_scc1 L_sown16
  buffer_load_dwordx4 v[56:59], v250, s[28:31], s7 offen offset:1024 sc1
  L_sown16:
  s_add_u32 s7, s69, 14680064
  s_cmp_eq_u32 s3, 7
  s_cbranch_scc1 L_sown17
  buffer_load_dwordx4 v[60:63], v250, s[28:31], s7 offen offset:1024 sc1
  L_sown17:
  s_lshr_b32 s7, s68, 16
  s_and_b32 s98, s7, 0x8000
  s_and_b32 s99, s7, 0x7fff
  s_xor_b32 s7, s7, 0xffff
  s_cmp_lg_u32 s98, 0
  s_cselect_b32 s7, s99, s7
  s_lshl_b32 s7, s7, 16
  v_mov_b32 v104, s7
  v_mul_f32 v104, 0xbfb8aa3b, v104
  v_exp_f32 v104, v104
  s_nop 0
  v_add_f32 v104, 1.0, v104
  v_rcp_f32 v104, v104
  s_nop 0
  v_cvt_pk_bf16_f32 v104, v104, v104
  v_lshlrev_b32 v104, 16, v104
  s_cmp_eq_u32 s67, 0
  s_cselect_b32 s7, 1.0, 0
  s_cselect_b32 s98, 0, 1.0
  s_waitcnt vmcnt(14)
  v_add_f32 v105, v128, v136
  v_add_f32 v105, v105, v144
  v_add_f32 v105, v105, v152
  v_add_f32 v105, v105, v160
  v_add_f32 v105, v105, v168
  v_add_f32 v105, v105, v176
  v_add_f32 v105, v105, v184
  v_cvt_pk_bf16_f32 v105, v105, v105
  v_lshlrev_b32 v105, 16, v105
  v_mul_f32 v105, v105, v104
  v_cvt_pk_bf16_f32 v105, v105, v105
  v_lshlrev_b32 v105, 16, v105
  v_mul_f32 v106, s7, v105
  v_mul_f32 v114, s98, v105
  v_add_f32 v105, v132, v140
  v_add_f32 v105, v105, v148
  v_add_f32 v105, v105, v156
  v_add_f32 v105, v105, v164
  v_add_f32 v105, v105, v172
  v_add_f32 v105, v105, v180
  v_add_f32 v105, v105, v188
  v_cvt_pk_bf16_f32 v105, v105, v105
  v_lshlrev_b32 v105, 16, v105
  v_mul_f32 v105, v105, v104
  v_cvt_pk_bf16_f32 v105, v105, v105
  v_lshlrev_b32 v105, 16, v105
  v_mul_f32 v107, s7, v105
  v_mul_f32 v115, s98, v105
  v_add_f32 v105, v129, v137
  v_add_f32 v105, v105, v145
  v_add_f32 v105, v105, v153
  v_add_f32 v105, v105, v161
  v_add_f32 v105, v105, v169
  v_add_f32 v105, v105, v177
  v_add_f32 v105, v105, v185
  v_cvt_pk_bf16_f32 v105, v105, v105
  v_lshlrev_b32 v105, 16, v105
  v_mul_f32 v105, v105, v104
  v_cvt_pk_bf16_f32 v105, v105, v105
  v_lshlrev_b32 v105, 16, v105
  v_mul_f32 v108, s7, v105
  v_mul_f32 v116, s98, v105
  v_add_f32 v105, v133, v141
  v_add_f32 v105, v105, v149
  v_add_f32 v105, v105, v157
  v_add_f32 v105, v105, v165
  v_add_f32 v105, v105, v173
  v_add_f32 v105, v105, v181
  v_add_f32 v105, v105, v189
  v_cvt_pk_bf16_f32 v105, v105, v105
  v_lshlrev_b32 v105, 16, v105
  v_mul_f32 v105, v105, v104
  v_cvt_pk_bf16_f32 v105, v105, v105
  v_lshlrev_b32 v105, 16, v105
  v_mul_f32 v109, s7, v105
  v_mul_f32 v117, s98, v105
  v_add_f32 v105, v130, v138
  v_add_f32 v105, v105, v146
  v_add_f32 v105, v105, v154
  v_add_f32 v105, v105, v162
  v_add_f32 v105, v105, v170
  v_add_f32 v105, v105, v178
  v_add_f32 v105, v105, v186
  v_cvt_pk_bf16_f32 v105, v105, v105
  v_lshlrev_b32 v105, 16, v105
  v_mul_f32 v105, v105, v104
  v_cvt_pk_bf16_f32 v105, v105, v105
  v_lshlrev_b32 v105, 16, v105
  v_mul_f32 v110, s7, v105
  v_mul_f32 v118, s98, v105
  v_add_f32 v105, v134, v142
  v_add_f32 v105, v105, v150
  v_add_f32 v105, v105, v158
  v_add_f32 v105, v105, v166
  v_add_f32 v105, v105, v174
  v_add_f32 v105, v105, v182
  v_add_f32 v105, v105, v190
  v_cvt_pk_bf16_f32 v105, v105, v105
  v_lshlrev_b32 v105, 16, v105
  v_mul_f32 v105, v105, v104
  v_cvt_pk_bf16_f32 v105, v105, v105
  v_lshlrev_b32 v105, 16, v105
  v_mul_f32 v111, s7, v105
  v_mul_f32 v119, s98, v105
  v_add_f32 v105, v131, v139
  v_add_f32 v105, v105, v147
  v_add_f32 v105, v105, v155
  v_add_f32 v105, v105, v163
  v_add_f32 v105, v105, v171
  v_add_f32 v105, v105, v179
  v_add_f32 v105, v105, v187
  v_cvt_pk_bf16_f32 v105, v105, v105
  v_lshlrev_b32 v105, 16, v105
  v_mul_f32 v105, v105, v104
  v_cvt_pk_bf16_f32 v105, v105, v105
  v_lshlrev_b32 v105, 16, v105
  v_mul_f32 v112, s7, v105
  v_mul_f32 v120, s98, v105
  v_add_f32 v105, v135, v143
  v_add_f32 v105, v105, v151
  v_add_f32 v105, v105, v159
  v_add_f32 v105, v105, v167
  v_add_f32 v105, v105, v175
  v_add_f32 v105, v105, v183
  v_add_f32 v105, v105, v191
  v_cvt_pk_bf16_f32 v105, v105, v105
  v_lshlrev_b32 v105, 16, v105
  v_mul_f32 v105, v105, v104
  v_cvt_pk_bf16_f32 v105, v105, v105
  v_lshlrev_b32 v105, 16, v105
  v_mul_f32 v113, s7, v105
  v_mul_f32 v121, s98, v105
  v_lshlrev_b32 v64, 16, v192
  v_and_b32 v65, s65, v192
  v_sub_f32 v80, v64, v200
  v_sub_f32 v81, v65, v200
  v_cvt_pk_bf16_f32 v122, v80, v81
  v_lshlrev_b32 v80, 16, v122
  v_and_b32 v81, s65, v122
  v_mul_f32 v80, v80, v201
  v_mul_f32 v81, v81, v201
  v_cvt_pk_bf16_f32 v122, v80, v81
  v_lshlrev_b32 v80, 16, v122
  v_and_b32 v81, s65, v122
  v_add_f32 v80, v80, v106
  v_add_f32 v81, v81, v107
  v_cvt_pk_bf16_f32 v122, v80, v81
  v_lshlrev_b32 v80, 16, v122
  v_and_b32 v81, s65, v122
  v_mul_f32 v124, 0xbfb8aa3b, v80
  v_mul_f32 v125, 0xbfb8aa3b, v81
  v_exp_f32 v124, v124
  v_exp_f32 v125, v125
  s_nop 0
  v_add_f32 v124, 1.0, v124
  v_add_f32 v125, 1.0, v125
  v_rcp_f32 v124, v124
  v_rcp_f32 v125, v125
  s_nop 0
  v_mul_f32 v80, v80, v124
  v_mul_f32 v81, v81, v125
  v_cvt_pk_bf16_f32 v122, v80, v81
  v_lshlrev_b32 v80, 16, v122
  v_and_b32 v81, s65, v122
  v_lshlrev_b32 v66, 16, v193
  v_and_b32 v67, s65, v193
  v_sub_f32 v82, v66, v200
  v_sub_f32 v83, v67, v200
  v_cvt_pk_bf16_f32 v122, v82, v83
  v_lshlrev_b32 v82, 16, v122
  v_and_b32 v83, s65, v122
  v_mul_f32 v82, v82, v201
  v_mul_f32 v83, v83, v201
  v_cvt_pk_bf16_f32 v122, v82, v83
  v_lshlrev_b32 v82, 16, v122
  v_and_b32 v83, s65, v122
  v_add_f32 v82, v82, v108
  v_add_f32 v83, v83, v109
  v_cvt_pk_bf16_f32 v122, v82, v83
  v_lshlrev_b32 v82, 16, v122
  v_and_b32 v83, s65, v122
  v_mul_f32 v124, 0xbfb8aa3b, v82
  v_mul_f32 v125, 0xbfb8aa3b, v83
  v_exp_f32 v124, v124
  v_exp_f32 v125, v125
  s_nop 0
  v_add_f32 v124, 1.0, v124
  v_add_f32 v125, 1.0, v125
  v_rcp_f32 v124, v124
  v_rcp_f32 v125, v125
  s_nop 0
  v_mul_f32 v82, v82, v124
  v_mul_f32 v83, v83, v125
  v_cvt_pk_bf16_f32 v122, v82, v83
  v_lshlrev_b32 v82, 16, v122
  v_and_b32 v83, s65, v122
  v_lshlrev_b32 v68, 16, v194
  v_and_b32 v69, s65, v194
  v_sub_f32 v84, v68, v200
  v_sub_f32 v85, v69, v200
  v_cvt_pk_bf16_f32 v122, v84, v85
  v_lshlrev_b32 v84, 16, v122
  v_and_b32 v85, s65, v122
  v_mul_f32 v84, v84, v201
  v_mul_f32 v85, v85, v201
  v_cvt_pk_bf16_f32 v122, v84, v85
  v_lshlrev_b32 v84, 16, v122
  v_and_b32 v85, s65, v122
  v_add_f32 v84, v84, v110
  v_add_f32 v85, v85, v111
  v_cvt_pk_bf16_f32 v122, v84, v85
  v_lshlrev_b32 v84, 16, v122
  v_and_b32 v85, s65, v122
  v_mul_f32 v124, 0xbfb8aa3b, v84
  v_mul_f32 v125, 0xbfb8aa3b, v85
  v_exp_f32 v124, v124
  v_exp_f32 v125, v125
  s_nop 0
  v_add_f32 v124, 1.0, v124
  v_add_f32 v125, 1.0, v125
  v_rcp_f32 v124, v124
  v_rcp_f32 v125, v125
  s_nop 0
  v_mul_f32 v84, v84, v124
  v_mul_f32 v85, v85, v125
  v_cvt_pk_bf16_f32 v122, v84, v85
  v_lshlrev_b32 v84, 16, v122
  v_and_b32 v85, s65, v122
  v_lshlrev_b32 v70, 16, v195
  v_and_b32 v71, s65, v195
  v_sub_f32 v86, v70, v200
  v_sub_f32 v87, v71, v200
  v_cvt_pk_bf16_f32 v122, v86, v87
  v_lshlrev_b32 v86, 16, v122
  v_and_b32 v87, s65, v122
  v_mul_f32 v86, v86, v201
  v_mul_f32 v87, v87, v201
  v_cvt_pk_bf16_f32 v122, v86, v87
  v_lshlrev_b32 v86, 16, v122
  v_and_b32 v87, s65, v122
  v_add_f32 v86, v86, v112
  v_add_f32 v87, v87, v113
  v_cvt_pk_bf16_f32 v122, v86, v87
  v_lshlrev_b32 v86, 16, v122
  v_and_b32 v87, s65, v122
  v_mul_f32 v124, 0xbfb8aa3b, v86
  v_mul_f32 v125, 0xbfb8aa3b, v87
  v_exp_f32 v124, v124
  v_exp_f32 v125, v125
  s_nop 0
  v_add_f32 v124, 1.0, v124
  v_add_f32 v125, 1.0, v125
  v_rcp_f32 v124, v124
  v_rcp_f32 v125, v125
  s_nop 0
  v_mul_f32 v86, v86, v124
  v_mul_f32 v87, v87, v125
  v_cvt_pk_bf16_f32 v122, v86, v87
  v_lshlrev_b32 v86, 16, v122
  v_and_b32 v87, s65, v122
  v_lshlrev_b32 v72, 16, v196
  v_and_b32 v73, s65, v196
  v_sub_f32 v88, v72, v202
  v_sub_f32 v89, v73, v202
  v_cvt_pk_bf16_f32 v122, v88, v89
  v_lshlrev_b32 v88, 16, v122
  v_and_b32 v89, s65, v122
  v_mul_f32 v88, v88, v203
  v_mul_f32 v89, v89, v203
  v_cvt_pk_bf16_f32 v122, v88, v89
  v_lshlrev_b32 v88, 16, v122
  v_and_b32 v89, s65, v122
  v_add_f32 v88, v88, v114
  v_add_f32 v89, v89, v115
  v_cvt_pk_bf16_f32 v122, v88, v89
  v_lshlrev_b32 v88, 16, v122
  v_and_b32 v89, s65, v122
  v_mul_f32 v124, 0xbfb8aa3b, v88
  v_mul_f32 v125, 0xbfb8aa3b, v89
  v_exp_f32 v124, v124
  v_exp_f32 v125, v125
  s_nop 0
  v_add_f32 v124, 1.0, v124
  v_add_f32 v125, 1.0, v125
  v_rcp_f32 v124, v124
  v_rcp_f32 v125, v125
  s_nop 0
  v_mul_f32 v88, v88, v124
  v_mul_f32 v89, v89, v125
  v_cvt_pk_bf16_f32 v122, v88, v89
  v_lshlrev_b32 v88, 16, v122
  v_and_b32 v89, s65, v122
  v_lshlrev_b32 v74, 16, v197
  v_and_b32 v75, s65, v197
  v_sub_f32 v90, v74, v202
  v_sub_f32 v91, v75, v202
  v_cvt_pk_bf16_f32 v122, v90, v91
  v_lshlrev_b32 v90, 16, v122
  v_and_b32 v91, s65, v122
  v_mul_f32 v90, v90, v203
  v_mul_f32 v91, v91, v203
  v_cvt_pk_bf16_f32 v122, v90, v91
  v_lshlrev_b32 v90, 16, v122
  v_and_b32 v91, s65, v122
  v_add_f32 v90, v90, v116
  v_add_f32 v91, v91, v117
  v_cvt_pk_bf16_f32 v122, v90, v91
  v_lshlrev_b32 v90, 16, v122
  v_and_b32 v91, s65, v122
  v_mul_f32 v124, 0xbfb8aa3b, v90
  v_mul_f32 v125, 0xbfb8aa3b, v91
  v_exp_f32 v124, v124
  v_exp_f32 v125, v125
  s_nop 0
  v_add_f32 v124, 1.0, v124
  v_add_f32 v125, 1.0, v125
  v_rcp_f32 v124, v124
  v_rcp_f32 v125, v125
  s_nop 0
  v_mul_f32 v90, v90, v124
  v_mul_f32 v91, v91, v125
  v_cvt_pk_bf16_f32 v122, v90, v91
  v_lshlrev_b32 v90, 16, v122
  v_and_b32 v91, s65, v122
  v_lshlrev_b32 v76, 16, v198
  v_and_b32 v77, s65, v198
  v_sub_f32 v92, v76, v202
  v_sub_f32 v93, v77, v202
  v_cvt_pk_bf16_f32 v122, v92, v93
  v_lshlrev_b32 v92, 16, v122
  v_and_b32 v93, s65, v122
  v_mul_f32 v92, v92, v203
  v_mul_f32 v93, v93, v203
  v_cvt_pk_bf16_f32 v122, v92, v93
  v_lshlrev_b32 v92, 16, v122
  v_and_b32 v93, s65, v122
  v_add_f32 v92, v92, v118
  v_add_f32 v93, v93, v119
  v_cvt_pk_bf16_f32 v122, v92, v93
  v_lshlrev_b32 v92, 16, v122
  v_and_b32 v93, s65, v122
  v_mul_f32 v124, 0xbfb8aa3b, v92
  v_mul_f32 v125, 0xbfb8aa3b, v93
  v_exp_f32 v124, v124
  v_exp_f32 v125, v125
  s_nop 0
  v_add_f32 v124, 1.0, v124
  v_add_f32 v125, 1.0, v125
  v_rcp_f32 v124, v124
  v_rcp_f32 v125, v125
  s_nop 0
  v_mul_f32 v92, v92, v124
  v_mul_f32 v93, v93, v125
  v_cvt_pk_bf16_f32 v122, v92, v93
  v_lshlrev_b32 v92, 16, v122
  v_and_b32 v93, s65, v122
  v_lshlrev_b32 v78, 16, v199
  v_and_b32 v79, s65, v199
  v_sub_f32 v94, v78, v202
  v_sub_f32 v95, v79, v202
  v_cvt_pk_bf16_f32 v122, v94, v95
  v_lshlrev_b32 v94, 16, v122
  v_and_b32 v95, s65, v122
  v_mul_f32 v94, v94, v203
  v_mul_f32 v95, v95, v203
  v_cvt_pk_bf16_f32 v122, v94, v95
  v_lshlrev_b32 v94, 16, v122
  v_and_b32 v95, s65, v122
  v_add_f32 v94, v94, v120
  v_add_f32 v95, v95, v121
  v_cvt_pk_bf16_f32 v122, v94, v95
  v_lshlrev_b32 v94, 16, v122
  v_and_b32 v95, s65, v122
  v_mul_f32 v124, 0xbfb8aa3b, v94
  v_mul_f32 v125, 0xbfb8aa3b, v95
  v_exp_f32 v124, v124
  v_exp_f32 v125, v125
  s_nop 0
  v_add_f32 v124, 1.0, v124
  v_add_f32 v125, 1.0, v125
  v_rcp_f32 v124, v124
  v_rcp_f32 v125, v125
  s_nop 0
  v_mul_f32 v94, v94, v124
  v_mul_f32 v95, v95, v125
  v_cvt_pk_bf16_f32 v122, v94, v95
  v_lshlrev_b32 v94, 16, v122
  v_and_b32 v95, s65, v122
  s_waitcnt vmcnt(0)
  s_mov_b32 s6, 0x00003f80
  s_mov_b32 s7, 0x3f800000
  v_dot2_f32_bf16 v104, v0, s6, 0
  v_dot2_f32_bf16 v106, v1, s6, 0
  v_dot2_f32_bf16 v105, v0, s7, 0
  v_dot2_f32_bf16 v107, v1, s7, 0
  v_dot2_f32_bf16 v104, v4, s6, v104
  v_dot2_f32_bf16 v106, v5, s6, v106
  v_dot2_f32_bf16 v105, v4, s7, v105
  v_dot2_f32_bf16 v107, v5, s7, v107
  v_dot2_f32_bf16 v104, v8, s6, v104
  v_dot2_f32_bf16 v106, v9, s6, v106
  v_dot2_f32_bf16 v105, v8, s7, v105
  v_dot2_f32_bf16 v107, v9, s7, v107
  v_dot2_f32_bf16 v104, v12, s6, v104
  v_dot2_f32_bf16 v106, v13, s6, v106
  v_dot2_f32_bf16 v105, v12, s7, v105
  v_dot2_f32_bf16 v107, v13, s7, v107
  v_dot2_f32_bf16 v104, v16, s6, v104
  v_dot2_f32_bf16 v106, v17, s6, v106
  v_dot2_f32_bf16 v105, v16, s7, v105
  v_dot2_f32_bf16 v107, v17, s7, v107
  v_dot2_f32_bf16 v104, v20, s6, v104
  v_dot2_f32_bf16 v106, v21, s6, v106
  v_dot2_f32_bf16 v105, v20, s7, v105
  v_dot2_f32_bf16 v107, v21, s7, v107
  v_dot2_f32_bf16 v104, v24, s6, v104
  v_dot2_f32_bf16 v106, v25, s6, v106
  v_dot2_f32_bf16 v105, v24, s7, v105
  v_dot2_f32_bf16 v107, v25, s7, v107
  v_dot2_f32_bf16 v104, v28, s6, v104
  v_dot2_f32_bf16 v106, v29, s6, v106
  v_dot2_f32_bf16 v105, v28, s7, v105
  v_dot2_f32_bf16 v107, v29, s7, v107
  s_nop 1
  v_cvt_pk_bf16_f32 v112, v104, v105
  v_lshlrev_b32 v104, 16, v112
  v_and_b32 v105, s65, v112
  v_pk_mul_f32 v[104:105], v[104:105], v[80:81]
  v_cvt_pk_bf16_f32 v112, v104, v105
  v_lshlrev_b32 v104, 16, v112
  v_and_b32 v105, s65, v112
  v_pk_add_f32 v[104:105], v[104:105], v[64:65]
  v_cvt_pk_bf16_f32 v112, v106, v107
  v_lshlrev_b32 v106, 16, v112
  v_and_b32 v107, s65, v112
  v_pk_mul_f32 v[106:107], v[106:107], v[82:83]
  v_cvt_pk_bf16_f32 v112, v106, v107
  v_lshlrev_b32 v106, 16, v112
  v_and_b32 v107, s65, v112
  v_pk_add_f32 v[106:107], v[106:107], v[66:67]
  v_cvt_pk_bf16_f32 v96, v104, v105
  v_cvt_pk_bf16_f32 v97, v106, v107
  v_dot2_f32_bf16 v104, v2, s6, 0
  v_dot2_f32_bf16 v106, v3, s6, 0
  v_dot2_f32_bf16 v105, v2, s7, 0
  v_dot2_f32_bf16 v107, v3, s7, 0
  v_dot2_f32_bf16 v104, v6, s6, v104
  v_dot2_f32_bf16 v106, v7, s6, v106
  v_dot2_f32_bf16 v105, v6, s7, v105
  v_dot2_f32_bf16 v107, v7, s7, v107
  v_dot2_f32_bf16 v104, v10, s6, v104
  v_dot2_f32_bf16 v106, v11, s6, v106
  v_dot2_f32_bf16 v105, v10, s7, v105
  v_dot2_f32_bf16 v107, v11, s7, v107
  v_dot2_f32_bf16 v104, v14, s6, v104
  v_dot2_f32_bf16 v106, v15, s6, v106
  v_dot2_f32_bf16 v105, v14, s7, v105
  v_dot2_f32_bf16 v107, v15, s7, v107
  v_dot2_f32_bf16 v104, v18, s6, v104
  v_dot2_f32_bf16 v106, v19, s6, v106
  v_dot2_f32_bf16 v105, v18, s7, v105
  v_dot2_f32_bf16 v107, v19, s7, v107
  v_dot2_f32_bf16 v104, v22, s6, v104
  v_dot2_f32_bf16 v106, v23, s6, v106
  v_dot2_f32_bf16 v105, v22, s7, v105
  v_dot2_f32_bf16 v107, v23, s7, v107
  v_dot2_f32_bf16 v104, v26, s6, v104
  v_dot2_f32_bf16 v106, v27, s6, v106
  v_dot2_f32_bf16 v105, v26, s7, v105
  v_dot2_f32_bf16 v107, v27, s7, v107
  v_dot2_f32_bf16 v104, v30, s6, v104
  v_dot2_f32_bf16 v106, v31, s6, v106
  v_dot2_f32_bf16 v105, v30, s7, v105
  v_dot2_f32_bf16 v107, v31, s7, v107
  s_nop 1
  v_cvt_pk_bf16_f32 v112, v104, v105
  v_lshlrev_b32 v104, 16, v112
  v_and_b32 v105, s65, v112
  v_pk_mul_f32 v[104:105], v[104:105], v[84:85]
  v_cvt_pk_bf16_f32 v112, v104, v105
  v_lshlrev_b32 v104, 16, v112
  v_and_b32 v105, s65, v112
  v_pk_add_f32 v[104:105], v[104:105], v[68:69]
  v_cvt_pk_bf16_f32 v112, v106, v107
  v_lshlrev_b32 v106, 16, v112
  v_and_b32 v107, s65, v112
  v_pk_mul_f32 v[106:107], v[106:107], v[86:87]
  v_cvt_pk_bf16_f32 v112, v106, v107
  v_lshlrev_b32 v106, 16, v112
  v_and_b32 v107, s65, v112
  v_pk_add_f32 v[106:107], v[106:107], v[70:71]
  v_cvt_pk_bf16_f32 v98, v104, v105
  v_cvt_pk_bf16_f32 v99, v106, v107
  v_dot2_f32_bf16 v108, v32, s6, 0
  v_dot2_f32_bf16 v110, v33, s6, 0
  v_dot2_f32_bf16 v109, v32, s7, 0
  v_dot2_f32_bf16 v111, v33, s7, 0
  v_dot2_f32_bf16 v108, v36, s6, v108
  v_dot2_f32_bf16 v110, v37, s6, v110
  v_dot2_f32_bf16 v109, v36, s7, v109
  v_dot2_f32_bf16 v111, v37, s7, v111
  v_dot2_f32_bf16 v108, v40, s6, v108
  v_dot2_f32_bf16 v110, v41, s6, v110
  v_dot2_f32_bf16 v109, v40, s7, v109
  v_dot2_f32_bf16 v111, v41, s7, v111
  v_dot2_f32_bf16 v108, v44, s6, v108
  v_dot2_f32_bf16 v110, v45, s6, v110
  v_dot2_f32_bf16 v109, v44, s7, v109
  v_dot2_f32_bf16 v111, v45, s7, v111
  v_dot2_f32_bf16 v108, v48, s6, v108
  v_dot2_f32_bf16 v110, v49, s6, v110
  v_dot2_f32_bf16 v109, v48, s7, v109
  v_dot2_f32_bf16 v111, v49, s7, v111
  v_dot2_f32_bf16 v108, v52, s6, v108
  v_dot2_f32_bf16 v110, v53, s6, v110
  v_dot2_f32_bf16 v109, v52, s7, v109
  v_dot2_f32_bf16 v111, v53, s7, v111
  v_dot2_f32_bf16 v108, v56, s6, v108
  v_dot2_f32_bf16 v110, v57, s6, v110
  v_dot2_f32_bf16 v109, v56, s7, v109
  v_dot2_f32_bf16 v111, v57, s7, v111
  v_dot2_f32_bf16 v108, v60, s6, v108
  v_dot2_f32_bf16 v110, v61, s6, v110
  v_dot2_f32_bf16 v109, v60, s7, v109
  v_dot2_f32_bf16 v111, v61, s7, v111
  s_nop 1
  v_cvt_pk_bf16_f32 v112, v108, v109
  v_lshlrev_b32 v108, 16, v112
  v_and_b32 v109, s65, v112
  v_pk_mul_f32 v[108:109], v[108:109], v[88:89]
  v_cvt_pk_bf16_f32 v112, v108, v109
  v_lshlrev_b32 v108, 16, v112
  v_and_b32 v109, s65, v112
  v_pk_add_f32 v[108:109], v[108:109], v[72:73]
  v_cvt_pk_bf16_f32 v112, v110, v111
  v_lshlrev_b32 v110, 16, v112
  v_and_b32 v111, s65, v112
  v_pk_mul_f32 v[110:111], v[110:111], v[90:91]
  v_cvt_pk_bf16_f32 v112, v110, v111
  v_lshlrev_b32 v110, 16, v112
  v_and_b32 v111, s65, v112
  v_pk_add_f32 v[110:111], v[110:111], v[74:75]
  v_cvt_pk_bf16_f32 v100, v108, v109
  v_cvt_pk_bf16_f32 v101, v110, v111
  v_dot2_f32_bf16 v108, v34, s6, 0
  v_dot2_f32_bf16 v110, v35, s6, 0
  v_dot2_f32_bf16 v109, v34, s7, 0
  v_dot2_f32_bf16 v111, v35, s7, 0
  v_dot2_f32_bf16 v108, v38, s6, v108
  v_dot2_f32_bf16 v110, v39, s6, v110
  v_dot2_f32_bf16 v109, v38, s7, v109
  v_dot2_f32_bf16 v111, v39, s7, v111
  v_dot2_f32_bf16 v108, v42, s6, v108
  v_dot2_f32_bf16 v110, v43, s6, v110
  v_dot2_f32_bf16 v109, v42, s7, v109
  v_dot2_f32_bf16 v111, v43, s7, v111
  v_dot2_f32_bf16 v108, v46, s6, v108
  v_dot2_f32_bf16 v110, v47, s6, v110
  v_dot2_f32_bf16 v109, v46, s7, v109
  v_dot2_f32_bf16 v111, v47, s7, v111
  v_dot2_f32_bf16 v108, v50, s6, v108
  v_dot2_f32_bf16 v110, v51, s6, v110
  v_dot2_f32_bf16 v109, v50, s7, v109
  v_dot2_f32_bf16 v111, v51, s7, v111
  v_dot2_f32_bf16 v108, v54, s6, v108
  v_dot2_f32_bf16 v110, v55, s6, v110
  v_dot2_f32_bf16 v109, v54, s7, v109
  v_dot2_f32_bf16 v111, v55, s7, v111
  v_dot2_f32_bf16 v108, v58, s6, v108
  v_dot2_f32_bf16 v110, v59, s6, v110
  v_dot2_f32_bf16 v109, v58, s7, v109
  v_dot2_f32_bf16 v111, v59, s7, v111
  v_dot2_f32_bf16 v108, v62, s6, v108
  v_dot2_f32_bf16 v110, v63, s6, v110
  v_dot2_f32_bf16 v109, v62, s7, v109
  v_dot2_f32_bf16 v111, v63, s7, v111
  s_nop 1
  v_cvt_pk_bf16_f32 v112, v108, v109
  v_lshlrev_b32 v108, 16, v112
  v_and_b32 v109, s65, v112
  v_pk_mul_f32 v[108:109], v[108:109], v[92:93]
  v_cvt_pk_bf16_f32 v112, v108, v109
  v_lshlrev_b32 v108, 16, v112
  v_and_b32 v109, s65, v112
  v_pk_add_f32 v[108:109], v[108:109], v[76:77]
  v_cvt_pk_bf16_f32 v112, v110, v111
  v_lshlrev_b32 v110, 16, v112
  v_and_b32 v111, s65, v112
  v_pk_mul_f32 v[110:111], v[110:111], v[94:95]
  v_cvt_pk_bf16_f32 v112, v110, v111
  v_lshlrev_b32 v110, 16, v112
  v_and_b32 v111, s65, v112
  v_pk_add_f32 v[110:111], v[110:111], v[78:79]
  v_cvt_pk_bf16_f32 v102, v108, v109
  v_cvt_pk_bf16_f32 v103, v110, v111
  buffer_store_dwordx4 v[96:99], v250, s[40:43], s69 offen sc1
  buffer_store_dwordx4 v[100:103], v250, s[40:43], s69 offen offset:1024 sc1
  s_branch L1_done
L_keyspin:
  s_mov_b32 s98, 0
  L_keyspin2:
  s_sleep 4
  v_and_b32 v250, 31, v255
  v_lshlrev_b32 v250, 2, v250
  buffer_load_dword v120, v250, s[36:39], 0 offen sc1
  s_waitcnt vmcnt(0)
  v_cmp_eq_u32 vcc, 0, v120
  s_add_u32 s98, s98, 1
  s_cmp_lt_u32 s98, 0x8000
  s_cbranch_scc0 L_keyok
  s_nop 2
  s_cbranch_vccnz L_keyspin2
  s_branch L_keyok
L_cnt1spin:
  s_mov_b32 s98, 0
  s_mov_b32 s99, 16810112
  L_cnt1spin2:
  s_sleep 4
  v_and_b32 v252, 31, v255
  v_lshlrev_b32 v252, 8, v252
  buffer_load_dword v253, v252, s[28:31], s99 offen sc1
  s_waitcnt vmcnt(0)
  v_cmp_ne_u32 vcc, 8, v253
  s_add_u32 s98, s98, 1
  s_cmp_lt_u32 s98, 0x4000
  s_cbranch_scc0 L_cnt1ok
  s_nop 2
  s_cbranch_vccnz L_cnt1spin2
  s_branch L_cnt1ok
L1_fallback:
  s_waitcnt vmcnt(0) lgkmcnt(0)
  s_lshl_b32 s98, s5, 13
  s_add_u32 s98, s98, 131072
  v_add_u32 v104, s98, v80
  v_add_u32 v105, s98, v81
  v_add_u32 v106, s98, v82
  v_add_u32 v107, s98, v83
  v_add_u32 v108, s98, v84
  v_add_u32 v109, s98, v85
  v_add_u32 v110, s98, v86
  v_add_u32 v111, s98, v87
  v_add_u32 v112, s98, v88
  v_subrev_u32 v112, 0x10000, v112
  v_add_u32 v113, s98, v89
  v_subrev_u32 v113, 0x10000, v113
  v_add_u32 v114, s98, v90
  v_subrev_u32 v114, 0x10000, v114
  v_add_u32 v115, s98, v91
  v_subrev_u32 v115, 0x10000, v115
  v_lshrrev_b32 v250, 4, v255
  v_and_b32 v251, 15, v255
  v_lshlrev_b32 v252, 8, v250
  v_lshlrev_b32 v253, 2, v250
  v_xor_b32 v253, v251, v253
  v_lshl_add_u32 v118, v253, 4, v252
  v_xor_b32 v253, v251, v250
  v_lshl_add_u32 v116, v253, 4, v252
  v_mov_b32 v102, 0xff800000
  v_mov_b32 v92, 0
  v_mov_b32 v93, 0
  v_mov_b32 v103, 0xff800000
  v_mov_b32 v94, 0
  v_mov_b32 v95, 0
  v_accvgpr_write_b32 a0, 0
  v_accvgpr_write_b32 a1, 0
  v_accvgpr_write_b32 a2, 0
  v_accvgpr_write_b32 a3, 0
  v_accvgpr_write_b32 a4, 0
  v_accvgpr_write_b32 a5, 0
  v_accvgpr_write_b32 a6, 0
  v_accvgpr_write_b32 a7, 0
  v_accvgpr_write_b32 a8, 0
  v_accvgpr_write_b32 a9, 0
  v_accvgpr_write_b32 a10, 0
  v_accvgpr_write_b32 a11, 0
  v_accvgpr_write_b32 a12, 0
  v_accvgpr_write_b32 a13, 0
  v_accvgpr_write_b32 a14, 0
  v_accvgpr_write_b32 a15, 0
  v_accvgpr_write_b32 a16, 0
  v_accvgpr_write_b32 a17, 0
  v_accvgpr_write_b32 a18, 0
  v_accvgpr_write_b32 a19, 0
  v_accvgpr_write_b32 a20, 0
  v_accvgpr_write_b32 a21, 0
  v_accvgpr_write_b32 a22, 0
  v_accvgpr_write_b32 a23, 0
  v_accvgpr_write_b32 a24, 0
  v_accvgpr_write_b32 a25, 0
  v_accvgpr_write_b32 a26, 0
  v_accvgpr_write_b32 a27, 0
  v_accvgpr_write_b32 a28, 0
  v_accvgpr_write_b32 a29, 0
  v_accvgpr_write_b32 a30, 0
  v_accvgpr_write_b32 a31, 0
  v_accvgpr_write_b32 a32, 0
  v_accvgpr_write_b32 a33, 0
  v_accvgpr_write_b32 a34, 0
  v_accvgpr_write_b32 a35, 0
  v_accvgpr_write_b32 a36, 0
  v_accvgpr_write_b32 a37, 0
  v_accvgpr_write_b32 a38, 0
  v_accvgpr_write_b32 a39, 0
  v_accvgpr_write_b32 a40, 0
  v_accvgpr_write_b32 a41, 0
  v_accvgpr_write_b32 a42, 0
  v_accvgpr_write_b32 a43, 0
  v_accvgpr_write_b32 a44, 0
  v_accvgpr_write_b32 a45, 0
  v_accvgpr_write_b32 a46, 0
  v_accvgpr_write_b32 a47, 0
  v_accvgpr_write_b32 a48, 0
  v_accvgpr_write_b32 a49, 0
  v_accvgpr_write_b32 a50, 0
  v_accvgpr_write_b32 a51, 0
  v_accvgpr_write_b32 a52, 0
  v_accvgpr_write_b32 a53, 0
  v_accvgpr_write_b32 a54, 0
  v_accvgpr_write_b32 a55, 0
  v_accvgpr_write_b32 a56, 0
  v_accvgpr_write_b32 a57, 0
  v_accvgpr_write_b32 a58, 0
  v_accvgpr_write_b32 a59, 0
  v_accvgpr_write_b32 a60, 0
  v_accvgpr_write_b32 a61, 0
  v_accvgpr_write_b32 a62, 0
  v_accvgpr_write_b32 a63, 0
  v_accvgpr_write_b32 a64, 0
  v_accvgpr_write_b32 a65, 0
  v_accvgpr_write_b32 a66, 0
  v_accvgpr_write_b32 a67, 0
  v_accvgpr_write_b32 a68, 0
  v_accvgpr_write_b32 a69, 0
  v_accvgpr_write_b32 a70, 0
  v_accvgpr_write_b32 a71, 0
  v_accvgpr_write_b32 a72, 0
  v_accvgpr_write_b32 a73, 0
  v_accvgpr_write_b32 a74, 0
  v_accvgpr_write_b32 a75, 0
  v_accvgpr_write_b32 a76, 0
  v_accvgpr_write_b32 a77, 0
  v_accvgpr_write_b32 a78, 0
  v_accvgpr_write_b32 a79, 0
  v_accvgpr_write_b32 a80, 0
  v_accvgpr_write_b32 a81, 0
  v_accvgpr_write_b32 a82, 0
  v_accvgpr_write_b32 a83, 0
  v_accvgpr_write_b32 a84, 0
  v_accvgpr_write_b32 a85, 0
  v_accvgpr_write_b32 a86, 0
  v_accvgpr_write_b32 a87, 0
  v_accvgpr_write_b32 a88, 0
  v_accvgpr_write_b32 a89, 0
  v_accvgpr_write_b32 a90, 0
  v_accvgpr_write_b32 a91, 0
  v_accvgpr_write_b32 a92, 0
  v_accvgpr_write_b32 a93, 0
  v_accvgpr_write_b32 a94, 0
  v_accvgpr_write_b32 a95, 0
  v_accvgpr_write_b32 a96, 0
  v_accvgpr_write_b32 a97, 0
  v_accvgpr_write_b32 a98, 0
  v_accvgpr_write_b32 a99, 0
  v_accvgpr_write_b32 a100, 0
  v_accvgpr_write_b32 a101, 0
  v_accvgpr_write_b32 a102, 0
  v_accvgpr_write_b32 a103, 0
  v_accvgpr_write_b32 a104, 0
  v_accvgpr_write_b32 a105, 0
  v_accvgpr_write_b32 a106, 0
  v_accvgpr_write_b32 a107, 0
  v_accvgpr_write_b32 a108, 0
  v_accvgpr_write_b32 a109, 0
  v_accvgpr_write_b32 a110, 0
  v_accvgpr_write_b32 a111, 0
  v_accvgpr_write_b32 a112, 0
  v_accvgpr_write_b32 a113, 0
  v_accvgpr_write_b32 a114, 0
  v_accvgpr_write_b32 a115, 0
  v_accvgpr_write_b32 a116, 0
  v_accvgpr_write_b32 a117, 0
  v_accvgpr_write_b32 a118, 0
  v_accvgpr_write_b32 a119, 0
  v_accvgpr_write_b32 a120, 0
  v_accvgpr_write_b32 a121, 0
  v_accvgpr_write_b32 a122, 0
  v_accvgpr_write_b32 a123, 0
  v_accvgpr_write_b32 a124, 0
  v_accvgpr_write_b32 a125, 0
  v_accvgpr_write_b32 a126, 0
  v_accvgpr_write_b32 a127, 0
  s_mov_b32 s61, 0
L1_fb_loop:
  s_mov_b32 m0, s98
  v_xor_b32 v117, 0, v116
  buffer_load_dwordx4 v117, s[20:23], s61 offen offset:0 lds
  v_xor_b32 v117, 64, v116
  buffer_load_dwordx4 v117, s[20:23], s61 offen offset:1024 lds
  v_xor_b32 v117, 128, v116
  buffer_load_dwordx4 v117, s[20:23], s61 offen offset:2048 lds
  v_xor_b32 v117, 192, v116
  buffer_load_dwordx4 v117, s[20:23], s61 offen offset:3072 lds
  v_xor_b32 v117, 0, v116
  s_add_u32 m0, s98, 4096
  s_add_u32 s99, s61, 4096
  buffer_load_dwordx4 v117, s[20:23], s99 offen offset:0 lds
  v_xor_b32 v117, 64, v116
  buffer_load_dwordx4 v117, s[20:23], s99 offen offset:1024 lds
  v_xor_b32 v117, 128, v116
  buffer_load_dwordx4 v117, s[20:23], s99 offen offset:2048 lds
  v_xor_b32 v117, 192, v116
  buffer_load_dwordx4 v117, s[20:23], s99 offen offset:3072 lds
  s_waitcnt vmcnt(0)
  ds_read_b128 a[128:131], v104
  ds_read_b128 a[132:135], v105
  ds_read_b128 a[136:139], v106
  ds_read_b128 a[140:143], v107
  ds_read_b128 a[144:147], v108
  ds_read_b128 a[148:151], v109
  ds_read_b128 a[152:155], v110
  ds_read_b128 a[156:159], v111
  s_waitcnt lgkmcnt(0)
  s_mov_b32 m0, s98
  s_nop 0
  buffer_load_dwordx4 v118, s[24:27], s61 offen offset:0 lds
  buffer_load_dwordx4 v118, s[24:27], s61 offen offset:1024 lds
  buffer_load_dwordx4 v118, s[24:27], s61 offen offset:2048 lds
  buffer_load_dwordx4 v118, s[24:27], s61 offen offset:3072 lds
  s_add_u32 m0, s98, 4096
  s_nop 0
  buffer_load_dwordx4 v118, s[24:27], s99 offen offset:0 lds
  buffer_load_dwordx4 v118, s[24:27], s99 offen offset:1024 lds
  buffer_load_dwordx4 v118, s[24:27], s99 offen offset:2048 lds
  buffer_load_dwordx4 v118, s[24:27], s99 offen offset:3072 lds
  v_mfma_f32_32x32x16_bf16 v[32:47], a[128:131], v[128:131], 0
  v_mfma_f32_32x32x16_bf16 v[32:47], a[132:135], v[132:135], v[32:47]
  v_mfma_f32_32x32x16_bf16 v[32:47], a[136:139], v[136:139], v[32:47]
  v_mfma_f32_32x32x16_bf16 v[32:47], a[140:143], v[140:143], v[32:47]
  v_mfma_f32_32x32x16_bf16 v[32:47], a[144:147], v[144:147], v[32:47]
  v_mfma_f32_32x32x16_bf16 v[32:47], a[148:151], v[148:151], v[32:47]
  v_mfma_f32_32x32x16_bf16 v[32:47], a[152:155], v[152:155], v[32:47]
  v_mfma_f32_32x32x16_bf16 v[32:47], a[156:159], v[156:159], v[32:47]
  v_mfma_f32_32x32x16_bf16 v[48:63], a[128:131], v[0:3], 0
  v_mfma_f32_32x32x16_bf16 v[48:63], a[132:135], v[4:7], v[48:63]
  v_mfma_f32_32x32x16_bf16 v[48:63], a[136:139], v[8:11], v[48:63]
  v_mfma_f32_32x32x16_bf16 v[48:63], a[140:143], v[12:15], v[48:63]
  v_mfma_f32_32x32x16_bf16 v[48:63], a[144:147], v[16:19], v[48:63]
  v_mfma_f32_32x32x16_bf16 v[48:63], a[148:151], v[20:23], v[48:63]
  v_mfma_f32_32x32x16_bf16 v[48:63], a[152:155], v[24:27], v[48:63]
  v_mfma_f32_32x32x16_bf16 v[48:63], a[156:159], v[28:31], v[48:63]
  s_nop 7
  s_nop 7
  v_max3_f32 v250, v32, v33, v34
  v_max3_f32 v250, v250, v35, v36
  v_max3_f32 v250, v250, v37, v38
  v_max3_f32 v250, v250, v39, v40
  v_max3_f32 v250, v250, v41, v42
  v_max3_f32 v250, v250, v43, v44
  v_max3_f32 v250, v250, v45, v46
  v_max_f32 v250, v250, v47
  v_mov_b32 v251, v250
  s_nop 1
  v_permlane32_swap_b32 v250, v251
  s_nop 0
  v_max3_f32 v250, v250, v251, v102
  v_sub_f32 v251, v102, v250
  v_exp_f32 v251, v251
  v_mov_b32 v102, v250
  v_mul_f32 v92, v92, v251
  v_sub_f32 v32, v32, v250
  v_sub_f32 v33, v33, v250
  v_sub_f32 v34, v34, v250
  v_sub_f32 v35, v35, v250
  v_sub_f32 v36, v36, v250
  v_sub_f32 v37, v37, v250
  v_sub_f32 v38, v38, v250
  v_sub_f32 v39, v39, v250
  v_sub_f32 v40, v40, v250
  v_sub_f32 v41, v41, v250
  v_sub_f32 v42, v42, v250
  v_sub_f32 v43, v43, v250
  v_sub_f32 v44, v44, v250
  v_sub_f32 v45, v45, v250
  v_sub_f32 v46, v46, v250
  v_sub_f32 v47, v47, v250
  v_exp_f32 v32, v32
  v_exp_f32 v33, v33
  v_exp_f32 v34, v34
  v_exp_f32 v35, v35
  v_exp_f32 v36, v36
  v_exp_f32 v37, v37
  v_exp_f32 v38, v38
  v_exp_f32 v39, v39
  v_exp_f32 v40, v40
  v_exp_f32 v41, v41
  v_exp_f32 v42, v42
  v_exp_f32 v43, v43
  v_exp_f32 v44, v44
  v_exp_f32 v45, v45
  v_exp_f32 v46, v46
  v_exp_f32 v47, v47
  s_nop 0
  v_add_f32 v92, v92, v32
  v_add_f32 v92, v92, v33
  v_add_f32 v92, v92, v34
  v_add_f32 v92, v92, v35
  v_add_f32 v92, v92, v36
  v_add_f32 v92, v92, v37
  v_add_f32 v92, v92, v38
  v_add_f32 v92, v92, v39
  v_add_f32 v92, v92, v40
  v_add_f32 v92, v92, v41
  v_add_f32 v92, v92, v42
  v_add_f32 v92, v92, v43
  v_add_f32 v92, v92, v44
  v_add_f32 v92, v92, v45
  v_add_f32 v92, v92, v46
  v_add_f32 v92, v92, v47
  v_cvt_pk_bf16_f32 v64, v32, v33
  v_cvt_pk_bf16_f32 v65, v34, v35
  v_cvt_pk_bf16_f32 v66, v36, v37
  v_cvt_pk_bf16_f32 v67, v38, v39
  v_cvt_pk_bf16_f32 v68, v40, v41
  v_cvt_pk_bf16_f32 v69, v42, v43
  v_cvt_pk_bf16_f32 v70, v44, v45
  v_cvt_pk_bf16_f32 v71, v46, v47
  v_accvgpr_read_b32 v252, a0
  s_nop 0
  v_mul_f32 v252, v252, v251
  s_nop 0
  v_accvgpr_write_b32 a0, v252
  v_accvgpr_read_b32 v252, a1
  s_nop 0
  v_mul_f32 v252, v252, v251
  s_nop 0
  v_accvgpr_write_b32 a1, v252
  v_accvgpr_read_b32 v252, a2
  s_nop 0
  v_mul_f32 v252, v252, v251
  s_nop 0
  v_accvgpr_write_b32 a2, v252
  v_accvgpr_read_b32 v252, a3
  s_nop 0
  v_mul_f32 v252, v252, v251
  s_nop 0
  v_accvgpr_write_b32 a3, v252
  v_accvgpr_read_b32 v252, a4
  s_nop 0
  v_mul_f32 v252, v252, v251
  s_nop 0
  v_accvgpr_write_b32 a4, v252
  v_accvgpr_read_b32 v252, a5
  s_nop 0
  v_mul_f32 v252, v252, v251
  s_nop 0
  v_accvgpr_write_b32 a5, v252
  v_accvgpr_read_b32 v252, a6
  s_nop 0
  v_mul_f32 v252, v252, v251
  s_nop 0
  v_accvgpr_write_b32 a6, v252
  v_accvgpr_read_b32 v252, a7
  s_nop 0
  v_mul_f32 v252, v252, v251
  s_nop 0
  v_accvgpr_write_b32 a7, v252
  v_accvgpr_read_b32 v252, a8
  s_nop 0
  v_mul_f32 v252, v252, v251
  s_nop 0
  v_accvgpr_write_b32 a8, v252
  v_accvgpr_read_b32 v252, a9
  s_nop 0
  v_mul_f32 v252, v252, v251
  s_nop 0
  v_accvgpr_write_b32 a9, v252
  v_accvgpr_read_b32 v252, a10
  s_nop 0
  v_mul_f32 v252, v252, v251
  s_nop 0
  v_accvgpr_write_b32 a10, v252
  v_accvgpr_read_b32 v252, a11
  s_nop 0
  v_mul_f32 v252, v252, v251
  s_nop 0
  v_accvgpr_write_b32 a11, v252
  v_accvgpr_read_b32 v252, a12
  s_nop 0
  v_mul_f32 v252, v252, v251
  s_nop 0
  v_accvgpr_write_b32 a12, v252
  v_accvgpr_read_b32 v252, a13
  s_nop 0
  v_mul_f32 v252, v252, v251
  s_nop 0
  v_accvgpr_write_b32 a13, v252
  v_accvgpr_read_b32 v252, a14
  s_nop 0
  v_mul_f32 v252, v252, v251
  s_nop 0
  v_accvgpr_write_b32 a14, v252
  v_accvgpr_read_b32 v252, a15
  s_nop 0
  v_mul_f32 v252, v252, v251
  s_nop 0
  v_accvgpr_write_b32 a15, v252
  v_accvgpr_read_b32 v252, a16
  s_nop 0
  v_mul_f32 v252, v252, v251
  s_nop 0
  v_accvgpr_write_b32 a16, v252
  v_accvgpr_read_b32 v252, a17
  s_nop 0
  v_mul_f32 v252, v252, v251
  s_nop 0
  v_accvgpr_write_b32 a17, v252
  v_accvgpr_read_b32 v252, a18
  s_nop 0
  v_mul_f32 v252, v252, v251
  s_nop 0
  v_accvgpr_write_b32 a18, v252
  v_accvgpr_read_b32 v252, a19
  s_nop 0
  v_mul_f32 v252, v252, v251
  s_nop 0
  v_accvgpr_write_b32 a19, v252
  v_accvgpr_read_b32 v252, a20
  s_nop 0
  v_mul_f32 v252, v252, v251
  s_nop 0
  v_accvgpr_write_b32 a20, v252
  v_accvgpr_read_b32 v252, a21
  s_nop 0
  v_mul_f32 v252, v252, v251
  s_nop 0
  v_accvgpr_write_b32 a21, v252
  v_accvgpr_read_b32 v252, a22
  s_nop 0
  v_mul_f32 v252, v252, v251
  s_nop 0
  v_accvgpr_write_b32 a22, v252
  v_accvgpr_read_b32 v252, a23
  s_nop 0
  v_mul_f32 v252, v252, v251
  s_nop 0
  v_accvgpr_write_b32 a23, v252
  v_accvgpr_read_b32 v252, a24
  s_nop 0
  v_mul_f32 v252, v252, v251
  s_nop 0
  v_accvgpr_write_b32 a24, v252
  v_accvgpr_read_b32 v252, a25
  s_nop 0
  v_mul_f32 v252, v252, v251
  s_nop 0
  v_accvgpr_write_b32 a25, v252
  v_accvgpr_read_b32 v252, a26
  s_nop 0
  v_mul_f32 v252, v252, v251
  s_nop 0
  v_accvgpr_write_b32 a26, v252
  v_accvgpr_read_b32 v252, a27
  s_nop 0
  v_mul_f32 v252, v252, v251
  s_nop 0
  v_accvgpr_write_b32 a27, v252
  v_accvgpr_read_b32 v252, a28
  s_nop 0
  v_mul_f32 v252, v252, v251
  s_nop 0
  v_accvgpr_write_b32 a28, v252
  v_accvgpr_read_b32 v252, a29
  s_nop 0
  v_mul_f32 v252, v252, v251
  s_nop 0
  v_accvgpr_write_b32 a29, v252
  v_accvgpr_read_b32 v252, a30
  s_nop 0
  v_mul_f32 v252, v252, v251
  s_nop 0
  v_accvgpr_write_b32 a30, v252
  v_accvgpr_read_b32 v252, a31
  s_nop 0
  v_mul_f32 v252, v252, v251
  s_nop 0
  v_accvgpr_write_b32 a31, v252
  v_accvgpr_read_b32 v252, a32
  s_nop 0
  v_mul_f32 v252, v252, v251
  s_nop 0
  v_accvgpr_write_b32 a32, v252
  v_accvgpr_read_b32 v252, a33
  s_nop 0
  v_mul_f32 v252, v252, v251
  s_nop 0
  v_accvgpr_write_b32 a33, v252
  v_accvgpr_read_b32 v252, a34
  s_nop 0
  v_mul_f32 v252, v252, v251
  s_nop 0
  v_accvgpr_write_b32 a34, v252
  v_accvgpr_read_b32 v252, a35
  s_nop 0
  v_mul_f32 v252, v252, v251
  s_nop 0
  v_accvgpr_write_b32 a35, v252
  v_accvgpr_read_b32 v252, a36
  s_nop 0
  v_mul_f32 v252, v252, v251
  s_nop 0
  v_accvgpr_write_b32 a36, v252
  v_accvgpr_read_b32 v252, a37
  s_nop 0
  v_mul_f32 v252, v252, v251
  s_nop 0
  v_accvgpr_write_b32 a37, v252
  v_accvgpr_read_b32 v252, a38
  s_nop 0
  v_mul_f32 v252, v252, v251
  s_nop 0
  v_accvgpr_write_b32 a38, v252
  v_accvgpr_read_b32 v252, a39
  s_nop 0
  v_mul_f32 v252, v252, v251
  s_nop 0
  v_accvgpr_write_b32 a39, v252
  v_accvgpr_read_b32 v252, a40
  s_nop 0
  v_mul_f32 v252, v252, v251
  s_nop 0
  v_accvgpr_write_b32 a40, v252
  v_accvgpr_read_b32 v252, a41
  s_nop 0
  v_mul_f32 v252, v252, v251
  s_nop 0
  v_accvgpr_write_b32 a41, v252
  v_accvgpr_read_b32 v252, a42
  s_nop 0
  v_mul_f32 v252, v252, v251
  s_nop 0
  v_accvgpr_write_b32 a42, v252
  v_accvgpr_read_b32 v252, a43
  s_nop 0
  v_mul_f32 v252, v252, v251
  s_nop 0
  v_accvgpr_write_b32 a43, v252
  v_accvgpr_read_b32 v252, a44
  s_nop 0
  v_mul_f32 v252, v252, v251
  s_nop 0
  v_accvgpr_write_b32 a44, v252
  v_accvgpr_read_b32 v252, a45
  s_nop 0
  v_mul_f32 v252, v252, v251
  s_nop 0
  v_accvgpr_write_b32 a45, v252
  v_accvgpr_read_b32 v252, a46
  s_nop 0
  v_mul_f32 v252, v252, v251
  s_nop 0
  v_accvgpr_write_b32 a46, v252
  v_accvgpr_read_b32 v252, a47
  s_nop 0
  v_mul_f32 v252, v252, v251
  s_nop 0
  v_accvgpr_write_b32 a47, v252
  v_accvgpr_read_b32 v252, a48
  s_nop 0
  v_mul_f32 v252, v252, v251
  s_nop 0
  v_accvgpr_write_b32 a48, v252
  v_accvgpr_read_b32 v252, a49
  s_nop 0
  v_mul_f32 v252, v252, v251
  s_nop 0
  v_accvgpr_write_b32 a49, v252
  v_accvgpr_read_b32 v252, a50
  s_nop 0
  v_mul_f32 v252, v252, v251
  s_nop 0
  v_accvgpr_write_b32 a50, v252
  v_accvgpr_read_b32 v252, a51
  s_nop 0
  v_mul_f32 v252, v252, v251
  s_nop 0
  v_accvgpr_write_b32 a51, v252
  v_accvgpr_read_b32 v252, a52
  s_nop 0
  v_mul_f32 v252, v252, v251
  s_nop 0
  v_accvgpr_write_b32 a52, v252
  v_accvgpr_read_b32 v252, a53
  s_nop 0
  v_mul_f32 v252, v252, v251
  s_nop 0
  v_accvgpr_write_b32 a53, v252
  v_accvgpr_read_b32 v252, a54
  s_nop 0
  v_mul_f32 v252, v252, v251
  s_nop 0
  v_accvgpr_write_b32 a54, v252
  v_accvgpr_read_b32 v252, a55
  s_nop 0
  v_mul_f32 v252, v252, v251
  s_nop 0
  v_accvgpr_write_b32 a55, v252
  v_accvgpr_read_b32 v252, a56
  s_nop 0
  v_mul_f32 v252, v252, v251
  s_nop 0
  v_accvgpr_write_b32 a56, v252
  v_accvgpr_read_b32 v252, a57
  s_nop 0
  v_mul_f32 v252, v252, v251
  s_nop 0
  v_accvgpr_write_b32 a57, v252
  v_accvgpr_read_b32 v252, a58
  s_nop 0
  v_mul_f32 v252, v252, v251
  s_nop 0
  v_accvgpr_write_b32 a58, v252
  v_accvgpr_read_b32 v252, a59
  s_nop 0
  v_mul_f32 v252, v252, v251
  s_nop 0
  v_accvgpr_write_b32 a59, v252
  v_accvgpr_read_b32 v252, a60
  s_nop 0
  v_mul_f32 v252, v252, v251
  s_nop 0
  v_accvgpr_write_b32 a60, v252
  v_accvgpr_read_b32 v252, a61
  s_nop 0
  v_mul_f32 v252, v252, v251
  s_nop 0
  v_accvgpr_write_b32 a61, v252
  v_accvgpr_read_b32 v252, a62
  s_nop 0
  v_mul_f32 v252, v252, v251
  s_nop 0
  v_accvgpr_write_b32 a62, v252
  v_accvgpr_read_b32 v252, a63
  s_nop 0
  v_mul_f32 v252, v252, v251
  s_nop 0
  v_accvgpr_write_b32 a63, v252
  v_max3_f32 v250, v48, v49, v50
  v_max3_f32 v250, v250, v51, v52
  v_max3_f32 v250, v250, v53, v54
  v_max3_f32 v250, v250, v55, v56
  v_max3_f32 v250, v250, v57, v58
  v_max3_f32 v250, v250, v59, v60
  v_max3_f32 v250, v250, v61, v62
  v_max_f32 v250, v250, v63
  v_mov_b32 v251, v250
  s_nop 1
  v_permlane32_swap_b32 v250, v251
  s_nop 0
  v_max3_f32 v250, v250, v251, v103
  v_sub_f32 v251, v103, v250
  v_exp_f32 v251, v251
  v_mov_b32 v103, v250
  v_mul_f32 v94, v94, v251
  v_sub_f32 v48, v48, v250
  v_sub_f32 v49, v49, v250
  v_sub_f32 v50, v50, v250
  v_sub_f32 v51, v51, v250
  v_sub_f32 v52, v52, v250
  v_sub_f32 v53, v53, v250
  v_sub_f32 v54, v54, v250
  v_sub_f32 v55, v55, v250
  v_sub_f32 v56, v56, v250
  v_sub_f32 v57, v57, v250
  v_sub_f32 v58, v58, v250
  v_sub_f32 v59, v59, v250
  v_sub_f32 v60, v60, v250
  v_sub_f32 v61, v61, v250
  v_sub_f32 v62, v62, v250
  v_sub_f32 v63, v63, v250
  v_exp_f32 v48, v48
  v_exp_f32 v49, v49
  v_exp_f32 v50, v50
  v_exp_f32 v51, v51
  v_exp_f32 v52, v52
  v_exp_f32 v53, v53
  v_exp_f32 v54, v54
  v_exp_f32 v55, v55
  v_exp_f32 v56, v56
  v_exp_f32 v57, v57
  v_exp_f32 v58, v58
  v_exp_f32 v59, v59
  v_exp_f32 v60, v60
  v_exp_f32 v61, v61
  v_exp_f32 v62, v62
  v_exp_f32 v63, v63
  s_nop 0
  v_add_f32 v94, v94, v48
  v_add_f32 v94, v94, v49
  v_add_f32 v94, v94, v50
  v_add_f32 v94, v94, v51
  v_add_f32 v94, v94, v52
  v_add_f32 v94, v94, v53
  v_add_f32 v94, v94, v54
  v_add_f32 v94, v94, v55
  v_add_f32 v94, v94, v56
  v_add_f32 v94, v94, v57
  v_add_f32 v94, v94, v58
  v_add_f32 v94, v94, v59
  v_add_f32 v94, v94, v60
  v_add_f32 v94, v94, v61
  v_add_f32 v94, v94, v62
  v_add_f32 v94, v94, v63
  v_cvt_pk_bf16_f32 v72, v48, v49
  v_cvt_pk_bf16_f32 v73, v50, v51
  v_cvt_pk_bf16_f32 v74, v52, v53
  v_cvt_pk_bf16_f32 v75, v54, v55
  v_cvt_pk_bf16_f32 v76, v56, v57
  v_cvt_pk_bf16_f32 v77, v58, v59
  v_cvt_pk_bf16_f32 v78, v60, v61
  v_cvt_pk_bf16_f32 v79, v62, v63
  v_accvgpr_read_b32 v252, a64
  s_nop 0
  v_mul_f32 v252, v252, v251
  s_nop 0
  v_accvgpr_write_b32 a64, v252
  v_accvgpr_read_b32 v252, a65
  s_nop 0
  v_mul_f32 v252, v252, v251
  s_nop 0
  v_accvgpr_write_b32 a65, v252
  v_accvgpr_read_b32 v252, a66
  s_nop 0
  v_mul_f32 v252, v252, v251
  s_nop 0
  v_accvgpr_write_b32 a66, v252
  v_accvgpr_read_b32 v252, a67
  s_nop 0
  v_mul_f32 v252, v252, v251
  s_nop 0
  v_accvgpr_write_b32 a67, v252
  v_accvgpr_read_b32 v252, a68
  s_nop 0
  v_mul_f32 v252, v252, v251
  s_nop 0
  v_accvgpr_write_b32 a68, v252
  v_accvgpr_read_b32 v252, a69
  s_nop 0
  v_mul_f32 v252, v252, v251
  s_nop 0
  v_accvgpr_write_b32 a69, v252
  v_accvgpr_read_b32 v252, a70
  s_nop 0
  v_mul_f32 v252, v252, v251
  s_nop 0
  v_accvgpr_write_b32 a70, v252
  v_accvgpr_read_b32 v252, a71
  s_nop 0
  v_mul_f32 v252, v252, v251
  s_nop 0
  v_accvgpr_write_b32 a71, v252
  v_accvgpr_read_b32 v252, a72
  s_nop 0
  v_mul_f32 v252, v252, v251
  s_nop 0
  v_accvgpr_write_b32 a72, v252
  v_accvgpr_read_b32 v252, a73
  s_nop 0
  v_mul_f32 v252, v252, v251
  s_nop 0
  v_accvgpr_write_b32 a73, v252
  v_accvgpr_read_b32 v252, a74
  s_nop 0
  v_mul_f32 v252, v252, v251
  s_nop 0
  v_accvgpr_write_b32 a74, v252
  v_accvgpr_read_b32 v252, a75
  s_nop 0
  v_mul_f32 v252, v252, v251
  s_nop 0
  v_accvgpr_write_b32 a75, v252
  v_accvgpr_read_b32 v252, a76
  s_nop 0
  v_mul_f32 v252, v252, v251
  s_nop 0
  v_accvgpr_write_b32 a76, v252
  v_accvgpr_read_b32 v252, a77
  s_nop 0
  v_mul_f32 v252, v252, v251
  s_nop 0
  v_accvgpr_write_b32 a77, v252
  v_accvgpr_read_b32 v252, a78
  s_nop 0
  v_mul_f32 v252, v252, v251
  s_nop 0
  v_accvgpr_write_b32 a78, v252
  v_accvgpr_read_b32 v252, a79
  s_nop 0
  v_mul_f32 v252, v252, v251
  s_nop 0
  v_accvgpr_write_b32 a79, v252
  v_accvgpr_read_b32 v252, a80
  s_nop 0
  v_mul_f32 v252, v252, v251
  s_nop 0
  v_accvgpr_write_b32 a80, v252
  v_accvgpr_read_b32 v252, a81
  s_nop 0
  v_mul_f32 v252, v252, v251
  s_nop 0
  v_accvgpr_write_b32 a81, v252
  v_accvgpr_read_b32 v252, a82
  s_nop 0
  v_mul_f32 v252, v252, v251
  s_nop 0
  v_accvgpr_write_b32 a82, v252
  v_accvgpr_read_b32 v252, a83
  s_nop 0
  v_mul_f32 v252, v252, v251
  s_nop 0
  v_accvgpr_write_b32 a83, v252
  v_accvgpr_read_b32 v252, a84
  s_nop 0
  v_mul_f32 v252, v252, v251
  s_nop 0
  v_accvgpr_write_b32 a84, v252
  v_accvgpr_read_b32 v252, a85
  s_nop 0
  v_mul_f32 v252, v252, v251
  s_nop 0
  v_accvgpr_write_b32 a85, v252
  v_accvgpr_read_b32 v252, a86
  s_nop 0
  v_mul_f32 v252, v252, v251
  s_nop 0
  v_accvgpr_write_b32 a86, v252
  v_accvgpr_read_b32 v252, a87
  s_nop 0
  v_mul_f32 v252, v252, v251
  s_nop 0
  v_accvgpr_write_b32 a87, v252
  v_accvgpr_read_b32 v252, a88
  s_nop 0
  v_mul_f32 v252, v252, v251
  s_nop 0
  v_accvgpr_write_b32 a88, v252
  v_accvgpr_read_b32 v252, a89
  s_nop 0
  v_mul_f32 v252, v252, v251
  s_nop 0
  v_accvgpr_write_b32 a89, v252
  v_accvgpr_read_b32 v252, a90
  s_nop 0
  v_mul_f32 v252, v252, v251
  s_nop 0
  v_accvgpr_write_b32 a90, v252
  v_accvgpr_read_b32 v252, a91
  s_nop 0
  v_mul_f32 v252, v252, v251
  s_nop 0
  v_accvgpr_write_b32 a91, v252
  v_accvgpr_read_b32 v252, a92
  s_nop 0
  v_mul_f32 v252, v252, v251
  s_nop 0
  v_accvgpr_write_b32 a92, v252
  v_accvgpr_read_b32 v252, a93
  s_nop 0
  v_mul_f32 v252, v252, v251
  s_nop 0
  v_accvgpr_write_b32 a93, v252
  v_accvgpr_read_b32 v252, a94
  s_nop 0
  v_mul_f32 v252, v252, v251
  s_nop 0
  v_accvgpr_write_b32 a94, v252
  v_accvgpr_read_b32 v252, a95
  s_nop 0
  v_mul_f32 v252, v252, v251
  s_nop 0
  v_accvgpr_write_b32 a95, v252
  v_accvgpr_read_b32 v252, a96
  s_nop 0
  v_mul_f32 v252, v252, v251
  s_nop 0
  v_accvgpr_write_b32 a96, v252
  v_accvgpr_read_b32 v252, a97
  s_nop 0
  v_mul_f32 v252, v252, v251
  s_nop 0
  v_accvgpr_write_b32 a97, v252
  v_accvgpr_read_b32 v252, a98
  s_nop 0
  v_mul_f32 v252, v252, v251
  s_nop 0
  v_accvgpr_write_b32 a98, v252
  v_accvgpr_read_b32 v252, a99
  s_nop 0
  v_mul_f32 v252, v252, v251
  s_nop 0
  v_accvgpr_write_b32 a99, v252
  v_accvgpr_read_b32 v252, a100
  s_nop 0
  v_mul_f32 v252, v252, v251
  s_nop 0
  v_accvgpr_write_b32 a100, v252
  v_accvgpr_read_b32 v252, a101
  s_nop 0
  v_mul_f32 v252, v252, v251
  s_nop 0
  v_accvgpr_write_b32 a101, v252
  v_accvgpr_read_b32 v252, a102
  s_nop 0
  v_mul_f32 v252, v252, v251
  s_nop 0
  v_accvgpr_write_b32 a102, v252
  v_accvgpr_read_b32 v252, a103
  s_nop 0
  v_mul_f32 v252, v252, v251
  s_nop 0
  v_accvgpr_write_b32 a103, v252
  v_accvgpr_read_b32 v252, a104
  s_nop 0
  v_mul_f32 v252, v252, v251
  s_nop 0
  v_accvgpr_write_b32 a104, v252
  v_accvgpr_read_b32 v252, a105
  s_nop 0
  v_mul_f32 v252, v252, v251
  s_nop 0
  v_accvgpr_write_b32 a105, v252
  v_accvgpr_read_b32 v252, a106
  s_nop 0
  v_mul_f32 v252, v252, v251
  s_nop 0
  v_accvgpr_write_b32 a106, v252
  v_accvgpr_read_b32 v252, a107
  s_nop 0
  v_mul_f32 v252, v252, v251
  s_nop 0
  v_accvgpr_write_b32 a107, v252
  v_accvgpr_read_b32 v252, a108
  s_nop 0
  v_mul_f32 v252, v252, v251
  s_nop 0
  v_accvgpr_write_b32 a108, v252
  v_accvgpr_read_b32 v252, a109
  s_nop 0
  v_mul_f32 v252, v252, v251
  s_nop 0
  v_accvgpr_write_b32 a109, v252
  v_accvgpr_read_b32 v252, a110
  s_nop 0
  v_mul_f32 v252, v252, v251
  s_nop 0
  v_accvgpr_write_b32 a110, v252
  v_accvgpr_read_b32 v252, a111
  s_nop 0
  v_mul_f32 v252, v252, v251
  s_nop 0
  v_accvgpr_write_b32 a111, v252
  v_accvgpr_read_b32 v252, a112
  s_nop 0
  v_mul_f32 v252, v252, v251
  s_nop 0
  v_accvgpr_write_b32 a112, v252
  v_accvgpr_read_b32 v252, a113
  s_nop 0
  v_mul_f32 v252, v252, v251
  s_nop 0
  v_accvgpr_write_b32 a113, v252
  v_accvgpr_read_b32 v252, a114
  s_nop 0
  v_mul_f32 v252, v252, v251
  s_nop 0
  v_accvgpr_write_b32 a114, v252
  v_accvgpr_read_b32 v252, a115
  s_nop 0
  v_mul_f32 v252, v252, v251
  s_nop 0
  v_accvgpr_write_b32 a115, v252
  v_accvgpr_read_b32 v252, a116
  s_nop 0
  v_mul_f32 v252, v252, v251
  s_nop 0
  v_accvgpr_write_b32 a116, v252
  v_accvgpr_read_b32 v252, a117
  s_nop 0
  v_mul_f32 v252, v252, v251
  s_nop 0
  v_accvgpr_write_b32 a117, v252
  v_accvgpr_read_b32 v252, a118
  s_nop 0
  v_mul_f32 v252, v252, v251
  s_nop 0
  v_accvgpr_write_b32 a118, v252
  v_accvgpr_read_b32 v252, a119
  s_nop 0
  v_mul_f32 v252, v252, v251
  s_nop 0
  v_accvgpr_write_b32 a119, v252
  v_accvgpr_read_b32 v252, a120
  s_nop 0
  v_mul_f32 v252, v252, v251
  s_nop 0
  v_accvgpr_write_b32 a120, v252
  v_accvgpr_read_b32 v252, a121
  s_nop 0
  v_mul_f32 v252, v252, v251
  s_nop 0
  v_accvgpr_write_b32 a121, v252
  v_accvgpr_read_b32 v252, a122
  s_nop 0
  v_mul_f32 v252, v252, v251
  s_nop 0
  v_accvgpr_write_b32 a122, v252
  v_accvgpr_read_b32 v252, a123
  s_nop 0
  v_mul_f32 v252, v252, v251
  s_nop 0
  v_accvgpr_write_b32 a123, v252
  v_accvgpr_read_b32 v252, a124
  s_nop 0
  v_mul_f32 v252, v252, v251
  s_nop 0
  v_accvgpr_write_b32 a124, v252
  v_accvgpr_read_b32 v252, a125
  s_nop 0
  v_mul_f32 v252, v252, v251
  s_nop 0
  v_accvgpr_write_b32 a125, v252
  v_accvgpr_read_b32 v252, a126
  s_nop 0
  v_mul_f32 v252, v252, v251
  s_nop 0
  v_accvgpr_write_b32 a126, v252
  v_accvgpr_read_b32 v252, a127
  s_nop 0
  v_mul_f32 v252, v252, v251
  s_nop 0
  v_accvgpr_write_b32 a127, v252
  s_waitcnt vmcnt(0)
  ds_read_b64_tr_b16 a[160:161], v112 offset:0
  ds_read_b64_tr_b16 a[162:163], v112 offset:2048
  ds_read_b64_tr_b16 a[164:165], v112 offset:4096
  ds_read_b64_tr_b16 a[166:167], v112 offset:6144
  ds_read_b64_tr_b16 a[168:169], v113 offset:0
  ds_read_b64_tr_b16 a[170:171], v113 offset:2048
  ds_read_b64_tr_b16 a[172:173], v113 offset:4096
  ds_read_b64_tr_b16 a[174:175], v113 offset:6144
  ds_read_b64_tr_b16 a[176:177], v114 offset:0
  ds_read_b64_tr_b16 a[178:179], v114 offset:2048
  ds_read_b64_tr_b16 a[180:181], v114 offset:4096
  ds_read_b64_tr_b16 a[182:183], v114 offset:6144
  ds_read_b64_tr_b16 a[184:185], v115 offset:0
  ds_read_b64_tr_b16 a[186:187], v115 offset:2048
  ds_read_b64_tr_b16 a[188:189], v115 offset:4096
  ds_read_b64_tr_b16 a[190:191], v115 offset:6144
  s_waitcnt lgkmcnt(0)
  v_mfma_f32_32x32x16_bf16 a[0:15], a[160:163], v[64:67], a[0:15]
  v_mfma_f32_32x32x16_bf16 a[16:31], a[168:171], v[64:67], a[16:31]
  v_mfma_f32_32x32x16_bf16 a[32:47], a[176:179], v[64:67], a[32:47]
  v_mfma_f32_32x32x16_bf16 a[48:63], a[184:187], v[64:67], a[48:63]
  v_mfma_f32_32x32x16_bf16 a[0:15], a[164:167], v[68:71], a[0:15]
  v_mfma_f32_32x32x16_bf16 a[16:31], a[172:175], v[68:71], a[16:31]
  v_mfma_f32_32x32x16_bf16 a[32:47], a[180:183], v[68:71], a[32:47]
  v_mfma_f32_32x32x16_bf16 a[48:63], a[188:191], v[68:71], a[48:63]
  v_mfma_f32_32x32x16_bf16 a[64:79], a[160:163], v[72:75], a[64:79]
  v_mfma_f32_32x32x16_bf16 a[80:95], a[168:171], v[72:75], a[80:95]
  v_mfma_f32_32x32x16_bf16 a[96:111], a[176:179], v[72:75], a[96:111]
  v_mfma_f32_32x32x16_bf16 a[112:127], a[184:187], v[72:75], a[112:127]
  v_mfma_f32_32x32x16_bf16 a[64:79], a[164:167], v[76:79], a[64:79]
  v_mfma_f32_32x32x16_bf16 a[80:95], a[172:175], v[76:79], a[80:95]
  v_mfma_f32_32x32x16_bf16 a[96:111], a[180:183], v[76:79], a[96:111]
  v_mfma_f32_32x32x16_bf16 a[112:127], a[188:191], v[76:79], a[112:127]
  s_nop 7
  s_nop 7
  s_add_u32 s61, s61, 8192
  s_cmp_lt_u32 s61, 131072
  s_cbranch_scc1 L1_fb_loop
  v_add_f32 v92, v92, v93
  s_nop 0
  v_mov_b32 v93, v92
  s_nop 1
  v_permlane32_swap_b32 v92, v93
  s_nop 0
  v_add_f32 v92, v92, v93
  s_nop 0
  v_rcp_f32 v98, v92
  s_nop 0
  v_mov_b32 v99, v98
  v_add_f32 v94, v94, v95
  s_nop 0
  v_mov_b32 v95, v94
  s_nop 1
  v_permlane32_swap_b32 v94, v95
  s_nop 0
  v_add_f32 v94, v94, v95
  s_nop 0
  v_rcp_f32 v100, v94
  s_nop 0
  v_mov_b32 v101, v100
  v_bfe_u32 v250, v255, 4, 1
  v_lshrrev_b32 v251, 5, v255
  v_and_b32 v252, 15, v255
  v_lshlrev_b32 v250, 10, v250
  v_lshl_add_u32 v250, v251, 8, v250
  v_lshl_add_u32 v250, v252, 4, v250
  s_lshr_b32 s6, s5, 1
  s_lshl_b32 s6, s6, 16
  s_and_b32 s7, s5, 1
  s_lshl_b32 s7, s7, 14
  s_add_u32 s6, s6, s7
  v_add_u32 v96, s6, v250
  v_accvgpr_read_b32 v104, a0
  v_accvgpr_read_b32 v105, a1
  v_accvgpr_read_b32 v106, a2
  v_accvgpr_read_b32 v107, a3
  v_accvgpr_read_b32 v108, a4
  v_accvgpr_read_b32 v109, a5
  v_accvgpr_read_b32 v110, a6
  v_accvgpr_read_b32 v111, a7
  v_pk_mul_f32 v[104:105], v[104:105], v[98:99]
  v_pk_mul_f32 v[106:107], v[106:107], v[98:99]
  v_pk_mul_f32 v[108:109], v[108:109], v[98:99]
  v_pk_mul_f32 v[110:111], v[110:111], v[98:99]
  v_cvt_pk_bf16_f32 v104, v104, v105
  v_cvt_pk_bf16_f32 v105, v106, v107
  v_cvt_pk_bf16_f32 v106, v108, v109
  v_cvt_pk_bf16_f32 v107, v110, v111
  v_accvgpr_read_b32 v112, a8
  v_accvgpr_read_b32 v113, a9
  v_accvgpr_read_b32 v114, a10
  v_accvgpr_read_b32 v115, a11
  ds_write_b128 v96, v[104:107] offset:0
  v_accvgpr_read_b32 v116, a12
  v_accvgpr_read_b32 v117, a13
  v_accvgpr_read_b32 v118, a14
  v_accvgpr_read_b32 v119, a15
  v_pk_mul_f32 v[112:113], v[112:113], v[98:99]
  v_pk_mul_f32 v[114:115], v[114:115], v[98:99]
  v_pk_mul_f32 v[116:117], v[116:117], v[98:99]
  v_pk_mul_f32 v[118:119], v[118:119], v[98:99]
  v_cvt_pk_bf16_f32 v112, v112, v113
  v_cvt_pk_bf16_f32 v113, v114, v115
  v_cvt_pk_bf16_f32 v114, v116, v117
  v_cvt_pk_bf16_f32 v115, v118, v119
  v_accvgpr_read_b32 v104, a16
  v_accvgpr_read_b32 v105, a17
  v_accvgpr_read_b32 v106, a18
  v_accvgpr_read_b32 v107, a19
  ds_write_b128 v96, v[112:115] offset:512
  v_accvgpr_read_b32 v108, a20
  v_accvgpr_read_b32 v109, a21
  v_accvgpr_read_b32 v110, a22
  v_accvgpr_read_b32 v111, a23
  v_pk_mul_f32 v[104:105], v[104:105], v[98:99]
  v_pk_mul_f32 v[106:107], v[106:107], v[98:99]
  v_pk_mul_f32 v[108:109], v[108:109], v[98:99]
  v_pk_mul_f32 v[110:111], v[110:111], v[98:99]
  v_cvt_pk_bf16_f32 v104, v104, v105
  v_cvt_pk_bf16_f32 v105, v106, v107
  v_cvt_pk_bf16_f32 v106, v108, v109
  v_cvt_pk_bf16_f32 v107, v110, v111
  v_accvgpr_read_b32 v112, a24
  v_accvgpr_read_b32 v113, a25
  v_accvgpr_read_b32 v114, a26
  v_accvgpr_read_b32 v115, a27
  ds_write_b128 v96, v[104:107] offset:4096
  v_accvgpr_read_b32 v116, a28
  v_accvgpr_read_b32 v117, a29
  v_accvgpr_read_b32 v118, a30
  v_accvgpr_read_b32 v119, a31
  v_pk_mul_f32 v[112:113], v[112:113], v[98:99]
  v_pk_mul_f32 v[114:115], v[114:115], v[98:99]
  v_pk_mul_f32 v[116:117], v[116:117], v[98:99]
  v_pk_mul_f32 v[118:119], v[118:119], v[98:99]
  v_cvt_pk_bf16_f32 v112, v112, v113
  v_cvt_pk_bf16_f32 v113, v114, v115
  v_cvt_pk_bf16_f32 v114, v116, v117
  v_cvt_pk_bf16_f32 v115, v118, v119
  v_accvgpr_read_b32 v104, a32
  v_accvgpr_read_b32 v105, a33
  v_accvgpr_read_b32 v106, a34
  v_accvgpr_read_b32 v107, a35
  ds_write_b128 v96, v[112:115] offset:4608
  v_accvgpr_read_b32 v108, a36
  v_accvgpr_read_b32 v109, a37
  v_accvgpr_read_b32 v110, a38
  v_accvgpr_read_b32 v111, a39
  v_pk_mul_f32 v[104:105], v[104:105], v[98:99]
  v_pk_mul_f32 v[106:107], v[106:107], v[98:99]
  v_pk_mul_f32 v[108:109], v[108:109], v[98:99]
  v_pk_mul_f32 v[110:111], v[110:111], v[98:99]
  v_cvt_pk_bf16_f32 v104, v104, v105
  v_cvt_pk_bf16_f32 v105, v106, v107
  v_cvt_pk_bf16_f32 v106, v108, v109
  v_cvt_pk_bf16_f32 v107, v110, v111
  v_accvgpr_read_b32 v112, a40
  v_accvgpr_read_b32 v113, a41
  v_accvgpr_read_b32 v114, a42
  v_accvgpr_read_b32 v115, a43
  ds_write_b128 v96, v[104:107] offset:8192
  v_accvgpr_read_b32 v116, a44
  v_accvgpr_read_b32 v117, a45
  v_accvgpr_read_b32 v118, a46
  v_accvgpr_read_b32 v119, a47
  v_pk_mul_f32 v[112:113], v[112:113], v[98:99]
  v_pk_mul_f32 v[114:115], v[114:115], v[98:99]
  v_pk_mul_f32 v[116:117], v[116:117], v[98:99]
  v_pk_mul_f32 v[118:119], v[118:119], v[98:99]
  v_cvt_pk_bf16_f32 v112, v112, v113
  v_cvt_pk_bf16_f32 v113, v114, v115
  v_cvt_pk_bf16_f32 v114, v116, v117
  v_cvt_pk_bf16_f32 v115, v118, v119
  v_accvgpr_read_b32 v104, a48
  v_accvgpr_read_b32 v105, a49
  v_accvgpr_read_b32 v106, a50
  v_accvgpr_read_b32 v107, a51
  ds_write_b128 v96, v[112:115] offset:8704
  v_accvgpr_read_b32 v108, a52
  v_accvgpr_read_b32 v109, a53
  v_accvgpr_read_b32 v110, a54
  v_accvgpr_read_b32 v111, a55
  v_pk_mul_f32 v[104:105], v[104:105], v[98:99]
  v_pk_mul_f32 v[106:107], v[106:107], v[98:99]
  v_pk_mul_f32 v[108:109], v[108:109], v[98:99]
  v_pk_mul_f32 v[110:111], v[110:111], v[98:99]
  v_cvt_pk_bf16_f32 v104, v104, v105
  v_cvt_pk_bf16_f32 v105, v106, v107
  v_cvt_pk_bf16_f32 v106, v108, v109
  v_cvt_pk_bf16_f32 v107, v110, v111
  v_accvgpr_read_b32 v112, a56
  v_accvgpr_read_b32 v113, a57
  v_accvgpr_read_b32 v114, a58
  v_accvgpr_read_b32 v115, a59
  ds_write_b128 v96, v[104:107] offset:12288
  v_accvgpr_read_b32 v116, a60
  v_accvgpr_read_b32 v117, a61
  v_accvgpr_read_b32 v118, a62
  v_accvgpr_read_b32 v119, a63
  v_pk_mul_f32 v[112:113], v[112:113], v[98:99]
  v_pk_mul_f32 v[114:115], v[114:115], v[98:99]
  v_pk_mul_f32 v[116:117], v[116:117], v[98:99]
  v_pk_mul_f32 v[118:119], v[118:119], v[98:99]
  v_cvt_pk_bf16_f32 v112, v112, v113
  v_cvt_pk_bf16_f32 v113, v114, v115
  v_cvt_pk_bf16_f32 v114, v116, v117
  v_cvt_pk_bf16_f32 v115, v118, v119
  ds_write_b128 v96, v[112:115] offset:12800
  v_accvgpr_read_b32 v104, a64
  v_accvgpr_read_b32 v105, a65
  v_accvgpr_read_b32 v106, a66
  v_accvgpr_read_b32 v107, a67
  v_accvgpr_read_b32 v108, a68
  v_accvgpr_read_b32 v109, a69
  v_accvgpr_read_b32 v110, a70
  v_accvgpr_read_b32 v111, a71
  v_pk_mul_f32 v[104:105], v[104:105], v[100:101]
  v_pk_mul_f32 v[106:107], v[106:107], v[100:101]
  v_pk_mul_f32 v[108:109], v[108:109], v[100:101]
  v_pk_mul_f32 v[110:111], v[110:111], v[100:101]
  v_cvt_pk_bf16_f32 v104, v104, v105
  v_cvt_pk_bf16_f32 v105, v106, v107
  v_cvt_pk_bf16_f32 v106, v108, v109
  v_cvt_pk_bf16_f32 v107, v110, v111
  v_accvgpr_read_b32 v112, a72
  v_accvgpr_read_b32 v113, a73
  v_accvgpr_read_b32 v114, a74
  v_accvgpr_read_b32 v115, a75
  ds_write_b128 v96, v[104:107] offset:2048
  v_accvgpr_read_b32 v116, a76
  v_accvgpr_read_b32 v117, a77
  v_accvgpr_read_b32 v118, a78
  v_accvgpr_read_b32 v119, a79
  v_pk_mul_f32 v[112:113], v[112:113], v[100:101]
  v_pk_mul_f32 v[114:115], v[114:115], v[100:101]
  v_pk_mul_f32 v[116:117], v[116:117], v[100:101]
  v_pk_mul_f32 v[118:119], v[118:119], v[100:101]
  v_cvt_pk_bf16_f32 v112, v112, v113
  v_cvt_pk_bf16_f32 v113, v114, v115
  v_cvt_pk_bf16_f32 v114, v116, v117
  v_cvt_pk_bf16_f32 v115, v118, v119
  v_accvgpr_read_b32 v104, a80
  v_accvgpr_read_b32 v105, a81
  v_accvgpr_read_b32 v106, a82
  v_accvgpr_read_b32 v107, a83
  ds_write_b128 v96, v[112:115] offset:2560
  v_accvgpr_read_b32 v108, a84
  v_accvgpr_read_b32 v109, a85
  v_accvgpr_read_b32 v110, a86
  v_accvgpr_read_b32 v111, a87
  v_pk_mul_f32 v[104:105], v[104:105], v[100:101]
  v_pk_mul_f32 v[106:107], v[106:107], v[100:101]
  v_pk_mul_f32 v[108:109], v[108:109], v[100:101]
  v_pk_mul_f32 v[110:111], v[110:111], v[100:101]
  v_cvt_pk_bf16_f32 v104, v104, v105
  v_cvt_pk_bf16_f32 v105, v106, v107
  v_cvt_pk_bf16_f32 v106, v108, v109
  v_cvt_pk_bf16_f32 v107, v110, v111
  v_accvgpr_read_b32 v112, a88
  v_accvgpr_read_b32 v113, a89
  v_accvgpr_read_b32 v114, a90
  v_accvgpr_read_b32 v115, a91
  ds_write_b128 v96, v[104:107] offset:6144
  v_accvgpr_read_b32 v116, a92
  v_accvgpr_read_b32 v117, a93
  v_accvgpr_read_b32 v118, a94
  v_accvgpr_read_b32 v119, a95
  v_pk_mul_f32 v[112:113], v[112:113], v[100:101]
  v_pk_mul_f32 v[114:115], v[114:115], v[100:101]
  v_pk_mul_f32 v[116:117], v[116:117], v[100:101]
  v_pk_mul_f32 v[118:119], v[118:119], v[100:101]
  v_cvt_pk_bf16_f32 v112, v112, v113
  v_cvt_pk_bf16_f32 v113, v114, v115
  v_cvt_pk_bf16_f32 v114, v116, v117
  v_cvt_pk_bf16_f32 v115, v118, v119
  v_accvgpr_read_b32 v104, a96
  v_accvgpr_read_b32 v105, a97
  v_accvgpr_read_b32 v106, a98
  v_accvgpr_read_b32 v107, a99
  ds_write_b128 v96, v[112:115] offset:6656
  v_accvgpr_read_b32 v108, a100
  v_accvgpr_read_b32 v109, a101
  v_accvgpr_read_b32 v110, a102
  v_accvgpr_read_b32 v111, a103
  v_pk_mul_f32 v[104:105], v[104:105], v[100:101]
  v_pk_mul_f32 v[106:107], v[106:107], v[100:101]
  v_pk_mul_f32 v[108:109], v[108:109], v[100:101]
  v_pk_mul_f32 v[110:111], v[110:111], v[100:101]
  v_cvt_pk_bf16_f32 v104, v104, v105
  v_cvt_pk_bf16_f32 v105, v106, v107
  v_cvt_pk_bf16_f32 v106, v108, v109
  v_cvt_pk_bf16_f32 v107, v110, v111
  v_accvgpr_read_b32 v112, a104
  v_accvgpr_read_b32 v113, a105
  v_accvgpr_read_b32 v114, a106
  v_accvgpr_read_b32 v115, a107
  ds_write_b128 v96, v[104:107] offset:10240
  v_accvgpr_read_b32 v116, a108
  v_accvgpr_read_b32 v117, a109
  v_accvgpr_read_b32 v118, a110
  v_accvgpr_read_b32 v119, a111
  v_pk_mul_f32 v[112:113], v[112:113], v[100:101]
  v_pk_mul_f32 v[114:115], v[114:115], v[100:101]
  v_pk_mul_f32 v[116:117], v[116:117], v[100:101]
  v_pk_mul_f32 v[118:119], v[118:119], v[100:101]
  v_cvt_pk_bf16_f32 v112, v112, v113
  v_cvt_pk_bf16_f32 v113, v114, v115
  v_cvt_pk_bf16_f32 v114, v116, v117
  v_cvt_pk_bf16_f32 v115, v118, v119
  v_accvgpr_read_b32 v104, a112
  v_accvgpr_read_b32 v105, a113
  v_accvgpr_read_b32 v106, a114
  v_accvgpr_read_b32 v107, a115
  ds_write_b128 v96, v[112:115] offset:10752
  v_accvgpr_read_b32 v108, a116
  v_accvgpr_read_b32 v109, a117
  v_accvgpr_read_b32 v110, a118
  v_accvgpr_read_b32 v111, a119
  v_pk_mul_f32 v[104:105], v[104:105], v[100:101]
  v_pk_mul_f32 v[106:107], v[106:107], v[100:101]
  v_pk_mul_f32 v[108:109], v[108:109], v[100:101]
  v_pk_mul_f32 v[110:111], v[110:111], v[100:101]
  v_cvt_pk_bf16_f32 v104, v104, v105
  v_cvt_pk_bf16_f32 v105, v106, v107
  v_cvt_pk_bf16_f32 v106, v108, v109
  v_cvt_pk_bf16_f32 v107, v110, v111
  v_accvgpr_read_b32 v112, a120
  v_accvgpr_read_b32 v113, a121
  v_accvgpr_read_b32 v114, a122
  v_accvgpr_read_b32 v115, a123
  ds_write_b128 v96, v[104:107] offset:14336
  v_accvgpr_read_b32 v116, a124
  v_accvgpr_read_b32 v117, a125
  v_accvgpr_read_b32 v118, a126
  v_accvgpr_read_b32 v119, a127
  v_pk_mul_f32 v[112:113], v[112:113], v[100:101]
  v_pk_mul_f32 v[114:115], v[114:115], v[100:101]
  v_pk_mul_f32 v[116:117], v[116:117], v[100:101]
  v_pk_mul_f32 v[118:119], v[118:119], v[100:101]
  v_cvt_pk_bf16_f32 v112, v112, v113
  v_cvt_pk_bf16_f32 v113, v114, v115
  v_cvt_pk_bf16_f32 v114, v116, v117
  v_cvt_pk_bf16_f32 v115, v118, v119
  ds_write_b128 v96, v[112:115] offset:14848
  buffer_load_dwordx4 v[128:131], v236, s[16:19], s60 offen offset:0
  buffer_load_dwordx4 v[132:135], v236, s[16:19], s60 offen offset:1024
  buffer_load_dwordx4 v[136:139], v236, s[16:19], s60 offen offset:2048
  buffer_load_dwordx4 v[140:143], v236, s[16:19], s60 offen offset:3072
  buffer_load_dwordx4 v[144:147], v237, s[16:19], s60 offen offset:0
  buffer_load_dwordx4 v[148:151], v237, s[16:19], s60 offen offset:1024
  buffer_load_dwordx4 v[152:155], v237, s[16:19], s60 offen offset:2048
  buffer_load_dwordx4 v[156:159], v237, s[16:19], s60 offen offset:3072
  s_add_u32 s60, s60, 32768
  s_waitcnt vmcnt(0)
  s_branch L1_join
L1_end:
  s_endpgm
L1_code_end:
.section .rodata,"a"
.p2align 6
.amdhsa_kernel recurrent_scan__sliding_block_cached__moe_arch_mod__prompt_kernel
  .amdhsa_next_free_vgpr 512
  .amdhsa_next_free_sgpr 102
  .amdhsa_accum_offset 256
  .amdhsa_group_segment_fixed_size 0
  .amdhsa_kernarg_size 104
  .amdhsa_user_sgpr_count 2
  .amdhsa_user_sgpr_kernarg_segment_ptr 1
  .amdhsa_system_sgpr_workgroup_id_x 1
  .amdhsa_float_denorm_mode_32 3
.end_amdhsa_kernel
```
